```python
import torch

def _softmax(x, axis=-1):
    return torch.softmax(x, dim=axis)
def _gelu(x):
    return torch.nn.functional.gelu(x, approximate="tanh")
def _silu(x):
    return torch.nn.functional.silu(x)
def _sigmoid(x):
    return torch.sigmoid(x)
def _layernorm(x, axis=-1, eps=1e-5):
    m = x.mean(dim=axis, keepdim=True)
    v = x.var(dim=axis, keepdim=True, unbiased=False)
    return (x - m) / torch.sqrt(v + eps)
def _scatter_add(tgt, idx, src, axis=0):
    return tgt.clone().index_add_(axis, idx, src)
def _segment_sum(src, seg, n):
    out = torch.zeros((n,) + src.shape[1:], dtype=src.dtype)
    return out.index_add_(0, seg, src)
def _pad(x, pw):
    flat = tuple(v for pair in reversed(pw) for v in pair)
    return torch.nn.functional.pad(x, flat)

kernel_name = 'recurrent_scan__sliding_block_cached__glu_gated_glu__prompt'

def setup_inputs():

    _w = (lambda a: (lambda t: t.to(torch.bfloat16) if t.is_floating_point() else t)(torch.as_tensor(a)))
    def _A_setup():
        B, Sq, D = 1, 2048, 512
        Hq, Hkv, Sk, Dh = 32, 8, 2048, 128
        assert Hq % Hkv == 0, (Hq, Hkv)
        return {
            "x": _w((lambda *s: torch.randn(*s, dtype=torch.bfloat16) * 0.05)(B, Sq, D)),
            "k_cache": _w((lambda *s: torch.randn(*s, dtype=torch.bfloat16) * 0.8)(B, Hkv, Sk, Dh)),
            "v_cache": _w((lambda *s: torch.randn(*s, dtype=torch.bfloat16) * 0.2)(B, Hkv, Sk, Dh)),
            "wq": _w((lambda *s: torch.randn(*s, dtype=torch.bfloat16) * 0.8)(D, Hq * Dh) * (D ** -0.5)),
            "wo": _w((lambda *s: torch.randn(*s, dtype=torch.bfloat16) * 0.2)(Hq * Dh, D) * ((Hq * Dh) ** -0.5)),
        }
    _A_in = _A_setup()

    def _B_setup():
        B, S, D, F = 1, 2048, 512, 1792
        return {
            "x": _w((lambda *s: torch.randn(*s, dtype=torch.bfloat16) * 0.05)(B, S, D)),
            "w_gate": _w((lambda *s: torch.randn(*s, dtype=torch.bfloat16) * 0.2)(D, F)),
            "w_up": _w((lambda *s: torch.randn(*s, dtype=torch.bfloat16) * 0.1)(D, F)),
            "w_down": _w((lambda *s: torch.randn(*s, dtype=torch.bfloat16) * 0.1)(F, D)),
        }
    _B_in = _B_setup()

    return {
        "A_x": _A_in["x"],
        "A_k_cache": _A_in["k_cache"],
        "A_v_cache": _A_in["v_cache"],
        "A_wq": _A_in["wq"],
        "A_wo": _A_in["wo"],
        "B_x": _B_in["x"],
        "B_w_gate": _B_in["w_gate"],
        "B_w_up": _B_in["w_up"],
        "B_w_down": _B_in["w_down"],
    }

def reference(A_x, A_k_cache, A_v_cache, A_wq, A_wo, B_x, B_w_gate, B_w_up, B_w_down):
    def _A_ref(x, k_cache, v_cache, wq, wo):
        B, Sq, D = x.shape
        Hq, Dh = 32, 128
        Hkv, Sk = k_cache.shape[1], k_cache.shape[2]
        W = min(4096, max(256, Sk // 4))
        rep = Hq // Hkv
        q = (lambda x, *d: x.permute(*d))((x @ wq).reshape(B, Sq, Hq, Dh), 0, 2, 1, 3)
        k = (lambda x, n, axis: torch.repeat_interleave(x, n, dim=axis))(k_cache[:, :, Sk - W:, :], rep, axis=1)
        v = (lambda x, n, axis: torch.repeat_interleave(x, n, dim=axis))(v_cache[:, :, Sk - W:, :], rep, axis=1)
        scores = torch.einsum("bhqd,bhkd->bhqk", q, k) * (Dh ** -0.5)
        p = _softmax(scores, axis=-1)
        o = torch.einsum("bhqk,bhkd->bhqd", p, v)
        return (lambda x, *d: x.permute(*d))(o, 0, 2, 1, 3).reshape(B, Sq, Hq * Dh) @ wo

    def _B_ref(x, w_gate, w_up, w_down):
        g = torch.einsum("bsd,df->bsf", x, w_gate)
        u = torch.einsum("bsd,df->bsf", x, w_up)
        h = _sigmoid(g) * u
        return torch.einsum("bsf,fd->bsd", h, w_down)

    x = A_x
    xn = _layernorm(x, axis=-1)
    s = _A_ref(xn, A_k_cache, A_v_cache, A_wq, A_wo)
    g = _silu(_B_ref(xn, B_w_gate, B_w_up, B_w_down))
    return x + s * g
```

```asm
; @launch grid=(256,1,1) block=(256,1,1) lds=163840
.amdgcn_target "amdgcn-amd-amdhsa--gfx950"
.text
.globl recurrent_scan__sliding_block_cached__glu_gated_glu__prompt_kernel
.p2align 8
.type recurrent_scan__sliding_block_cached__glu_gated_glu__prompt_kernel,@function
recurrent_scan__sliding_block_cached__glu_gated_glu__prompt_kernel:
    s_cmp_ge_u32 s2, 256
    s_cbranch_scc1 K_END
    s_load_dwordx8 s[60:67], s[0:1], 0
    s_getpc_b64 s[42:43]
CODE0:
    s_load_dwordx4 s[68:71], s[0:1], 48
    s_load_dwordx4 s[72:75], s[0:1], 80
    v_and_b32 v1, 31, v0
    v_lshlrev_b32 v1, 7, v1
    global_load_dword v253, v1, s[42:43]
    v_lshrrev_b32 v230, 6, v0
    v_and_b32 v231, 63, v0
    v_and_b32 v3, 7, v231
    v_readfirstlane_b32 s36, v230
    v_lshrrev_b32 v4, 3, v231
    v_lshlrev_b32 v5, 10, v3
    v_lshl_add_u32 v5, v4, 4, v5
    v_lshl_add_u32 v5, v230, 8, v5
    s_lshl_b32 s3, s2, 13
    s_and_b32 s54, s2, 7
    s_lshr_b32 s55, s2, 3
    s_and_b32 s55, s55, 3
    s_lshr_b32 s38, s2, 5
    s_lshl_b32 s37, s54, 2
    s_add_u32 s37, s37, s55
    s_lshl_b32 s39, s36, 11
    s_lshl_b32 s40, s36, 10
    s_lshl_b32 s100, s36, 12
    s_mul_i32 s41, s55, 0
    s_add_u32 s41, s41, s38
    s_and_b32 s41, s41, 7
    s_lshl_b32 s49, s38, 2
    s_add_u32 s49, s49, s55
    s_lshr_b32 s49, s49, 1
    s_lshl_b32 s49, s49, 13
    s_waitcnt lgkmcnt(0)
    s_mov_b32 s4, s60
    s_mov_b32 s5, s61
    s_mov_b32 s6, 2097152
    s_mov_b32 s7, 0x00020000
    buffer_load_dwordx4 v[8:11], v5, s[4:7], s3 offen
    buffer_load_dwordx4 v[12:15], v5, s[4:7], s3 offen offset:128
    v_and_b32 v1, 3, v231
    v_lshl_add_u32 v1, v230, 2, v1
    s_lshr_b32 s56, s2, 3
    s_lshl_b32 s56, s56, 11
    v_lshlrev_b32 v1, 7, v1
    v_add_u32 v1, s56, v1
    v_min_u32 v1, CODE_END-CODE0-4, v1
    global_load_dword v253, v1, s[42:43]
    s_add_u32 s20, s74, 0
    s_addc_u32 s21, s75, 0
    s_mov_b32 s22, 2097152
    s_mov_b32 s23, 0x00020000
    s_add_u32 s32, s74, 4194304
    s_addc_u32 s33, s75, 0
    s_mov_b32 s34, 24117248
    s_mov_b32 s35, 0x00020000
    s_add_u32 s45, s74, 3145728
    s_addc_u32 s46, s75, 0
    s_mov_b32 s74, 256
    s_mov_b32 s75, 0x00020000
    s_lshl_b32 s55, s54, 19
    s_add_u32 s55, s55, 393216
    s_add_u32 s24, s62, s55
    s_addc_u32 s25, s63, 0
    s_mov_b32 s26, 131072
    s_mov_b32 s27, 0x00020000
    s_add_u32 s28, s64, s55
    s_addc_u32 s29, s65, 0
    s_mov_b32 s30, 131072
    s_mov_b32 s31, 0x00020000
    s_lshl_b32 s63, s2, 7
    v_and_b32 v254, 31, v231
    v_lshlrev_b32 v175, 3, v254
    v_lshlrev_b32 v254, 7, v254
    v_mov_b32 v174, 0
    s_or_b32 s55, s2, s36
    s_cmp_lg_u32 s55, 0
    s_cbranch_scc1 EPD
    s_memrealtime s[60:61]
    s_waitcnt lgkmcnt(0)
    s_or_b32 s62, s60, 1
    v_mov_b32 v172, s62
    s_mov_b64 exec, 1
    buffer_store_dword v172, v174, s[72:75], 0 offen sc1
    s_mov_b64 exec, -1
EPD:
    v_lshrrev_b32 v232, 4, v231
    v_and_b32 v233, 15, v231
    v_lshlrev_b32 v234, 2, v232
    v_xor_b32 v234, v233, v234
    v_lshlrev_b32 v234, 4, v234
    v_lshl_add_u32 v235, v230, 4, v232
    v_lshl_add_u32 v206, v235, 13, v234
    s_lshl_b32 s55, s37, 8
    s_sub_u32 s56, 4194304, s55
    s_add_u32 s8, s66, s55
    s_addc_u32 s9, s67, 0
    s_mov_b32 s10, s56
    s_mov_b32 s11, 0x00020000
    v_lshrrev_b32 v236, 1, v4
    v_xor_b32 v237, v3, v236
    v_lshlrev_b32 v237, 4, v237
    v_lshl_add_u32 v136, v4, 10, v237
    s_lshl_b32 s55, s38, 18
    s_lshl_b32 s56, s36, 16
    s_add_u32 s55, s55, s56
    v_add_u32 v136, s55, v136
    v_xor_b32 v137, 64, v136
    s_lshl_b32 s44, s41, 7
    s_lshl_b32 s59, s36, 13
    s_and_b32 s55, s37, 3
    s_lshl_b32 s55, s55, 16
    s_lshl_b32 s56, s38, 18
    s_add_u32 s55, s55, s56
    s_lshl_b32 s56, s36, 14
    s_add_u32 s55, s55, s56
    v_bfe_u32 v236, v231, 4, 1
    v_add_u32 v236, s41, v236
    v_lshlrev_b32 v237, 10, v233
    v_add_u32 v237, s55, v237
    v_add_u32 v238, 0, v236
    v_and_b32 v238, 7, v238
    v_lshl_add_u32 v180, v238, 7, v237
    buffer_load_dword v253, v180, s[4:7], 0 offen
    v_add_u32 v238, 2, v236
    v_and_b32 v238, 7, v238
    v_lshl_add_u32 v181, v238, 7, v237
    v_add_u32 v238, 4, v236
    v_and_b32 v238, 7, v238
    v_lshl_add_u32 v182, v238, 7, v237
    v_add_u32 v238, 6, v236
    v_and_b32 v238, 7, v238
    v_lshl_add_u32 v183, v238, 7, v237
    s_lshl_b32 s42, s41, 19
    s_add_u32 m0, s100, 98304
    s_add_u32 s41, s41, 1
    buffer_load_dwordx4 v206, s[8:11], s42 offen offset:0 lds
    s_add_u32 m0, s100, 98304
    s_add_u32 s42, s42, 31744
    buffer_load_dwordx4 v206, s[8:11], s42 offen offset:1024 lds
    s_add_u32 m0, s100, 98304
    s_add_u32 s42, s42, 31744
    buffer_load_dwordx4 v206, s[8:11], s42 offen offset:2048 lds
    s_add_u32 m0, s100, 98304
    s_add_u32 s42, s42, 31744
    buffer_load_dwordx4 v206, s[8:11], s42 offen offset:3072 lds
    s_and_b32 s41, s41, 7
    s_lshr_b32 s57, s54, 1
    s_mul_i32 s57, s57, 7
    s_and_b32 s55, s37, 7
    s_add_u32 s57, s57, s55
    s_cmp_eq_u32 s55, 7
    s_cselect_b32 s58, 1, 0
    s_lshl_b32 s55, s57, 7
    s_sub_u32 s56, 1835008, s55
    s_cmp_lg_u32 s58, 0
    s_cselect_b32 s56, 0, s56
    s_add_u32 s12, s68, s55
    s_addc_u32 s13, s69, 0
    s_mov_b32 s14, s56
    s_mov_b32 s15, 0x00020000
    s_add_u32 s16, s70, s55
    s_addc_u32 s17, s71, 0
    s_mov_b32 s18, s56
    s_mov_b32 s19, 0x00020000
    s_mov_b32 s68, s45
    s_mov_b32 s69, s46
    s_mov_b32 s70, 524288
    s_mov_b32 s71, 0x00020000
    s_mov_b32 s50, 0x3e0293ee
    s_mov_b32 s52, 0xbfb8aa3b
    s_mov_b32 s53, 0xbfb8aa3b
    s_mov_b32 s48, 0
    s_mov_b32 s45, s49
    s_mov_b32 s46, s49
    s_lshl_b32 s57, s57, 12
    s_add_u32 s57, s57, 262144
    s_cmp_lg_u32 s58, 0
    s_cselect_b32 s57, 0x40000000, s57
    s_lshl_b32 s58, s37, 13
    v_lshrrev_b32 v6, 1, v4
    s_add_u32 m0, s59, 32768
    s_add_u32 s43, s44, 0
    buffer_load_dwordx4 v136, s[4:7], s43 offen lds
    v_lshlrev_b32 v6, 10, v6
    v_and_b32 v7, 1, v4
    v_lshl_add_u32 v6, v7, 9, v6
    v_lshl_add_u32 v6, v3, 4, v6
    v_lshl_add_u32 v6, v230, 13, v6
    v_add_u32 v17, 4096, v6
    v_lshlrev_b32 v16, 4, v3
    v_add_u32 v16, 0, v16
    v_lshl_add_u32 v7, v230, 2, v16
    v_lshrrev_b32 v232, 5, v231
    v_bfe_u32 v233, v231, 4, 1
    v_bfe_u32 v234, v231, 2, 2
    v_and_b32 v235, 3, v231
    v_and_b32 v236, 1, v235
    v_lshrrev_b32 v237, 1, v235
    v_lshl_add_u32 v236, v236, 1, v237
    v_lshlrev_b32 v237, 5, v233
    v_lshl_add_u32 v238, v236, 3, v237
    v_lshl_add_u32 v239, v235, 3, v237
    v_lshl_add_u32 v240, v232, 3, v234
    s_add_u32 m0, s59, 33792
    s_add_u32 s43, s44, 8192
    buffer_load_dwordx4 v137, s[4:7], s43 offen lds
    v_lshl_add_u32 v241, v240, 8, v238
    v_add_u32 v241, 0x10000, v241
    v_xor_b32 v242, 0, v234
    v_lshl_add_u32 v192, v242, 6, v241
    v_add_u32 v196, 0x10000, v192
    v_xor_b32 v242, 1, v234
    v_lshl_add_u32 v193, v242, 6, v241
    v_add_u32 v197, 0x10000, v193
    v_xor_b32 v242, 2, v234
    v_lshl_add_u32 v194, v242, 6, v241
    v_add_u32 v198, 0x10000, v194
    v_xor_b32 v242, 3, v234
    v_lshl_add_u32 v195, v242, 6, v241
    v_add_u32 v199, 0x10000, v195
    v_xor_b32 v242, s36, v234
    v_lshl_add_u32 v138, v242, 6, v241
    v_add_u32 v139, 0x10000, v138
    v_and_b32 v242, 31, v231
    v_bfe_u32 v243, v231, 1, 3
    v_lshlrev_b32 v242, 7, v242
    s_add_u32 m0, s59, 34816
    s_add_u32 s43, s44, 16384
    buffer_load_dwordx4 v136, s[4:7], s43 offen lds
    v_add_u32 v242, s59, v242
    v_add_u32 v244, 0, v232
    v_xor_b32 v244, v244, v243
    v_lshl_add_u32 v128, v244, 4, v242
    v_add_u32 v132, 0x10000, v128
    v_add_u32 v244, 2, v232
    v_xor_b32 v244, v244, v243
    v_lshl_add_u32 v129, v244, 4, v242
    v_add_u32 v133, 0x10000, v129
    v_add_u32 v244, 4, v232
    v_xor_b32 v244, v244, v243
    v_lshl_add_u32 v130, v244, 4, v242
    v_add_u32 v134, 0x10000, v130
    v_add_u32 v244, 6, v232
    v_xor_b32 v244, v244, v243
    v_lshl_add_u32 v131, v244, 4, v242
    v_add_u32 v135, 0x10000, v131
    s_lshr_b32 s55, s2, 2
    s_lshl_b32 s55, s55, 15
    s_and_b32 s56, s2, 3
    s_lshl_b32 s56, s56, 7
    s_add_u32 s3, s55, s56
    s_mov_b32 s54, 0x3b000000
    s_waitcnt vmcnt(9)
    v_lshlrev_b32 v20, 16, v8
    s_add_u32 m0, s59, 35840
    s_add_u32 s43, s44, 24576
    buffer_load_dwordx4 v137, s[4:7], s43 offen lds
    v_and_b32 v21, 0xffff0000, v8
    v_lshlrev_b32 v22, 16, v9
    v_and_b32 v23, 0xffff0000, v9
    v_lshlrev_b32 v24, 16, v10
    v_and_b32 v25, 0xffff0000, v10
    v_lshlrev_b32 v26, 16, v11
    v_and_b32 v27, 0xffff0000, v11
    v_lshlrev_b32 v28, 16, v12
    v_and_b32 v29, 0xffff0000, v12
    v_lshlrev_b32 v30, 16, v13
    v_and_b32 v31, 0xffff0000, v13
    v_lshlrev_b32 v32, 16, v14
    v_and_b32 v33, 0xffff0000, v14
    v_lshlrev_b32 v34, 16, v15
    v_and_b32 v35, 0xffff0000, v15
    v_add_f32 v36, v20, v21
    v_add_f32 v37, v22, v23
    v_add_f32 v36, v36, v24
    v_add_f32 v37, v37, v25
    v_add_f32 v36, v36, v26
    s_add_u32 m0, s59, 36864
    s_add_u32 s43, s44, 32768
    buffer_load_dwordx4 v136, s[4:7], s43 offen lds
    v_add_f32 v37, v37, v27
    v_add_f32 v36, v36, v28
    v_add_f32 v37, v37, v29
    v_add_f32 v36, v36, v30
    v_add_f32 v37, v37, v31
    v_add_f32 v36, v36, v32
    v_add_f32 v37, v37, v33
    v_add_f32 v36, v36, v34
    v_add_f32 v37, v37, v35
    v_add_f32 v36, v36, v37
    s_nop 1
    v_add_f32_dpp v36, v36, v36 row_ror:8 row_mask:0xf bank_mask:0xf
    v_mov_b32 v41, v36
    s_nop 1
    v_permlane16_swap_b32 v36, v41
    v_add_f32 v36, v36, v41
    v_mov_b32 v41, v36
    s_nop 1
    v_permlane32_swap_b32 v36, v41
    v_add_f32 v36, v36, v41
    ds_write_b32 v7, v36 offset:0
    s_waitcnt lgkmcnt(0)
    s_barrier
    ds_read_b128 v[44:47], v16 offset:0
    s_waitcnt lgkmcnt(0)
    v_add_f32 v44, v44, v45
    s_add_u32 m0, s59, 37888
    s_add_u32 s43, s44, 40960
    buffer_load_dwordx4 v137, s[4:7], s43 offen lds
    v_add_f32 v46, v46, v47
    v_add_f32 v40, v44, v46
    v_mul_f32 v48, s54, v40
    v_mov_b32 v36, 0
    v_mov_b32 v37, 0
    v_sub_f32 v38, v20, v48
    v_sub_f32 v39, v21, v48
    v_fmac_f32 v36, v38, v38
    v_fmac_f32 v37, v39, v39
    v_sub_f32 v38, v22, v48
    v_sub_f32 v39, v23, v48
    v_fmac_f32 v36, v38, v38
    v_fmac_f32 v37, v39, v39
    v_sub_f32 v38, v24, v48
    v_sub_f32 v39, v25, v48
    v_fmac_f32 v36, v38, v38
    v_fmac_f32 v37, v39, v39
    v_sub_f32 v38, v26, v48
    v_sub_f32 v39, v27, v48
    v_fmac_f32 v36, v38, v38
    s_add_u32 m0, s59, 38912
    s_add_u32 s43, s44, 49152
    buffer_load_dwordx4 v136, s[4:7], s43 offen lds
    v_fmac_f32 v37, v39, v39
    v_sub_f32 v38, v28, v48
    v_sub_f32 v39, v29, v48
    v_fmac_f32 v36, v38, v38
    v_fmac_f32 v37, v39, v39
    v_sub_f32 v38, v30, v48
    v_sub_f32 v39, v31, v48
    v_fmac_f32 v36, v38, v38
    v_fmac_f32 v37, v39, v39
    v_sub_f32 v38, v32, v48
    v_sub_f32 v39, v33, v48
    v_fmac_f32 v36, v38, v38
    v_fmac_f32 v37, v39, v39
    v_sub_f32 v38, v34, v48
    v_sub_f32 v39, v35, v48
    v_fmac_f32 v36, v38, v38
    v_fmac_f32 v37, v39, v39
    v_add_f32 v36, v36, v37
    s_nop 1
    v_add_f32_dpp v36, v36, v36 row_ror:8 row_mask:0xf bank_mask:0xf
    s_add_u32 m0, s59, 39936
    s_add_u32 s43, s44, 57344
    buffer_load_dwordx4 v137, s[4:7], s43 offen lds
    s_add_u32 s44, s44, 128
    s_and_b32 s44, s44, 0x3ff
    v_mov_b32 v41, v36
    s_nop 1
    v_permlane16_swap_b32 v36, v41
    v_add_f32 v36, v36, v41
    v_mov_b32 v41, v36
    s_nop 1
    v_permlane32_swap_b32 v36, v41
    v_add_f32 v36, v36, v41
    ds_write_b32 v7, v36 offset:128
    s_waitcnt lgkmcnt(0)
    s_barrier
    ds_read_b128 v[44:47], v16 offset:128
    s_waitcnt lgkmcnt(0)
    v_add_f32 v44, v44, v45
    v_add_f32 v46, v46, v47
    v_add_f32 v40, v44, v46
    v_mul_f32 v49, s54, v40
    v_cvt_pk_bf16_f32 v49, v49, v49
    v_and_b32 v49, 0xffff0000, v49
    v_add_f32 v49, 0x3727c5ac, v49
    v_cvt_pk_bf16_f32 v49, v49, v49
    v_and_b32 v49, 0xffff0000, v49
    v_sqrt_f32 v49, v49
    v_cvt_pk_bf16_f32 v48, v48, v48
    v_cvt_pk_bf16_f32 v49, v49, v49
    v_and_b32 v48, 0xffff0000, v48
    v_and_b32 v49, 0xffff0000, v49
    v_rcp_f32 v49, v49
    v_sub_f32 v20, v20, v48
    v_sub_f32 v21, v21, v48
    v_cvt_pk_bf16_f32 v38, v20, v21
    v_lshlrev_b32 v20, 16, v38
    v_and_b32 v21, 0xffff0000, v38
    v_mul_f32 v20, v20, v49
    v_mul_f32 v21, v21, v49
    v_cvt_pk_bf16_f32 v8, v20, v21
    v_sub_f32 v22, v22, v48
    v_sub_f32 v23, v23, v48
    v_cvt_pk_bf16_f32 v38, v22, v23
    v_lshlrev_b32 v22, 16, v38
    v_and_b32 v23, 0xffff0000, v38
    v_mul_f32 v22, v22, v49
    v_mul_f32 v23, v23, v49
    v_cvt_pk_bf16_f32 v9, v22, v23
    v_sub_f32 v24, v24, v48
    v_sub_f32 v25, v25, v48
    v_cvt_pk_bf16_f32 v38, v24, v25
    v_lshlrev_b32 v24, 16, v38
    v_and_b32 v25, 0xffff0000, v38
    v_mul_f32 v24, v24, v49
    v_mul_f32 v25, v25, v49
    v_cvt_pk_bf16_f32 v10, v24, v25
    v_sub_f32 v26, v26, v48
    v_sub_f32 v27, v27, v48
    v_cvt_pk_bf16_f32 v38, v26, v27
    v_lshlrev_b32 v26, 16, v38
    v_and_b32 v27, 0xffff0000, v38
    v_mul_f32 v26, v26, v49
    v_mul_f32 v27, v27, v49
    v_cvt_pk_bf16_f32 v11, v26, v27
    buffer_store_dwordx4 v[8:11], v6, s[20:23], s3 offen sc1
    v_sub_f32 v28, v28, v48
    v_sub_f32 v29, v29, v48
    v_cvt_pk_bf16_f32 v38, v28, v29
    v_lshlrev_b32 v28, 16, v38
    v_and_b32 v29, 0xffff0000, v38
    v_mul_f32 v28, v28, v49
    v_mul_f32 v29, v29, v49
    v_cvt_pk_bf16_f32 v12, v28, v29
    v_sub_f32 v30, v30, v48
    v_sub_f32 v31, v31, v48
    v_cvt_pk_bf16_f32 v38, v30, v31
    v_lshlrev_b32 v30, 16, v38
    v_and_b32 v31, 0xffff0000, v38
    v_mul_f32 v30, v30, v49
    v_mul_f32 v31, v31, v49
    v_cvt_pk_bf16_f32 v13, v30, v31
    v_sub_f32 v32, v32, v48
    v_sub_f32 v33, v33, v48
    v_cvt_pk_bf16_f32 v38, v32, v33
    v_lshlrev_b32 v32, 16, v38
    v_and_b32 v33, 0xffff0000, v38
    v_mul_f32 v32, v32, v49
    v_mul_f32 v33, v33, v49
    v_cvt_pk_bf16_f32 v14, v32, v33
    v_sub_f32 v34, v34, v48
    v_sub_f32 v35, v35, v48
    v_cvt_pk_bf16_f32 v38, v34, v35
    v_lshlrev_b32 v34, 16, v38
    v_and_b32 v35, 0xffff0000, v38
    v_mul_f32 v34, v34, v49
    v_mul_f32 v35, v35, v49
    v_cvt_pk_bf16_f32 v15, v34, v35
    buffer_store_dwordx4 v[12:15], v17, s[20:23], s3 offen sc1
    v_xor_b32 v56, 0x80000000, v48
    v_lshrrev_b32 v57, 16, v56
    v_or_b32 v56, v56, v57
    v_mul_f32 v57, s50, v49
    v_lshlrev_b32 v58, 3, v3
    s_lshl_b32 s55, s2, 6
    s_add_u32 s55, s55, 32768
    s_cmp_lg_u32 s36, 0
    s_cselect_b32 s55, 0x40000000, s55
    s_mov_b64 exec, 0xff
    buffer_store_dwordx2 v[56:57], v58, s[68:71], s55 offen sc1
    s_mov_b64 exec, -1
    s_load_dwordx2 s[60:61], s[0:1], 32
    s_load_dwordx2 s[64:65], s[0:1], 64
    s_mov_b32 s51, 0x3f803f80
    v_mov_b32 v156, 0
    v_mov_b32 v157, 0
    s_lshl_b32 s54, s38, 12
    s_lshl_b32 s56, s38, 11
    s_lshl_b32 s55, s36, 9
    s_add_u32 s56, s56, s55
    s_add_u32 s56, s56, 32768
    buffer_load_dword v253, v181, s[4:7], 0 offen
    s_lshl_b32 s55, s36, 12
    buffer_load_dword v255, v174, s[72:75], s55 offen sc1
    s_waitcnt vmcnt(5)
    s_barrier
    ds_read_b64_tr_b16 a[0:1], v192 offset:32768
    ds_read_b64_tr_b16 a[2:3], v192 offset:33792
    ds_read_b128 a[32:35], v128 offset:32768
    ds_read_b128 a[36:39], v128 offset:36864
    ds_read_b64_tr_b16 a[4:5], v193 offset:32768
    ds_read_b64_tr_b16 a[6:7], v193 offset:33792
    ds_read_b64_tr_b16 a[8:9], v194 offset:32768
    ds_read_b64_tr_b16 a[10:11], v194 offset:33792
    ds_read_b64_tr_b16 a[12:13], v195 offset:32768
    ds_read_b64_tr_b16 a[14:15], v195 offset:33792
    ds_read_b64_tr_b16 v[140:141], v138 offset:32768
    ds_read_b64_tr_b16 v[142:143], v138 offset:33792
    ds_read_b64_tr_b16 v[144:145], v138 offset:36864
    ds_read_b64_tr_b16 v[146:147], v138 offset:37888
    s_waitcnt lgkmcnt(0)
    s_mov_b32 s66, 1835008
    s_mov_b32 s67, 0x00020000
    s_waitcnt lgkmcnt(4)
    v_mfma_f32_32x32x16_bf16 v[0:15], a[0:3], a[32:35], 0
    s_lshl_b32 s42, s41, 19
    s_add_u32 m0, s100, 114688
    s_add_u32 s41, s41, 1
    buffer_load_dwordx4 v206, s[8:11], s42 offen offset:0 lds
    ds_read_b64_tr_b16 v[148:149], v138 offset:40960
    ds_read_b64_tr_b16 v[150:151], v138 offset:41984
    v_dot2c_f32_bf16 v156, s51, v140
    ds_read_b64_tr_b16 a[16:17], v192 offset:36864
    ds_read_b64_tr_b16 a[18:19], v192 offset:37888
    v_mfma_f32_32x32x16_bf16 v[16:31], a[0:3], a[36:39], 0
    ds_read_b64_tr_b16 v[152:153], v138 offset:45056
    ds_read_b64_tr_b16 v[154:155], v138 offset:46080
    v_dot2c_f32_bf16 v157, s51, v141
    ds_read_b128 a[40:43], v129 offset:32768
    ds_read_b128 a[44:47], v129 offset:36864
    v_mfma_f32_32x32x16_bf16 v[32:47], a[4:7], a[32:35], 0
    s_add_u32 m0, s100, 114688
    s_add_u32 s42, s42, 31744
    buffer_load_dwordx4 v206, s[8:11], s42 offen offset:1024 lds
    v_dot2c_f32_bf16 v156, s51, v142
    ds_read_b64_tr_b16 a[20:21], v193 offset:36864
    ds_read_b64_tr_b16 a[22:23], v193 offset:37888
    v_mfma_f32_32x32x16_bf16 v[48:63], a[4:7], a[36:39], 0
    v_dot2c_f32_bf16 v157, s51, v143
    ds_read_b64_tr_b16 a[24:25], v194 offset:36864
    ds_read_b64_tr_b16 a[26:27], v194 offset:37888
    v_mfma_f32_32x32x16_bf16 v[64:79], a[8:11], a[32:35], 0
    s_add_u32 m0, s100, 114688
    s_add_u32 s42, s42, 31744
    buffer_load_dwordx4 v206, s[8:11], s42 offen offset:2048 lds
    v_dot2c_f32_bf16 v156, s51, v144
    ds_read_b64_tr_b16 a[28:29], v195 offset:36864
    ds_read_b64_tr_b16 a[30:31], v195 offset:37888
    s_lshl_b32 s47, s38, 6
    v_mfma_f32_32x32x16_bf16 v[80:95], a[8:11], a[36:39], 0
    v_dot2c_f32_bf16 v157, s51, v145
    v_add_u32 v227, s47, v231
    v_mfma_f32_32x32x16_bf16 v[96:111], a[12:15], a[32:35], 0
    s_add_u32 m0, s100, 114688
    s_add_u32 s42, s42, 31744
    buffer_load_dwordx4 v206, s[8:11], s42 offen offset:3072 lds
    s_and_b32 s41, s41, 7
    v_dot2c_f32_bf16 v156, s51, v146
    v_mul_u32_u24 v227, 3584, v227
    v_mfma_f32_32x32x16_bf16 v[112:127], a[12:15], a[36:39], 0
    v_dot2c_f32_bf16 v157, s51, v147
    v_lshrrev_b32 v233, 4, v231
    s_waitcnt lgkmcnt(0)
    v_mfma_f32_32x32x16_bf16 v[0:15], a[16:19], a[40:43], v[0:15]
    s_add_u32 m0, s59, 65536
    s_add_u32 s43, s44, 0
    buffer_load_dwordx4 v136, s[4:7], s43 offen lds
    v_dot2c_f32_bf16 v156, s51, v148
    ds_read_b64_tr_b16 a[0:1], v192 offset:40960
    ds_read_b64_tr_b16 a[2:3], v192 offset:41984
    v_and_b32 v235, 15, v231
    v_mfma_f32_32x32x16_bf16 v[16:31], a[16:19], a[44:47], v[16:31]
    v_dot2c_f32_bf16 v157, s51, v149
    ds_read_b128 a[32:35], v130 offset:32768
    ds_read_b128 a[36:39], v130 offset:36864
    v_lshlrev_b32 v236, 2, v233
    v_mfma_f32_32x32x16_bf16 v[32:47], a[20:23], a[40:43], v[32:47]
    s_add_u32 m0, s59, 66560
    s_add_u32 s43, s44, 8192
    buffer_load_dwordx4 v137, s[4:7], s43 offen lds
    v_dot2c_f32_bf16 v156, s51, v150
    ds_read_b64_tr_b16 a[4:5], v193 offset:40960
    ds_read_b64_tr_b16 a[6:7], v193 offset:41984
    v_xor_b32 v236, v235, v236
    v_mfma_f32_32x32x16_bf16 v[48:63], a[20:23], a[44:47], v[48:63]
    v_dot2c_f32_bf16 v157, s51, v151
    ds_read_b64_tr_b16 a[8:9], v194 offset:40960
    ds_read_b64_tr_b16 a[10:11], v194 offset:41984
    v_lshlrev_b32 v236, 4, v236
    v_mfma_f32_32x32x16_bf16 v[64:79], a[24:27], a[40:43], v[64:79]
    s_add_u32 m0, s59, 67584
    s_add_u32 s43, s44, 16384
    buffer_load_dwordx4 v136, s[4:7], s43 offen lds
    v_dot2c_f32_bf16 v156, s51, v152
    ds_read_b64_tr_b16 a[12:13], v195 offset:40960
    ds_read_b64_tr_b16 a[14:15], v195 offset:41984
    v_lshl_add_u32 v237, v230, 3, v233
    v_mfma_f32_32x32x16_bf16 v[80:95], a[24:27], a[44:47], v[80:95]
    v_dot2c_f32_bf16 v157, s51, v153
    v_lshl_add_u32 v224, v237, 8, v236
    v_mfma_f32_32x32x16_bf16 v[96:111], a[28:31], a[40:43], v[96:111]
    s_add_u32 m0, s59, 68608
    s_add_u32 s43, s44, 24576
    buffer_load_dwordx4 v137, s[4:7], s43 offen lds
    v_dot2c_f32_bf16 v156, s51, v154
    v_xor_b32 v236, v235, v237
    v_mfma_f32_32x32x16_bf16 v[112:127], a[28:31], a[44:47], v[112:127]
    v_dot2c_f32_bf16 v157, s51, v155
    v_and_b32 v236, 15, v236
    s_waitcnt lgkmcnt(0)
    v_mfma_f32_32x32x16_bf16 v[0:15], a[0:3], a[32:35], v[0:15]
    s_add_u32 m0, s59, 69632
    s_add_u32 s43, s44, 32768
    buffer_load_dwordx4 v136, s[4:7], s43 offen lds
    ds_read_b64_tr_b16 a[16:17], v192 offset:45056
    ds_read_b64_tr_b16 a[18:19], v192 offset:46080
    v_lshlrev_b32 v236, 4, v236
    v_mfma_f32_32x32x16_bf16 v[16:31], a[0:3], a[36:39], v[16:31]
    v_add_f32 v156, v156, v157
    v_lshrrev_b32 v185, 5, v254
    ds_read_b128 a[40:43], v131 offset:32768
    ds_read_b128 a[44:47], v131 offset:36864
    v_lshl_add_u32 v222, v237, 8, v236
    v_mfma_f32_32x32x16_bf16 v[32:47], a[4:7], a[32:35], v[32:47]
    s_add_u32 m0, s59, 70656
    s_add_u32 s43, s44, 40960
    buffer_load_dwordx4 v137, s[4:7], s43 offen lds
    v_mov_b32 v157, v156
    ds_read_b64_tr_b16 a[20:21], v193 offset:45056
    ds_read_b64_tr_b16 a[22:23], v193 offset:46080
    v_mfma_f32_32x32x16_bf16 v[48:63], a[4:7], a[36:39], v[48:63]
    s_nop 1
    ds_read_b64_tr_b16 a[24:25], v194 offset:45056
    ds_read_b64_tr_b16 a[26:27], v194 offset:46080
    v_add_u32 v238, 4, v237
    v_mfma_f32_32x32x16_bf16 v[64:79], a[8:11], a[32:35], v[64:79]
    s_add_u32 m0, s59, 71680
    s_add_u32 s43, s44, 49152
    buffer_load_dwordx4 v136, s[4:7], s43 offen lds
    v_permlane32_swap_b32 v156, v157
    v_add_f32 v156, v156, v157
    ds_read_b64_tr_b16 a[28:29], v195 offset:45056
    ds_read_b64_tr_b16 a[30:31], v195 offset:46080
    v_xor_b32 v236, v235, v238
    v_mfma_f32_32x32x16_bf16 v[80:95], a[8:11], a[36:39], v[80:95]
    v_and_b32 v236, 15, v236
    v_mfma_f32_32x32x16_bf16 v[96:111], a[12:15], a[32:35], v[96:111]
    s_add_u32 m0, s59, 72704
    s_add_u32 s43, s44, 57344
    buffer_load_dwordx4 v137, s[4:7], s43 offen lds
    s_add_u32 s44, s44, 128
    s_and_b32 s44, s44, 0x3ff
    v_lshlrev_b32 v236, 4, v236
    v_mfma_f32_32x32x16_bf16 v[112:127], a[12:15], a[36:39], v[112:127]
    v_lshl_add_u32 v223, v237, 8, v236
    s_waitcnt vmcnt(0) lgkmcnt(0)
    s_barrier
    s_waitcnt lgkmcnt(0)
    v_mfma_f32_32x32x16_bf16 v[0:15], a[16:19], a[40:43], v[0:15]
    s_lshl_b32 s42, s41, 19
    s_add_u32 m0, s100, 131072
    s_add_u32 s41, s41, 1
    buffer_load_dwordx4 v206, s[8:11], s42 offen offset:0 lds
    ds_read_b64_tr_b16 a[0:1], v192 offset:49152
    ds_read_b64_tr_b16 a[2:3], v192 offset:50176
    v_and_b32 v237, 7, v231
    v_mfma_f32_32x32x16_bf16 v[16:31], a[16:19], a[44:47], v[16:31]
    ds_read_b128 a[32:35], v132 offset:0
    ds_read_b128 a[36:39], v132 offset:4096
    v_and_b32 v238, 1, v233
    v_mfma_f32_32x32x16_bf16 v[32:47], a[20:23], a[40:43], v[32:47]
    s_lshl_b32 s55, s37, 3
    s_add_u32 s55, s55, s38
    s_lshl_b32 s55, s55, 2
    s_add_u32 s55, s55, s36
    s_lshl_b32 s55, s55, 7
    s_add_u32 s55, s55, 196608
    s_mov_b32 exec_hi, 0
    buffer_store_dword v156, v185, s[68:71], s55 offen sc1
    s_mov_b32 exec_hi, -1
    ds_read_b64_tr_b16 a[4:5], v193 offset:49152
    ds_read_b64_tr_b16 a[6:7], v193 offset:50176
    v_lshlrev_b32 v238, 2, v238
    v_mfma_f32_32x32x16_bf16 v[48:63], a[20:23], a[44:47], v[48:63]
    ds_read_b64_tr_b16 a[8:9], v194 offset:49152
    ds_read_b64_tr_b16 a[10:11], v194 offset:50176
    v_xor_b32 v237, v237, v238
    v_mfma_f32_32x32x16_bf16 v[64:79], a[24:27], a[40:43], v[64:79]
    s_add_u32 m0, s100, 131072
    s_add_u32 s42, s42, 31744
    buffer_load_dwordx4 v206, s[8:11], s42 offen offset:1024 lds
    ds_read_b64_tr_b16 a[12:13], v195 offset:49152
    ds_read_b64_tr_b16 a[14:15], v195 offset:50176
    v_lshlrev_b32 v237, 4, v237
    v_mfma_f32_32x32x16_bf16 v[80:95], a[24:27], a[44:47], v[80:95]
    v_lshrrev_b32 v236, 3, v231
    v_mfma_f32_32x32x16_bf16 v[96:111], a[28:31], a[40:43], v[96:111]
    s_add_u32 m0, s100, 131072
    s_add_u32 s42, s42, 31744
    buffer_load_dwordx4 v206, s[8:11], s42 offen offset:2048 lds
    v_lshl_add_u32 v236, v230, 4, v236
    v_mfma_f32_32x32x16_bf16 v[112:127], a[28:31], a[44:47], v[112:127]
    v_mul_u32_u24 v236, 3584, v236
    s_waitcnt lgkmcnt(0)
    v_mfma_f32_32x32x16_bf16 v[0:15], a[0:3], a[32:35], v[0:15]
    s_add_u32 m0, s100, 131072
    s_add_u32 s42, s42, 31744
    buffer_load_dwordx4 v206, s[8:11], s42 offen offset:3072 lds
    s_and_b32 s41, s41, 7
    ds_read_b64_tr_b16 a[16:17], v192 offset:53248
    ds_read_b64_tr_b16 a[18:19], v192 offset:54272
    v_add_u32 v207, v236, v237
    v_mfma_f32_32x32x16_bf16 v[16:31], a[0:3], a[36:39], v[16:31]
    ds_read_b128 a[40:43], v133 offset:0
    ds_read_b128 a[44:47], v133 offset:4096
    s_lshl_b32 s101, s38, 3
    v_mfma_f32_32x32x16_bf16 v[32:47], a[4:7], a[32:35], v[32:47]
    s_add_u32 m0, s59, 0
    s_add_u32 s43, s44, 0
    buffer_load_dwordx4 v136, s[4:7], s43 offen lds
    ds_read_b64_tr_b16 a[20:21], v193 offset:53248
    ds_read_b64_tr_b16 a[22:23], v193 offset:54272
    s_lshl_b32 s47, s36, 1
    s_add_u32 s101, s101, s47
    v_mfma_f32_32x32x16_bf16 v[48:63], a[4:7], a[36:39], v[48:63]
    ds_read_b64_tr_b16 a[24:25], v194 offset:53248
    ds_read_b64_tr_b16 a[26:27], v194 offset:54272
    s_lshl_b32 s47, s101, 15
    v_mfma_f32_32x32x16_bf16 v[64:79], a[8:11], a[32:35], v[64:79]
    s_add_u32 m0, s59, 1024
    s_add_u32 s43, s44, 8192
    buffer_load_dwordx4 v137, s[4:7], s43 offen lds
    ds_read_b64_tr_b16 a[28:29], v195 offset:53248
    ds_read_b64_tr_b16 a[30:31], v195 offset:54272
    v_lshlrev_b32 v236, 4, v231
    v_mfma_f32_32x32x16_bf16 v[80:95], a[8:11], a[36:39], v[80:95]
    v_add_u32 v208, s47, v236
    v_mfma_f32_32x32x16_bf16 v[96:111], a[12:15], a[32:35], v[96:111]
    s_add_u32 m0, s59, 2048
    s_add_u32 s43, s44, 16384
    buffer_load_dwordx4 v136, s[4:7], s43 offen lds
    v_add_u32 v209, 32768, v208
    v_mfma_f32_32x32x16_bf16 v[112:127], a[12:15], a[36:39], v[112:127]
    s_mul_i32 s47, s101, 376832
    v_add_u32 v225, s47, v236
    s_waitcnt lgkmcnt(0)
    v_mfma_f32_32x32x16_bf16 v[0:15], a[16:19], a[40:43], v[0:15]
    s_add_u32 m0, s59, 3072
    s_add_u32 s43, s44, 24576
    buffer_load_dwordx4 v137, s[4:7], s43 offen lds
    ds_read_b64_tr_b16 a[0:1], v192 offset:57344
    ds_read_b64_tr_b16 a[2:3], v192 offset:58368
    v_mfma_f32_32x32x16_bf16 v[16:31], a[16:19], a[44:47], v[16:31]
    ds_read_b128 a[32:35], v134 offset:0
    ds_read_b128 a[36:39], v134 offset:4096
    v_add_u32 v226, 376832, v225
    v_mfma_f32_32x32x16_bf16 v[32:47], a[20:23], a[40:43], v[32:47]
    s_add_u32 m0, s59, 4096
    s_add_u32 s43, s44, 32768
    buffer_load_dwordx4 v136, s[4:7], s43 offen lds
    ds_read_b64_tr_b16 a[4:5], v193 offset:57344
    ds_read_b64_tr_b16 a[6:7], v193 offset:58368
    v_lshlrev_b32 v252, 7, v231
    v_mfma_f32_32x32x16_bf16 v[48:63], a[20:23], a[44:47], v[48:63]
    ds_read_b64_tr_b16 a[8:9], v194 offset:57344
    ds_read_b64_tr_b16 a[10:11], v194 offset:58368
    v_lshl_add_u32 v241, v232, 2, v234
    v_mfma_f32_32x32x16_bf16 v[64:79], a[24:27], a[40:43], v[64:79]
    s_add_u32 m0, s59, 5120
    s_add_u32 s43, s44, 40960
    buffer_load_dwordx4 v137, s[4:7], s43 offen lds
    ds_read_b64_tr_b16 a[12:13], v195 offset:57344
    ds_read_b64_tr_b16 a[14:15], v195 offset:58368
    v_lshl_add_u32 v241, v241, 8, v239
    v_mfma_f32_32x32x16_bf16 v[80:95], a[24:27], a[44:47], v[80:95]
    v_xor_b32 v242, 0, v234
    v_mfma_f32_32x32x16_bf16 v[96:111], a[28:31], a[40:43], v[96:111]
    s_add_u32 m0, s59, 6144
    s_add_u32 s43, s44, 49152
    buffer_load_dwordx4 v136, s[4:7], s43 offen lds
    v_lshl_add_u32 v218, v242, 6, v241
    v_mfma_f32_32x32x16_bf16 v[112:127], a[28:31], a[44:47], v[112:127]
    v_xor_b32 v242, 1, v234
    s_waitcnt lgkmcnt(0)
    v_mfma_f32_32x32x16_bf16 v[0:15], a[0:3], a[32:35], v[0:15]
    s_add_u32 m0, s59, 7168
    s_add_u32 s43, s44, 57344
    buffer_load_dwordx4 v137, s[4:7], s43 offen lds
    s_add_u32 s44, s44, 128
    s_and_b32 s44, s44, 0x3ff
    ds_read_b64_tr_b16 a[16:17], v192 offset:61440
    ds_read_b64_tr_b16 a[18:19], v192 offset:62464
    v_lshl_add_u32 v219, v242, 6, v241
    v_mfma_f32_32x32x16_bf16 v[16:31], a[0:3], a[36:39], v[16:31]
    ds_read_b128 a[40:43], v135 offset:0
    ds_read_b128 a[44:47], v135 offset:4096
    v_xor_b32 v242, 2, v234
    v_mfma_f32_32x32x16_bf16 v[32:47], a[4:7], a[32:35], v[32:47]
    s_lshl_b32 s42, s41, 19
    s_add_u32 m0, s100, 147456
    s_add_u32 s41, s41, 1
    buffer_load_dwordx4 v206, s[8:11], s42 offen offset:0 lds
    ds_read_b64_tr_b16 a[20:21], v193 offset:61440
    ds_read_b64_tr_b16 a[22:23], v193 offset:62464
    v_lshl_add_u32 v220, v242, 6, v241
    v_mfma_f32_32x32x16_bf16 v[48:63], a[4:7], a[36:39], v[48:63]
    ds_read_b64_tr_b16 a[24:25], v194 offset:61440
    ds_read_b64_tr_b16 a[26:27], v194 offset:62464
    v_xor_b32 v242, 3, v234
    v_mfma_f32_32x32x16_bf16 v[64:79], a[8:11], a[32:35], v[64:79]
    s_add_u32 m0, s100, 147456
    s_add_u32 s42, s42, 31744
    buffer_load_dwordx4 v206, s[8:11], s42 offen offset:1024 lds
    ds_read_b64_tr_b16 a[28:29], v195 offset:61440
    ds_read_b64_tr_b16 a[30:31], v195 offset:62464
    v_lshl_add_u32 v221, v242, 6, v241
    v_mfma_f32_32x32x16_bf16 v[80:95], a[8:11], a[36:39], v[80:95]
    v_lshrrev_b32 v244, 1, v234
    v_mfma_f32_32x32x16_bf16 v[96:111], a[12:15], a[32:35], v[96:111]
    s_add_u32 m0, s100, 147456
    s_add_u32 s42, s42, 31744
    buffer_load_dwordx4 v206, s[8:11], s42 offen offset:2048 lds
    v_lshl_add_u32 v241, v240, 7, v239
    v_mfma_f32_32x32x16_bf16 v[112:127], a[12:15], a[36:39], v[112:127]
    s_waitcnt vmcnt(3) lgkmcnt(0)
    s_barrier
    s_cmp_lg_u32 s36, 0
    s_cbranch_scc1 FS_X
    s_waitcnt vmcnt(28)
    v_readfirstlane_b32 s62, v255
    s_mov_b32 s55, 0
    s_cmp_lg_u32 s62, 0
    s_cbranch_scc1 EP_OK
EP_P:
    s_sleep 2
    buffer_load_dword v255, v174, s[72:75], 0 offen sc1
    s_add_u32 s55, s55, 1
    s_waitcnt vmcnt(0)
    v_readfirstlane_b32 s62, v255
    s_cmp_gt_u32 s55, 0x40000
    s_cbranch_scc1 EP_OK
    s_cmp_eq_u32 s62, 0
    s_cbranch_scc1 EP_P
EP_OK:
    s_cmp_lg_u32 s36, 0
    s_cbranch_scc1 FS_X
    v_mov_b32 v172, s62
    v_mov_b32 v173, 0
    s_mov_b64 exec, 1
    buffer_store_dword v172, v173, s[68:71], s63 offen offset:0 sc1
    s_mov_b64 exec, -1
FS_X:
    buffer_load_dword v253, v182, s[4:7], 0 offen
    s_waitcnt lgkmcnt(0)
    v_mfma_f32_32x32x16_bf16 v[0:15], a[16:19], a[40:43], v[0:15]
    s_add_u32 m0, s100, 147456
    s_add_u32 s42, s42, 31744
    buffer_load_dwordx4 v206, s[8:11], s42 offen offset:3072 lds
    s_and_b32 s41, s41, 7
    ds_read_b64_tr_b16 a[0:1], v196 offset:0
    ds_read_b64_tr_b16 a[2:3], v196 offset:1024
    v_xor_b32 v242, 0, v244
    v_mfma_f32_32x32x16_bf16 v[16:31], a[16:19], a[44:47], v[16:31]
    ds_read_b128 a[32:35], v128 offset:0
    ds_read_b128 a[36:39], v128 offset:4096
    v_lshl_add_u32 v200, v242, 6, v241
    v_mfma_f32_32x32x16_bf16 v[32:47], a[20:23], a[40:43], v[32:47]
    s_add_u32 m0, s59, 32768
    s_add_u32 s43, s44, 0
    buffer_load_dwordx4 v136, s[4:7], s43 offen lds
    ds_read_b64_tr_b16 a[4:5], v197 offset:0
    ds_read_b64_tr_b16 a[6:7], v197 offset:1024
    v_add_u32 v202, 0x10000, v200
    v_mfma_f32_32x32x16_bf16 v[48:63], a[20:23], a[44:47], v[48:63]
    ds_read_b64_tr_b16 a[8:9], v198 offset:0
    ds_read_b64_tr_b16 a[10:11], v198 offset:1024
    v_add_u32 v204, 0x20000, v200
    v_mfma_f32_32x32x16_bf16 v[64:79], a[24:27], a[40:43], v[64:79]
    s_add_u32 m0, s59, 33792
    s_add_u32 s43, s44, 8192
    buffer_load_dwordx4 v137, s[4:7], s43 offen lds
    ds_read_b64_tr_b16 a[12:13], v199 offset:0
    ds_read_b64_tr_b16 a[14:15], v199 offset:1024
    v_xor_b32 v242, 1, v244
    v_mfma_f32_32x32x16_bf16 v[80:95], a[24:27], a[44:47], v[80:95]
    v_lshl_add_u32 v201, v242, 6, v241
    v_mfma_f32_32x32x16_bf16 v[96:111], a[28:31], a[40:43], v[96:111]
    s_add_u32 m0, s59, 34816
    s_add_u32 s43, s44, 16384
    buffer_load_dwordx4 v136, s[4:7], s43 offen lds
    v_add_u32 v203, 0x10000, v201
    v_mfma_f32_32x32x16_bf16 v[112:127], a[28:31], a[44:47], v[112:127]
    v_add_u32 v205, 0x20000, v201
    s_waitcnt lgkmcnt(0)
    v_mfma_f32_32x32x16_bf16 v[0:15], a[0:3], a[32:35], v[0:15]
    s_add_u32 m0, s59, 35840
    s_add_u32 s43, s44, 24576
    buffer_load_dwordx4 v137, s[4:7], s43 offen lds
    ds_read_b64_tr_b16 a[16:17], v196 offset:4096
    ds_read_b64_tr_b16 a[18:19], v196 offset:5120
    v_accvgpr_write_b32 a66, 0
    v_accvgpr_write_b32 a67, 0
    v_and_b32 v242, 31, v231
    v_mfma_f32_32x32x16_bf16 v[16:31], a[0:3], a[36:39], v[16:31]
    ds_read_b128 a[40:43], v129 offset:0
    ds_read_b128 a[44:47], v129 offset:4096
    v_accvgpr_write_b32 a70, 0
    v_accvgpr_write_b32 a71, 0
    v_lshlrev_b32 v242, 8, v242
    v_mfma_f32_32x32x16_bf16 v[32:47], a[4:7], a[32:35], v[32:47]
    s_add_u32 m0, s59, 36864
    s_add_u32 s43, s44, 32768
    buffer_load_dwordx4 v136, s[4:7], s43 offen lds
    ds_read_b64_tr_b16 a[20:21], v197 offset:4096
    ds_read_b64_tr_b16 a[22:23], v197 offset:5120
    v_accvgpr_write_b32 a74, 0
    v_accvgpr_write_b32 a75, 0
    v_add_u32 v244, 0, v232
    v_mfma_f32_32x32x16_bf16 v[48:63], a[4:7], a[36:39], v[48:63]
    ds_read_b64_tr_b16 a[24:25], v198 offset:4096
    ds_read_b64_tr_b16 a[26:27], v198 offset:5120
    v_accvgpr_write_b32 a78, 0
    v_accvgpr_write_b32 a79, 0
    v_xor_b32 v244, v244, v235
    v_mfma_f32_32x32x16_bf16 v[64:79], a[8:11], a[32:35], v[64:79]
    s_add_u32 m0, s59, 37888
    s_add_u32 s43, s44, 40960
    buffer_load_dwordx4 v137, s[4:7], s43 offen lds
    ds_read_b64_tr_b16 a[28:29], v199 offset:4096
    ds_read_b64_tr_b16 a[30:31], v199 offset:5120
    v_mov_b32 v164, 0
    v_mov_b32 v165, 0
    v_lshl_add_u32 v210, v244, 4, v242
    v_mfma_f32_32x32x16_bf16 v[80:95], a[8:11], a[36:39], v[80:95]
    v_mov_b32 v166, 0
    v_mov_b32 v167, 0
    v_mfma_f32_32x32x16_bf16 v[96:111], a[12:15], a[32:35], v[96:111]
    s_add_u32 m0, s59, 38912
    s_add_u32 s43, s44, 49152
    buffer_load_dwordx4 v136, s[4:7], s43 offen lds
    v_mov_b32 v168, 0
    v_mov_b32 v169, 0
    v_add_u32 v244, 2, v232
    v_mfma_f32_32x32x16_bf16 v[112:127], a[12:15], a[36:39], v[112:127]
    v_mov_b32 v170, 0
    v_mov_b32 v171, 0
    v_xor_b32 v244, v244, v235
    s_waitcnt lgkmcnt(0)
    v_mfma_f32_32x32x16_bf16 v[0:15], a[16:19], a[40:43], v[0:15]
    s_add_u32 m0, s59, 39936
    s_add_u32 s43, s44, 57344
    buffer_load_dwordx4 v137, s[4:7], s43 offen lds
    s_add_u32 s44, s44, 128
    s_and_b32 s44, s44, 0x3ff
    ds_read_b64_tr_b16 a[0:1], v196 offset:8192
    ds_read_b64_tr_b16 a[2:3], v196 offset:9216
    v_lshl_add_u32 v211, v244, 4, v242
    v_mfma_f32_32x32x16_bf16 v[16:31], a[16:19], a[44:47], v[16:31]
    ds_read_b128 a[32:35], v130 offset:0
    ds_read_b128 a[36:39], v130 offset:4096
    v_add_u32 v244, 4, v232
    v_mfma_f32_32x32x16_bf16 v[32:47], a[20:23], a[40:43], v[32:47]
    s_lshl_b32 s42, s41, 19
    s_add_u32 m0, s100, 98304
    s_add_u32 s41, s41, 1
    buffer_load_dwordx4 v206, s[8:11], s42 offen offset:0 lds
    ds_read_b64_tr_b16 a[4:5], v197 offset:8192
    ds_read_b64_tr_b16 a[6:7], v197 offset:9216
    v_xor_b32 v244, v244, v235
    v_mfma_f32_32x32x16_bf16 v[48:63], a[20:23], a[44:47], v[48:63]
    ds_read_b64_tr_b16 a[8:9], v198 offset:8192
    ds_read_b64_tr_b16 a[10:11], v198 offset:9216
    v_lshl_add_u32 v212, v244, 4, v242
    v_mfma_f32_32x32x16_bf16 v[64:79], a[24:27], a[40:43], v[64:79]
    s_add_u32 m0, s100, 98304
    s_add_u32 s42, s42, 31744
    buffer_load_dwordx4 v206, s[8:11], s42 offen offset:1024 lds
    ds_read_b64_tr_b16 a[12:13], v199 offset:8192
    ds_read_b64_tr_b16 a[14:15], v199 offset:9216
    v_add_u32 v244, 6, v232
    v_mfma_f32_32x32x16_bf16 v[80:95], a[24:27], a[44:47], v[80:95]
    v_xor_b32 v244, v244, v235
    v_mfma_f32_32x32x16_bf16 v[96:111], a[28:31], a[40:43], v[96:111]
    s_add_u32 m0, s100, 98304
    s_add_u32 s42, s42, 31744
    buffer_load_dwordx4 v206, s[8:11], s42 offen offset:2048 lds
    v_lshl_add_u32 v213, v244, 4, v242
    v_mfma_f32_32x32x16_bf16 v[112:127], a[28:31], a[44:47], v[112:127]
    v_add_u32 v244, 8, v232
    s_waitcnt lgkmcnt(0)
    v_mfma_f32_32x32x16_bf16 v[0:15], a[0:3], a[32:35], v[0:15]
    s_add_u32 m0, s100, 98304
    s_add_u32 s42, s42, 31744
    buffer_load_dwordx4 v206, s[8:11], s42 offen offset:3072 lds
    s_and_b32 s41, s41, 7
    ds_read_b64_tr_b16 a[16:17], v196 offset:12288
    ds_read_b64_tr_b16 a[18:19], v196 offset:13312
    v_xor_b32 v244, v244, v235
    v_mfma_f32_32x32x16_bf16 v[16:31], a[0:3], a[36:39], v[16:31]
    ds_read_b128 a[40:43], v131 offset:0
    ds_read_b128 a[44:47], v131 offset:4096
    v_lshl_add_u32 v214, v244, 4, v242
    v_mfma_f32_32x32x16_bf16 v[32:47], a[4:7], a[32:35], v[32:47]
    s_add_u32 m0, s59, 65536
    s_add_u32 s43, s44, 0
    buffer_load_dwordx4 v136, s[4:7], s43 offen lds
    ds_read_b64_tr_b16 a[20:21], v197 offset:12288
    ds_read_b64_tr_b16 a[22:23], v197 offset:13312
    v_add_u32 v244, 10, v232
    v_mfma_f32_32x32x16_bf16 v[48:63], a[4:7], a[36:39], v[48:63]
    ds_read_b64_tr_b16 a[24:25], v198 offset:12288
    ds_read_b64_tr_b16 a[26:27], v198 offset:13312
    v_xor_b32 v244, v244, v235
    v_mfma_f32_32x32x16_bf16 v[64:79], a[8:11], a[32:35], v[64:79]
    s_add_u32 m0, s59, 66560
    s_add_u32 s43, s44, 8192
    buffer_load_dwordx4 v137, s[4:7], s43 offen lds
    ds_read_b64_tr_b16 a[28:29], v199 offset:12288
    ds_read_b64_tr_b16 a[30:31], v199 offset:13312
    v_mfma_f32_32x32x16_bf16 v[80:95], a[8:11], a[36:39], v[80:95]
    v_lshl_add_u32 v215, v244, 4, v242
    v_mfma_f32_32x32x16_bf16 v[96:111], a[12:15], a[32:35], v[96:111]
    s_add_u32 m0, s59, 67584
    s_add_u32 s43, s44, 16384
    buffer_load_dwordx4 v136, s[4:7], s43 offen lds
    v_add_u32 v244, 12, v232
    v_mfma_f32_32x32x16_bf16 v[112:127], a[12:15], a[36:39], v[112:127]
    v_xor_b32 v244, v244, v235
    s_waitcnt vmcnt(7) lgkmcnt(0)
    s_barrier
    s_waitcnt lgkmcnt(0)
    v_mfma_f32_32x32x16_bf16 v[0:15], a[16:19], a[40:43], v[0:15]
    s_add_u32 m0, s59, 68608
    s_add_u32 s43, s44, 24576
    buffer_load_dwordx4 v137, s[4:7], s43 offen lds
    ds_read_b64_tr_b16 a[0:1], v196 offset:16384
    ds_read_b64_tr_b16 a[2:3], v196 offset:17408
    v_lshl_add_u32 v216, v244, 4, v242
    v_mfma_f32_32x32x16_bf16 v[16:31], a[16:19], a[44:47], v[16:31]
    ds_read_b128 a[32:35], v128 offset:32768
    ds_read_b128 a[36:39], v128 offset:36864
    v_add_u32 v244, 14, v232
    v_mfma_f32_32x32x16_bf16 v[32:47], a[20:23], a[40:43], v[32:47]
    s_add_u32 m0, s59, 69632
    s_add_u32 s43, s44, 32768
    buffer_load_dwordx4 v136, s[4:7], s43 offen lds
    ds_read_b64_tr_b16 a[4:5], v197 offset:16384
    ds_read_b64_tr_b16 a[6:7], v197 offset:17408
    v_xor_b32 v244, v244, v235
    v_mfma_f32_32x32x16_bf16 v[48:63], a[20:23], a[44:47], v[48:63]
    ds_read_b64_tr_b16 a[8:9], v198 offset:16384
    ds_read_b64_tr_b16 a[10:11], v198 offset:17408
    v_lshl_add_u32 v217, v244, 4, v242
    v_mfma_f32_32x32x16_bf16 v[64:79], a[24:27], a[40:43], v[64:79]
    s_add_u32 m0, s59, 70656
    s_add_u32 s43, s44, 40960
    buffer_load_dwordx4 v137, s[4:7], s43 offen lds
    ds_read_b64_tr_b16 a[12:13], v199 offset:16384
    ds_read_b64_tr_b16 a[14:15], v199 offset:17408
    v_mfma_f32_32x32x16_bf16 v[80:95], a[24:27], a[44:47], v[80:95]
    v_mfma_f32_32x32x16_bf16 v[96:111], a[28:31], a[40:43], v[96:111]
    s_add_u32 m0, s59, 71680
    s_add_u32 s43, s44, 49152
    buffer_load_dwordx4 v136, s[4:7], s43 offen lds
    v_mfma_f32_32x32x16_bf16 v[112:127], a[28:31], a[44:47], v[112:127]
    s_waitcnt lgkmcnt(0)
    v_mfma_f32_32x32x16_bf16 v[0:15], a[0:3], a[32:35], v[0:15]
    s_add_u32 m0, s59, 72704
    s_add_u32 s43, s44, 57344
    buffer_load_dwordx4 v137, s[4:7], s43 offen lds
    s_add_u32 s44, s44, 128
    s_and_b32 s44, s44, 0x3ff
    ds_read_b64_tr_b16 a[16:17], v196 offset:20480
    ds_read_b64_tr_b16 a[18:19], v196 offset:21504
    v_mbcnt_lo_u32_b32 v172, -1, 0
    v_mfma_f32_32x32x16_bf16 v[16:31], a[0:3], a[36:39], v[16:31]
    ds_read_b128 a[40:43], v129 offset:32768
    ds_read_b128 a[44:47], v129 offset:36864
    v_mbcnt_hi_u32_b32 v172, -1, v172
    v_add_u32 v184, s54, v254
    v_mfma_f32_32x32x16_bf16 v[32:47], a[4:7], a[32:35], v[32:47]
    s_lshl_b32 s42, s41, 19
    s_add_u32 m0, s100, 114688
    s_add_u32 s41, s41, 1
    buffer_load_dwordx4 v206, s[8:11], s42 offen offset:0 lds
    ds_read_b64_tr_b16 a[20:21], v197 offset:20480
    ds_read_b64_tr_b16 a[22:23], v197 offset:21504
    v_and_b32 v173, 7, v172
    v_mfma_f32_32x32x16_bf16 v[48:63], a[4:7], a[36:39], v[48:63]
    ds_read_b64_tr_b16 a[24:25], v198 offset:20480
    ds_read_b64_tr_b16 a[26:27], v198 offset:21504
    v_lshlrev_b32 v173, 12, v173
    s_and_b32 s55, s2, 31
    s_lshl_b32 s55, s55, 7
    v_mfma_f32_32x32x16_bf16 v[64:79], a[8:11], a[32:35], v[64:79]
    s_add_u32 m0, s100, 114688
    s_add_u32 s42, s42, 31744
    buffer_load_dwordx4 v206, s[8:11], s42 offen offset:1024 lds
    ds_read_b64_tr_b16 a[28:29], v199 offset:20480
    ds_read_b64_tr_b16 a[30:31], v199 offset:21504
    v_add_u32 v173, s55, v173
    v_mfma_f32_32x32x16_bf16 v[80:95], a[8:11], a[36:39], v[80:95]
    s_mov_b32 exec_lo, 0
    v_mov_b32 v184, v173
    v_add_u32 v185, 2048, v185
    s_mov_b32 exec_lo, -1
    v_mfma_f32_32x32x16_bf16 v[96:111], a[12:15], a[32:35], v[96:111]
    s_add_u32 m0, s100, 114688
    s_add_u32 s42, s42, 31744
    buffer_load_dwordx4 v206, s[8:11], s42 offen offset:2048 lds
    v_mfma_f32_32x32x16_bf16 v[112:127], a[12:15], a[36:39], v[112:127]
    v_lshlrev_b32 v172, 3, v172
    v_add_u32 v172, 114688, v172
    s_waitcnt lgkmcnt(0)
    v_mfma_f32_32x32x16_bf16 v[0:15], a[16:19], a[40:43], v[0:15]
    s_add_u32 m0, s100, 114688
    s_add_u32 s42, s42, 31744
    buffer_load_dwordx4 v206, s[8:11], s42 offen offset:3072 lds
    s_and_b32 s41, s41, 7
    ds_read_b64_tr_b16 a[0:1], v196 offset:24576
    ds_read_b64_tr_b16 a[2:3], v196 offset:25600
    v_mfma_f32_32x32x16_bf16 v[16:31], a[16:19], a[44:47], v[16:31]
    ds_read_b128 a[32:35], v130 offset:32768
    ds_read_b128 a[36:39], v130 offset:36864
    v_mfma_f32_32x32x16_bf16 v[32:47], a[20:23], a[40:43], v[32:47]
    s_add_u32 m0, s59, 0
    s_add_u32 s43, s44, 0
    buffer_load_dwordx4 v136, s[4:7], s43 offen lds
    ds_read_b64_tr_b16 a[4:5], v197 offset:24576
    ds_read_b64_tr_b16 a[6:7], v197 offset:25600
    v_mfma_f32_32x32x16_bf16 v[48:63], a[20:23], a[44:47], v[48:63]
    ds_read_b64_tr_b16 a[8:9], v198 offset:24576
    ds_read_b64_tr_b16 a[10:11], v198 offset:25600
    v_mfma_f32_32x32x16_bf16 v[64:79], a[24:27], a[40:43], v[64:79]
    s_add_u32 m0, s59, 1024
    s_add_u32 s43, s44, 8192
    buffer_load_dwordx4 v137, s[4:7], s43 offen lds
    ds_read_b64_tr_b16 a[12:13], v199 offset:24576
    ds_read_b64_tr_b16 a[14:15], v199 offset:25600
    v_mfma_f32_32x32x16_bf16 v[80:95], a[24:27], a[44:47], v[80:95]
    v_mfma_f32_32x32x16_bf16 v[96:111], a[28:31], a[40:43], v[96:111]
    s_add_u32 m0, s59, 2048
    s_add_u32 s43, s44, 16384
    buffer_load_dwordx4 v136, s[4:7], s43 offen lds
    v_mfma_f32_32x32x16_bf16 v[112:127], a[28:31], a[44:47], v[112:127]
    s_waitcnt lgkmcnt(0)
    v_mfma_f32_32x32x16_bf16 v[0:15], a[0:3], a[32:35], v[0:15]
    s_add_u32 m0, s59, 3072
    s_add_u32 s43, s44, 24576
    buffer_load_dwordx4 v137, s[4:7], s43 offen lds
    ds_read_b64_tr_b16 a[16:17], v196 offset:28672
    ds_read_b64_tr_b16 a[18:19], v196 offset:29696
    v_mfma_f32_32x32x16_bf16 v[16:31], a[0:3], a[36:39], v[16:31]
    ds_read_b128 a[40:43], v131 offset:32768
    ds_read_b128 a[44:47], v131 offset:36864
    v_mfma_f32_32x32x16_bf16 v[32:47], a[4:7], a[32:35], v[32:47]
    buffer_load_dword v253, v183, s[4:7], 0 offen
    ds_read_b64_tr_b16 a[20:21], v197 offset:28672
    ds_read_b64_tr_b16 a[22:23], v197 offset:29696
    v_mfma_f32_32x32x16_bf16 v[48:63], a[4:7], a[36:39], v[48:63]
    ds_read_b64_tr_b16 a[24:25], v198 offset:28672
    ds_read_b64_tr_b16 a[26:27], v198 offset:29696
    v_mfma_f32_32x32x16_bf16 v[64:79], a[8:11], a[32:35], v[64:79]
    s_add_u32 m0, s59, 4096
    s_add_u32 s43, s44, 32768
    buffer_load_dwordx4 v136, s[4:7], s43 offen lds
    ds_read_b64_tr_b16 a[28:29], v199 offset:28672
    ds_read_b64_tr_b16 a[30:31], v199 offset:29696
    v_mfma_f32_32x32x16_bf16 v[80:95], a[8:11], a[36:39], v[80:95]
    v_mfma_f32_32x32x16_bf16 v[96:111], a[12:15], a[32:35], v[96:111]
    s_add_u32 m0, s59, 5120
    s_add_u32 s43, s44, 40960
    buffer_load_dwordx4 v137, s[4:7], s43 offen lds
    v_mfma_f32_32x32x16_bf16 v[112:127], a[12:15], a[36:39], v[112:127]
    s_waitcnt vmcnt(11) lgkmcnt(0)
    s_barrier
    s_waitcnt lgkmcnt(0)
    v_mfma_f32_32x32x16_bf16 v[0:15], a[16:19], a[40:43], v[0:15]
    s_add_u32 m0, s59, 6144
    s_add_u32 s43, s44, 49152
    buffer_load_dwordx4 v136, s[4:7], s43 offen lds
    ds_read_b64_tr_b16 a[0:1], v192 offset:32768
    ds_read_b64_tr_b16 a[2:3], v192 offset:33792
    v_mfma_f32_32x32x16_bf16 v[16:31], a[16:19], a[44:47], v[16:31]
    ds_read_b128 a[32:35], v132 offset:0
    ds_read_b128 a[36:39], v132 offset:4096
    v_mfma_f32_32x32x16_bf16 v[32:47], a[20:23], a[40:43], v[32:47]
    s_add_u32 m0, s59, 7168
    s_add_u32 s43, s44, 57344
    buffer_load_dwordx4 v137, s[4:7], s43 offen lds
    s_add_u32 s44, s44, 128
    s_and_b32 s44, s44, 0x3ff
    ds_read_b64_tr_b16 a[4:5], v193 offset:32768
    ds_read_b64_tr_b16 a[6:7], v193 offset:33792
    v_mfma_f32_32x32x16_bf16 v[48:63], a[20:23], a[44:47], v[48:63]
    ds_read_b64_tr_b16 a[8:9], v194 offset:32768
    ds_read_b64_tr_b16 a[10:11], v194 offset:33792
    v_mfma_f32_32x32x16_bf16 v[64:79], a[24:27], a[40:43], v[64:79]
    s_lshl_b32 s42, s41, 19
    s_add_u32 m0, s100, 131072
    s_add_u32 s41, s41, 1
    buffer_load_dwordx4 v206, s[8:11], s42 offen offset:0 lds
    ds_read_b64_tr_b16 a[12:13], v195 offset:32768
    ds_read_b64_tr_b16 a[14:15], v195 offset:33792
    v_mfma_f32_32x32x16_bf16 v[80:95], a[24:27], a[44:47], v[80:95]
    v_mfma_f32_32x32x16_bf16 v[96:111], a[28:31], a[40:43], v[96:111]
    s_add_u32 m0, s100, 131072
    s_add_u32 s42, s42, 31744
    buffer_load_dwordx4 v206, s[8:11], s42 offen offset:1024 lds
    v_mfma_f32_32x32x16_bf16 v[112:127], a[28:31], a[44:47], v[112:127]
    s_waitcnt lgkmcnt(0)
    v_mfma_f32_32x32x16_bf16 v[0:15], a[0:3], a[32:35], v[0:15]
    s_add_u32 m0, s100, 131072
    s_add_u32 s42, s42, 31744
    buffer_load_dwordx4 v206, s[8:11], s42 offen offset:2048 lds
    ds_read_b64_tr_b16 a[16:17], v192 offset:36864
    ds_read_b64_tr_b16 a[18:19], v192 offset:37888
    v_mfma_f32_32x32x16_bf16 v[16:31], a[0:3], a[36:39], v[16:31]
    ds_read_b128 a[40:43], v133 offset:0
    ds_read_b128 a[44:47], v133 offset:4096
    v_mfma_f32_32x32x16_bf16 v[32:47], a[4:7], a[32:35], v[32:47]
    s_add_u32 m0, s100, 131072
    s_add_u32 s42, s42, 31744
    buffer_load_dwordx4 v206, s[8:11], s42 offen offset:3072 lds
    s_and_b32 s41, s41, 7
    ds_read_b64_tr_b16 a[20:21], v193 offset:36864
    ds_read_b64_tr_b16 a[22:23], v193 offset:37888
    v_mfma_f32_32x32x16_bf16 v[48:63], a[4:7], a[36:39], v[48:63]
    ds_read_b64_tr_b16 a[24:25], v194 offset:36864
    ds_read_b64_tr_b16 a[26:27], v194 offset:37888
    v_mfma_f32_32x32x16_bf16 v[64:79], a[8:11], a[32:35], v[64:79]
    s_add_u32 m0, s59, 32768
    s_add_u32 s43, s44, 0
    buffer_load_dwordx4 v136, s[4:7], s43 offen lds
    ds_read_b64_tr_b16 a[28:29], v195 offset:36864
    ds_read_b64_tr_b16 a[30:31], v195 offset:37888
    v_mfma_f32_32x32x16_bf16 v[80:95], a[8:11], a[36:39], v[80:95]
    v_mfma_f32_32x32x16_bf16 v[96:111], a[12:15], a[32:35], v[96:111]
    s_add_u32 m0, s59, 33792
    s_add_u32 s43, s44, 8192
    buffer_load_dwordx4 v137, s[4:7], s43 offen lds
    v_mfma_f32_32x32x16_bf16 v[112:127], a[12:15], a[36:39], v[112:127]
    s_waitcnt lgkmcnt(0)
    v_mfma_f32_32x32x16_bf16 v[0:15], a[16:19], a[40:43], v[0:15]
    s_add_u32 m0, s59, 34816
    s_add_u32 s43, s44, 16384
    buffer_load_dwordx4 v136, s[4:7], s43 offen lds
    ds_read_b64_tr_b16 a[0:1], v192 offset:40960
    ds_read_b64_tr_b16 a[2:3], v192 offset:41984
    v_mfma_f32_32x32x16_bf16 v[16:31], a[16:19], a[44:47], v[16:31]
    ds_read_b128 a[32:35], v134 offset:0
    ds_read_b128 a[36:39], v134 offset:4096
    v_mfma_f32_32x32x16_bf16 v[32:47], a[20:23], a[40:43], v[32:47]
    s_add_u32 m0, s59, 35840
    s_add_u32 s43, s44, 24576
    buffer_load_dwordx4 v137, s[4:7], s43 offen lds
    ds_read_b64_tr_b16 a[4:5], v193 offset:40960
    ds_read_b64_tr_b16 a[6:7], v193 offset:41984
    v_mfma_f32_32x32x16_bf16 v[48:63], a[20:23], a[44:47], v[48:63]
    ds_read_b64_tr_b16 a[8:9], v194 offset:40960
    ds_read_b64_tr_b16 a[10:11], v194 offset:41984
    v_mfma_f32_32x32x16_bf16 v[64:79], a[24:27], a[40:43], v[64:79]
    s_add_u32 m0, s59, 36864
    s_add_u32 s43, s44, 32768
    buffer_load_dwordx4 v136, s[4:7], s43 offen lds
    ds_read_b64_tr_b16 a[12:13], v195 offset:40960
    ds_read_b64_tr_b16 a[14:15], v195 offset:41984
    v_mfma_f32_32x32x16_bf16 v[80:95], a[24:27], a[44:47], v[80:95]
    v_mfma_f32_32x32x16_bf16 v[96:111], a[28:31], a[40:43], v[96:111]
    s_add_u32 m0, s59, 37888
    s_add_u32 s43, s44, 40960
    buffer_load_dwordx4 v137, s[4:7], s43 offen lds
    v_mfma_f32_32x32x16_bf16 v[112:127], a[28:31], a[44:47], v[112:127]
    s_waitcnt lgkmcnt(0)
    v_mfma_f32_32x32x16_bf16 v[0:15], a[0:3], a[32:35], v[0:15]
    ds_read_b64_tr_b16 a[16:17], v192 offset:45056
    ds_read_b64_tr_b16 a[18:19], v192 offset:46080
    v_mfma_f32_32x32x16_bf16 v[16:31], a[0:3], a[36:39], v[16:31]
    s_mov_b32 s54, 0
    buffer_load_dword v255, v184, s[68:71], s54 offen offset:0 sc1
    ds_read_b128 a[40:43], v135 offset:0
    ds_read_b128 a[44:47], v135 offset:4096
    v_mfma_f32_32x32x16_bf16 v[32:47], a[4:7], a[32:35], v[32:47]
    ds_read_b64_tr_b16 a[20:21], v193 offset:45056
    ds_read_b64_tr_b16 a[22:23], v193 offset:46080
    v_mfma_f32_32x32x16_bf16 v[48:63], a[4:7], a[36:39], v[48:63]
    s_add_u32 m0, s59, 38912
    s_add_u32 s43, s44, 49152
    buffer_load_dwordx4 v136, s[4:7], s43 offen lds
    ds_read_b64_tr_b16 a[24:25], v194 offset:45056
    ds_read_b64_tr_b16 a[26:27], v194 offset:46080
    v_mfma_f32_32x32x16_bf16 v[64:79], a[8:11], a[32:35], v[64:79]
    ds_read_b64_tr_b16 a[28:29], v195 offset:45056
    ds_read_b64_tr_b16 a[30:31], v195 offset:46080
    v_mfma_f32_32x32x16_bf16 v[80:95], a[8:11], a[36:39], v[80:95]
    s_add_u32 m0, s59, 39936
    s_add_u32 s43, s44, 57344
    buffer_load_dwordx4 v137, s[4:7], s43 offen lds
    s_add_u32 s44, s44, 128
    s_and_b32 s44, s44, 0x3ff
    v_mfma_f32_32x32x16_bf16 v[96:111], a[12:15], a[32:35], v[96:111]
    v_mfma_f32_32x32x16_bf16 v[112:127], a[12:15], a[36:39], v[112:127]
    s_lshl_b32 s42, s41, 19
    s_add_u32 m0, s100, 147456
    s_add_u32 s41, s41, 1
    buffer_load_dwordx4 v206, s[8:11], s42 offen offset:0 lds
    s_waitcnt vmcnt(14) lgkmcnt(0)
    s_barrier
    s_waitcnt lgkmcnt(0)
    v_mfma_f32_32x32x16_bf16 v[0:15], a[16:19], a[40:43], v[0:15]
    ds_read_b64_tr_b16 a[0:1], v192 offset:49152
    ds_read_b64_tr_b16 a[2:3], v192 offset:50176
    v_mfma_f32_32x32x16_bf16 v[16:31], a[16:19], a[44:47], v[16:31]
    s_add_u32 m0, s100, 147456
    s_add_u32 s42, s42, 31744
    buffer_load_dwordx4 v206, s[8:11], s42 offen offset:1024 lds
    ds_read_b128 a[32:35], v128 offset:0
    ds_read_b128 a[36:39], v128 offset:4096
    v_mfma_f32_32x32x16_bf16 v[32:47], a[20:23], a[40:43], v[32:47]
    ds_read_b64_tr_b16 a[4:5], v193 offset:49152
    ds_read_b64_tr_b16 a[6:7], v193 offset:50176
    v_mfma_f32_32x32x16_bf16 v[48:63], a[20:23], a[44:47], v[48:63]
    s_add_u32 m0, s100, 147456
    s_add_u32 s42, s42, 31744
    buffer_load_dwordx4 v206, s[8:11], s42 offen offset:2048 lds
    ds_read_b64_tr_b16 a[8:9], v194 offset:49152
    ds_read_b64_tr_b16 a[10:11], v194 offset:50176
    v_mfma_f32_32x32x16_bf16 v[64:79], a[24:27], a[40:43], v[64:79]
    ds_read_b64_tr_b16 a[12:13], v195 offset:49152
    ds_read_b64_tr_b16 a[14:15], v195 offset:50176
    v_mfma_f32_32x32x16_bf16 v[80:95], a[24:27], a[44:47], v[80:95]
    s_add_u32 m0, s100, 147456
    s_add_u32 s42, s42, 31744
    buffer_load_dwordx4 v206, s[8:11], s42 offen offset:3072 lds
    s_and_b32 s41, s41, 7
    v_mfma_f32_32x32x16_bf16 v[96:111], a[28:31], a[40:43], v[96:111]
    v_mfma_f32_32x32x16_bf16 v[112:127], a[28:31], a[44:47], v[112:127]
    s_add_u32 m0, s59, 65536
    s_add_u32 s43, s44, 0
    buffer_load_dwordx4 v136, s[4:7], s43 offen lds
    s_waitcnt lgkmcnt(0)
    v_mfma_f32_32x32x16_bf16 v[0:15], a[0:3], a[32:35], v[0:15]
    ds_read_b64_tr_b16 a[16:17], v192 offset:53248
    ds_read_b64_tr_b16 a[18:19], v192 offset:54272
    v_mfma_f32_32x32x16_bf16 v[16:31], a[0:3], a[36:39], v[16:31]
    s_add_u32 m0, s59, 66560
    s_add_u32 s43, s44, 8192
    buffer_load_dwordx4 v137, s[4:7], s43 offen lds
    ds_read_b128 a[40:43], v129 offset:0
    ds_read_b128 a[44:47], v129 offset:4096
    v_mfma_f32_32x32x16_bf16 v[32:47], a[4:7], a[32:35], v[32:47]
    ds_read_b64_tr_b16 a[20:21], v193 offset:53248
    ds_read_b64_tr_b16 a[22:23], v193 offset:54272
    v_mfma_f32_32x32x16_bf16 v[48:63], a[4:7], a[36:39], v[48:63]
    s_add_u32 m0, s59, 67584
    s_add_u32 s43, s44, 16384
    buffer_load_dwordx4 v136, s[4:7], s43 offen lds
    ds_read_b64_tr_b16 a[24:25], v194 offset:53248
    ds_read_b64_tr_b16 a[26:27], v194 offset:54272
    v_mfma_f32_32x32x16_bf16 v[64:79], a[8:11], a[32:35], v[64:79]
    ds_read_b64_tr_b16 a[28:29], v195 offset:53248
    ds_read_b64_tr_b16 a[30:31], v195 offset:54272
    v_mfma_f32_32x32x16_bf16 v[80:95], a[8:11], a[36:39], v[80:95]
    s_add_u32 m0, s59, 68608
    s_add_u32 s43, s44, 24576
    buffer_load_dwordx4 v137, s[4:7], s43 offen lds
    v_mfma_f32_32x32x16_bf16 v[96:111], a[12:15], a[32:35], v[96:111]
    v_mfma_f32_32x32x16_bf16 v[112:127], a[12:15], a[36:39], v[112:127]
    s_add_u32 m0, s59, 69632
    s_add_u32 s43, s44, 32768
    buffer_load_dwordx4 v136, s[4:7], s43 offen lds
    s_waitcnt lgkmcnt(0)
    v_mfma_f32_32x32x16_bf16 v[0:15], a[16:19], a[40:43], v[0:15]
    ds_read_b64_tr_b16 a[0:1], v192 offset:57344
    ds_read_b64_tr_b16 a[2:3], v192 offset:58368
    v_mfma_f32_32x32x16_bf16 v[16:31], a[16:19], a[44:47], v[16:31]
    s_add_u32 m0, s59, 70656
    s_add_u32 s43, s44, 40960
    buffer_load_dwordx4 v137, s[4:7], s43 offen lds
    ds_read_b128 a[32:35], v130 offset:0
    ds_read_b128 a[36:39], v130 offset:4096
    v_mfma_f32_32x32x16_bf16 v[32:47], a[20:23], a[40:43], v[32:47]
    ds_read_b64_tr_b16 a[4:5], v193 offset:57344
    ds_read_b64_tr_b16 a[6:7], v193 offset:58368
    v_mfma_f32_32x32x16_bf16 v[48:63], a[20:23], a[44:47], v[48:63]
    s_add_u32 m0, s59, 71680
    s_add_u32 s43, s44, 49152
    buffer_load_dwordx4 v136, s[4:7], s43 offen lds
    ds_read_b64_tr_b16 a[8:9], v194 offset:57344
    ds_read_b64_tr_b16 a[10:11], v194 offset:58368
    v_mfma_f32_32x32x16_bf16 v[64:79], a[24:27], a[40:43], v[64:79]
    ds_read_b64_tr_b16 a[12:13], v195 offset:57344
    ds_read_b64_tr_b16 a[14:15], v195 offset:58368
    v_mfma_f32_32x32x16_bf16 v[80:95], a[24:27], a[44:47], v[80:95]
    s_add_u32 m0, s59, 72704
    s_add_u32 s43, s44, 57344
    buffer_load_dwordx4 v137, s[4:7], s43 offen lds
    s_add_u32 s44, s44, 128
    s_and_b32 s44, s44, 0x3ff
    v_mfma_f32_32x32x16_bf16 v[96:111], a[28:31], a[40:43], v[96:111]
    v_mfma_f32_32x32x16_bf16 v[112:127], a[28:31], a[44:47], v[112:127]
    s_add_u32 m0, s39, 98304
    s_nop 0
    buffer_load_dwordx4 v222, s[24:27], s45 offen lds
    s_waitcnt lgkmcnt(0)
    v_mfma_f32_32x32x16_bf16 v[0:15], a[0:3], a[32:35], v[0:15]
    ds_read_b64_tr_b16 a[16:17], v192 offset:61440
    ds_read_b64_tr_b16 a[18:19], v192 offset:62464
    v_mfma_f32_32x32x16_bf16 v[16:31], a[0:3], a[36:39], v[16:31]
    s_add_u32 m0, s39, 98304
    s_nop 0
    buffer_load_dwordx4 v223, s[24:27], s45 offen offset:1024 lds
    s_add_u32 s45, s45, 8192
    s_and_b32 s45, s45, 0x1ffff
    ds_read_b128 a[40:43], v131 offset:0
    ds_read_b128 a[44:47], v131 offset:4096
    v_mfma_f32_32x32x16_bf16 v[32:47], a[4:7], a[32:35], v[32:47]
    ds_read_b64_tr_b16 a[20:21], v193 offset:61440
    ds_read_b64_tr_b16 a[22:23], v193 offset:62464
    v_mfma_f32_32x32x16_bf16 v[48:63], a[4:7], a[36:39], v[48:63]
    s_add_u32 m0, s39, 106496
    s_nop 0
    buffer_load_dwordx4 v222, s[24:27], s45 offen lds
    ds_read_b64_tr_b16 a[24:25], v194 offset:61440
    ds_read_b64_tr_b16 a[26:27], v194 offset:62464
    v_mfma_f32_32x32x16_bf16 v[64:79], a[8:11], a[32:35], v[64:79]
    ds_read_b64_tr_b16 a[28:29], v195 offset:61440
    ds_read_b64_tr_b16 a[30:31], v195 offset:62464
    v_mfma_f32_32x32x16_bf16 v[80:95], a[8:11], a[36:39], v[80:95]
    s_add_u32 m0, s39, 106496
    s_nop 0
    buffer_load_dwordx4 v223, s[24:27], s45 offen offset:1024 lds
    s_add_u32 s45, s45, 8192
    s_and_b32 s45, s45, 0x1ffff
    v_mfma_f32_32x32x16_bf16 v[96:111], a[12:15], a[32:35], v[96:111]
    v_mfma_f32_32x32x16_bf16 v[112:127], a[12:15], a[36:39], v[112:127]
    s_waitcnt vmcnt(16) lgkmcnt(0)
    s_barrier
    s_waitcnt lgkmcnt(0)
    s_waitcnt vmcnt(18)
    s_and_b32 s55, s2, 31
    v_readlane_b32 s62, v255, s55
    s_nop 0
    s_waitcnt vmcnt(18)
    v_cmp_ne_u32 vcc, s62, v255
    s_mov_b32 s55, 0
    s_cbranch_vccz SY1_OK
SY1_P:
    s_sleep 2
    buffer_load_dword v255, v184, s[68:71], s54 offen offset:0 sc1
    s_add_u32 s55, s55, 1
    s_waitcnt vmcnt(0)
    v_cmp_ne_u32 vcc, s62, v255
    s_cmp_gt_u32 s55, 0x40000
    s_cbranch_scc1 SY1_OK
    s_cbranch_vccnz SY1_P
SY1_OK:
    v_mfma_f32_32x32x16_bf16 v[0:15], a[16:19], a[40:43], v[0:15]
    ds_read_b64_tr_b16 a[0:1], v196 offset:0
    ds_read_b64_tr_b16 a[2:3], v196 offset:1024
    v_mfma_f32_32x32x16_bf16 v[16:31], a[16:19], a[44:47], v[16:31]
    buffer_load_dwordx2 v[160:161], v175, s[68:71], s56 offen offset:0 sc1
    ds_read_b128 a[32:35], v128 offset:32768
    ds_read_b128 a[36:39], v128 offset:36864
    v_mfma_f32_32x32x16_bf16 v[32:47], a[20:23], a[40:43], v[32:47]
    ds_read_b64_tr_b16 a[4:5], v197 offset:0
    ds_read_b64_tr_b16 a[6:7], v197 offset:1024
    v_mfma_f32_32x32x16_bf16 v[48:63], a[20:23], a[44:47], v[48:63]
    buffer_load_dwordx2 v[162:163], v175, s[68:71], s56 offen offset:256 sc1
    ds_read_b64_tr_b16 a[8:9], v198 offset:0
    ds_read_b64_tr_b16 a[10:11], v198 offset:1024
    v_mfma_f32_32x32x16_bf16 v[64:79], a[24:27], a[40:43], v[64:79]
    ds_read_b64_tr_b16 a[12:13], v199 offset:0
    ds_read_b64_tr_b16 a[14:15], v199 offset:1024
    v_mfma_f32_32x32x16_bf16 v[80:95], a[24:27], a[44:47], v[80:95]
    s_lshl_b32 s54, s37, 12
    s_lshl_b32 s55, s36, 7
    s_add_u32 s54, s54, s55
    s_add_u32 s54, s54, 196608
    buffer_load_dword v140, v185, s[68:71], s54 offen offset:0 sc1
    v_mfma_f32_32x32x16_bf16 v[96:111], a[28:31], a[40:43], v[96:111]
    v_mfma_f32_32x32x16_bf16 v[112:127], a[28:31], a[44:47], v[112:127]
    buffer_load_dword v141, v185, s[68:71], s54 offen offset:512 sc1
    s_waitcnt lgkmcnt(0)
    v_mfma_f32_32x32x16_bf16 v[0:15], a[0:3], a[32:35], v[0:15]
    ds_read_b64_tr_b16 a[16:17], v196 offset:4096
    ds_read_b64_tr_b16 a[18:19], v196 offset:5120
    v_mfma_f32_32x32x16_bf16 v[16:31], a[0:3], a[36:39], v[16:31]
    buffer_load_dword v142, v185, s[68:71], s54 offen offset:1024 sc1
    ds_read_b128 a[40:43], v129 offset:32768
    ds_read_b128 a[44:47], v129 offset:36864
    v_mfma_f32_32x32x16_bf16 v[32:47], a[4:7], a[32:35], v[32:47]
    ds_read_b64_tr_b16 a[20:21], v197 offset:4096
    ds_read_b64_tr_b16 a[22:23], v197 offset:5120
    v_mfma_f32_32x32x16_bf16 v[48:63], a[4:7], a[36:39], v[48:63]
    buffer_load_dword v143, v185, s[68:71], s54 offen offset:1536 sc1
    ds_read_b64_tr_b16 a[24:25], v198 offset:4096
    ds_read_b64_tr_b16 a[26:27], v198 offset:5120
    v_mfma_f32_32x32x16_bf16 v[64:79], a[8:11], a[32:35], v[64:79]
    ds_read_b64_tr_b16 a[28:29], v199 offset:4096
    ds_read_b64_tr_b16 a[30:31], v199 offset:5120
    v_mfma_f32_32x32x16_bf16 v[80:95], a[8:11], a[36:39], v[80:95]
    s_add_u32 m0, s39, 0
    s_nop 0
    buffer_load_dwordx4 v224, s[28:31], s46 offen lds
    v_mfma_f32_32x32x16_bf16 v[96:111], a[12:15], a[32:35], v[96:111]
    v_mfma_f32_32x32x16_bf16 v[112:127], a[12:15], a[36:39], v[112:127]
    s_add_u32 m0, s39, 0
    s_nop 0
    buffer_load_dwordx4 v224, s[28:31], s46 offen offset:1024 lds
    s_add_u32 s46, s46, 8192
    s_and_b32 s46, s46, 0x1ffff
    s_waitcnt lgkmcnt(0)
    v_mfma_f32_32x32x16_bf16 v[0:15], a[16:19], a[40:43], v[0:15]
    ds_read_b64_tr_b16 a[0:1], v196 offset:8192
    ds_read_b64_tr_b16 a[2:3], v196 offset:9216
    v_mfma_f32_32x32x16_bf16 v[16:31], a[16:19], a[44:47], v[16:31]
    s_add_u32 m0, s39, 8192
    s_nop 0
    buffer_load_dwordx4 v222, s[24:27], s45 offen lds
    ds_read_b128 a[32:35], v130 offset:32768
    ds_read_b128 a[36:39], v130 offset:36864
    v_mfma_f32_32x32x16_bf16 v[32:47], a[20:23], a[40:43], v[32:47]
    ds_read_b64_tr_b16 a[4:5], v197 offset:8192
    ds_read_b64_tr_b16 a[6:7], v197 offset:9216
    v_mfma_f32_32x32x16_bf16 v[48:63], a[20:23], a[44:47], v[48:63]
    s_add_u32 m0, s39, 8192
    s_nop 0
    buffer_load_dwordx4 v223, s[24:27], s45 offen offset:1024 lds
    s_add_u32 s45, s45, 8192
    s_and_b32 s45, s45, 0x1ffff
    ds_read_b64_tr_b16 a[8:9], v198 offset:8192
    ds_read_b64_tr_b16 a[10:11], v198 offset:9216
    v_mfma_f32_32x32x16_bf16 v[64:79], a[24:27], a[40:43], v[64:79]
    ds_read_b64_tr_b16 a[12:13], v199 offset:8192
    ds_read_b64_tr_b16 a[14:15], v199 offset:9216
    v_mfma_f32_32x32x16_bf16 v[80:95], a[24:27], a[44:47], v[80:95]
    s_add_u32 m0, s39, 16384
    s_nop 0
    buffer_load_dwordx4 v224, s[28:31], s46 offen lds
    v_mfma_f32_32x32x16_bf16 v[96:111], a[28:31], a[40:43], v[96:111]
    v_mfma_f32_32x32x16_bf16 v[112:127], a[28:31], a[44:47], v[112:127]
    s_add_u32 m0, s39, 16384
    s_nop 0
    buffer_load_dwordx4 v224, s[28:31], s46 offen offset:1024 lds
    s_add_u32 s46, s46, 8192
    s_and_b32 s46, s46, 0x1ffff
    s_waitcnt lgkmcnt(0)
    v_mfma_f32_32x32x16_bf16 v[0:15], a[0:3], a[32:35], v[0:15]
    ds_read_b64_tr_b16 a[16:17], v196 offset:12288
    ds_read_b64_tr_b16 a[18:19], v196 offset:13312
    v_mfma_f32_32x32x16_bf16 v[16:31], a[0:3], a[36:39], v[16:31]
    s_add_u32 m0, s39, 24576
    s_nop 0
    buffer_load_dwordx4 v222, s[24:27], s45 offen lds
    ds_read_b128 a[40:43], v131 offset:32768
    ds_read_b128 a[44:47], v131 offset:36864
    v_mfma_f32_32x32x16_bf16 v[32:47], a[4:7], a[32:35], v[32:47]
    ds_read_b64_tr_b16 a[20:21], v197 offset:12288
    ds_read_b64_tr_b16 a[22:23], v197 offset:13312
    v_mfma_f32_32x32x16_bf16 v[48:63], a[4:7], a[36:39], v[48:63]
    s_add_u32 m0, s39, 24576
    s_nop 0
    buffer_load_dwordx4 v223, s[24:27], s45 offen offset:1024 lds
    s_add_u32 s45, s45, 8192
    s_and_b32 s45, s45, 0x1ffff
    ds_read_b64_tr_b16 a[24:25], v198 offset:12288
    ds_read_b64_tr_b16 a[26:27], v198 offset:13312
    v_mfma_f32_32x32x16_bf16 v[64:79], a[8:11], a[32:35], v[64:79]
    ds_read_b64_tr_b16 a[28:29], v199 offset:12288
    ds_read_b64_tr_b16 a[30:31], v199 offset:13312
    v_mfma_f32_32x32x16_bf16 v[80:95], a[8:11], a[36:39], v[80:95]
    v_mfma_f32_32x32x16_bf16 v[96:111], a[12:15], a[32:35], v[96:111]
    v_mfma_f32_32x32x16_bf16 v[112:127], a[12:15], a[36:39], v[112:127]
    s_waitcnt vmcnt(18) lgkmcnt(0)
    s_barrier
    s_waitcnt lgkmcnt(0)
    v_mfma_f32_32x32x16_bf16 v[0:15], a[16:19], a[40:43], v[0:15]
    ds_read_b64_tr_b16 a[0:1], v196 offset:16384
    ds_read_b64_tr_b16 a[2:3], v196 offset:17408
    v_mfma_f32_32x32x16_bf16 v[16:31], a[16:19], a[44:47], v[16:31]
    ds_read_b128 a[32:35], v132 offset:0
    ds_read_b128 a[36:39], v132 offset:4096
    v_mfma_f32_32x32x16_bf16 v[32:47], a[20:23], a[40:43], v[32:47]
    ds_read_b64_tr_b16 a[4:5], v197 offset:16384
    ds_read_b64_tr_b16 a[6:7], v197 offset:17408
    v_mfma_f32_32x32x16_bf16 v[48:63], a[20:23], a[44:47], v[48:63]
    ds_read_b64_tr_b16 a[8:9], v198 offset:16384
    ds_read_b64_tr_b16 a[10:11], v198 offset:17408
    v_mfma_f32_32x32x16_bf16 v[64:79], a[24:27], a[40:43], v[64:79]
    ds_read_b64_tr_b16 a[12:13], v199 offset:16384
    ds_read_b64_tr_b16 a[14:15], v199 offset:17408
    v_mfma_f32_32x32x16_bf16 v[80:95], a[24:27], a[44:47], v[80:95]
    v_mfma_f32_32x32x16_bf16 v[96:111], a[28:31], a[40:43], v[96:111]
    v_mfma_f32_32x32x16_bf16 v[112:127], a[28:31], a[44:47], v[112:127]
    s_waitcnt lgkmcnt(0)
    s_waitcnt vmcnt(12)
    s_mov_b32 exec_hi, 0
    v_mov_b32 v164, v160
    v_and_b32 v165, 0xffff, v160
    v_mov_b32 v168, v162
    v_and_b32 v169, 0xffff, v162
    s_mov_b32 exec_hi, -1
    v_mov_b32 v176, v161
    v_mov_b32 v177, v161
    v_mov_b32 v178, v163
    v_mov_b32 v179, v163
    v_mfma_f32_32x32x16_bf16 v[0:15], a[0:3], a[32:35], v[0:15]
    ds_read_b64_tr_b16 a[16:17], v196 offset:20480
    ds_read_b64_tr_b16 a[18:19], v196 offset:21504
    v_mfma_f32_32x32x16_bf16 v[16:31], a[0:3], a[36:39], v[16:31]
    ds_read_b128 a[40:43], v133 offset:0
    ds_read_b128 a[44:47], v133 offset:4096
    v_mfma_f32_32x32x16_bf16 v[32:47], a[4:7], a[32:35], v[32:47]
    ds_read_b64_tr_b16 a[20:21], v197 offset:20480
    ds_read_b64_tr_b16 a[22:23], v197 offset:21504
    v_mfma_f32_32x32x16_bf16 v[48:63], a[4:7], a[36:39], v[48:63]
    ds_read_b64_tr_b16 a[24:25], v198 offset:20480
    ds_read_b64_tr_b16 a[26:27], v198 offset:21504
    v_mfma_f32_32x32x16_bf16 v[64:79], a[8:11], a[32:35], v[64:79]
    ds_read_b64_tr_b16 a[28:29], v199 offset:20480
    ds_read_b64_tr_b16 a[30:31], v199 offset:21504
    v_mfma_f32_32x32x16_bf16 v[80:95], a[8:11], a[36:39], v[80:95]
    v_mfma_f32_32x32x16_bf16 v[96:111], a[12:15], a[32:35], v[96:111]
    v_mfma_f32_32x32x16_bf16 v[112:127], a[12:15], a[36:39], v[112:127]
    s_waitcnt lgkmcnt(0)
    s_waitcnt vmcnt(8)
    v_mfma_f32_32x32x16_bf16 v[0:15], a[16:19], a[40:43], v[0:15]
    ds_read_b64_tr_b16 a[0:1], v196 offset:24576
    ds_read_b64_tr_b16 a[2:3], v196 offset:25600
    v_add_f32 v156, v140, v141
    v_mfma_f32_32x32x16_bf16 v[16:31], a[16:19], a[44:47], v[16:31]
    ds_read_b128 a[32:35], v134 offset:0
    ds_read_b128 a[36:39], v134 offset:4096
    v_add_f32 v157, v142, v143
    v_add_f32 v156, v156, v157
    v_mfma_f32_32x32x16_bf16 v[32:47], a[20:23], a[40:43], v[32:47]
    ds_read_b64_tr_b16 a[4:5], v197 offset:24576
    ds_read_b64_tr_b16 a[6:7], v197 offset:25600
    v_mov_b32 v157, v156
    v_mfma_f32_32x32x16_bf16 v[48:63], a[20:23], a[44:47], v[48:63]
    ds_read_b64_tr_b16 a[8:9], v198 offset:24576
    ds_read_b64_tr_b16 a[10:11], v198 offset:25600
    s_nop 1
    v_mfma_f32_32x32x16_bf16 v[64:79], a[24:27], a[40:43], v[64:79]
    ds_read_b64_tr_b16 a[12:13], v199 offset:24576
    ds_read_b64_tr_b16 a[14:15], v199 offset:25600
    v_permlane32_swap_b32 v156, v157
    v_mfma_f32_32x32x16_bf16 v[80:95], a[24:27], a[44:47], v[80:95]
    v_add_f32 v156, v156, v157
    v_cvt_pk_bf16_f32 v157, v156, v156
    v_mfma_f32_32x32x16_bf16 v[96:111], a[28:31], a[40:43], v[96:111]
    v_and_b32 v157, 0xffff0000, v157
    v_mfma_f32_32x32x16_bf16 v[112:127], a[28:31], a[44:47], v[112:127]
    v_sub_f32 v157, v156, v157
    v_cvt_pk_bf16_f32 v158, v156, v157
    s_waitcnt lgkmcnt(0)
    v_mfma_f32_32x32x16_bf16 v[0:15], a[0:3], a[32:35], v[0:15]
    v_and_b32 v156, 0xffff0000, v158
    ds_read_b64_tr_b16 a[16:17], v196 offset:28672
    ds_read_b64_tr_b16 a[18:19], v196 offset:29696
    v_mfma_f32_32x32x16_bf16 v[16:31], a[0:3], a[36:39], v[16:31]
    v_sub_f32 v157, v157, v156
    v_cvt_pk_bf16_f32 v159, v157, 0
    ds_read_b128 a[40:43], v135 offset:0
    ds_read_b128 a[44:47], v135 offset:4096
    v_mfma_f32_32x32x16_bf16 v[32:47], a[4:7], a[32:35], v[32:47]
    s_lshl_b32 s55, s36, 9
    v_add_u32 v173, s55, v172
    ds_read_b64_tr_b16 a[20:21], v197 offset:28672
    ds_read_b64_tr_b16 a[22:23], v197 offset:29696
    v_mfma_f32_32x32x16_bf16 v[48:63], a[4:7], a[36:39], v[48:63]
    ds_write_b64 v173, v[158:159]
    ds_read_b64_tr_b16 a[24:25], v198 offset:28672
    ds_read_b64_tr_b16 a[26:27], v198 offset:29696
    v_mfma_f32_32x32x16_bf16 v[64:79], a[8:11], a[32:35], v[64:79]
    ds_read_b64_tr_b16 a[28:29], v199 offset:28672
    ds_read_b64_tr_b16 a[30:31], v199 offset:29696
    v_mfma_f32_32x32x16_bf16 v[80:95], a[8:11], a[36:39], v[80:95]
    v_mfma_f32_32x32x16_bf16 v[96:111], a[12:15], a[32:35], v[96:111]
    v_mfma_f32_32x32x16_bf16 v[112:127], a[12:15], a[36:39], v[112:127]
    s_waitcnt vmcnt(14) lgkmcnt(4)
    s_barrier
    s_waitcnt lgkmcnt(0)
    v_mfma_f32_32x32x16_bf16 v[0:15], a[16:19], a[40:43], v[0:15]
    ds_read_b64 a[64:65], v172 offset:0
    ds_read_b64 a[68:69], v172 offset:512
    ds_read_b64 a[72:73], v172 offset:1024
    v_mfma_f32_32x32x16_bf16 v[16:31], a[16:19], a[44:47], v[16:31]
    ds_read_b64 a[76:77], v172 offset:1536
    v_add_u32 v230, 0x10000, v210
    ds_read_b128 a[192:195], v230 offset:32768
    v_mfma_f32_32x32x16_bf16 v[32:47], a[20:23], a[40:43], v[32:47]
    buffer_load_dword v253, v227, s[12:15], 0 offen
    v_add_u32 v231, 0x10000, v211
    ds_read_b128 a[196:199], v231 offset:32768
    v_add_u32 v232, 0x10000, v212
    ds_read_b128 a[200:203], v232 offset:32768
    v_mfma_f32_32x32x16_bf16 v[48:63], a[20:23], a[44:47], v[48:63]
    v_add_u32 v233, 0x10000, v213
    ds_read_b128 a[204:207], v233 offset:32768
    v_add_u32 v230, 0x10000, v214
    ds_read_b128 a[208:211], v230 offset:32768
    v_mfma_f32_32x32x16_bf16 v[64:79], a[24:27], a[40:43], v[64:79]
    v_add_u32 v231, 0x10000, v215
    ds_read_b128 a[212:215], v231 offset:32768
    v_mfma_f32_32x32x16_bf16 v[80:95], a[24:27], a[44:47], v[80:95]
    v_add_u32 v232, 0x10000, v216
    ds_read_b128 a[216:219], v232 offset:32768
    v_add_u32 v233, 0x10000, v217
    ds_read_b128 a[220:223], v233 offset:32768
    v_mfma_f32_32x32x16_bf16 v[96:111], a[28:31], a[40:43], v[96:111]
    v_mfma_f32_32x32x16_bf16 v[112:127], a[28:31], a[44:47], v[112:127]
    s_waitcnt lgkmcnt(8)
    v_mfma_f32_32x32x16_bf16 v[0:15], a[64:67], v[164:167], v[0:15]
    v_mfma_f32_32x32x16_bf16 v[32:47], a[68:71], v[164:167], v[32:47]
    v_mfma_f32_32x32x16_bf16 v[64:79], a[72:75], v[164:167], v[64:79]
    buffer_load_dword v253, v227, s[16:19], 0 offen
    v_mfma_f32_32x32x16_bf16 v[96:111], a[76:79], v[164:167], v[96:111]
    v_mfma_f32_32x32x16_bf16 v[16:31], a[64:67], v[168:171], v[16:31]
    v_mfma_f32_32x32x16_bf16 v[48:63], a[68:71], v[168:171], v[48:63]
    v_mfma_f32_32x32x16_bf16 v[80:95], a[72:75], v[168:171], v[80:95]
    v_mfma_f32_32x32x16_bf16 v[112:127], a[76:79], v[168:171], v[112:127]
    s_and_b32 s41, s37, 3
    s_lshl_b32 s41, s41, 1
    s_add_u32 s41, s41, s38
    s_and_b32 s41, s41, 7
    s_lshl_b32 s44, s41, 12
    s_mov_b32 s8, s60
    s_mov_b32 s9, s61
    s_mov_b32 s10, 4194304
    s_mov_b32 s11, 0x00020000
    s_nop 7
    v_pk_mul_f32 v[0:1], v[0:1], v[176:177]
    v_pk_mul_f32 v[2:3], v[2:3], v[176:177]
    v_cvt_pk_bf16_f32 v0, v0, v1
    v_pk_mul_f32 v[4:5], v[4:5], v[176:177]
    v_cvt_pk_bf16_f32 v1, v2, v3
    v_pk_mul_f32 v[6:7], v[6:7], v[176:177]
    v_cvt_pk_bf16_f32 v2, v4, v5
    v_pk_mul_f32 v[8:9], v[8:9], v[176:177]
    v_cvt_pk_bf16_f32 v3, v6, v7
    v_pk_mul_f32 v[10:11], v[10:11], v[176:177]
    v_cvt_pk_bf16_f32 v4, v8, v9
    v_pk_mul_f32 v[12:13], v[12:13], v[176:177]
    v_cvt_pk_bf16_f32 v5, v10, v11
    v_pk_mul_f32 v[14:15], v[14:15], v[176:177]
    v_cvt_pk_bf16_f32 v6, v12, v13
    v_pk_mul_f32 v[16:17], v[16:17], v[178:179]
    v_cvt_pk_bf16_f32 v7, v14, v15
    v_pk_mul_f32 v[18:19], v[18:19], v[178:179]
    v_cvt_pk_bf16_f32 v8, v16, v17
    v_pk_mul_f32 v[20:21], v[20:21], v[178:179]
    v_cvt_pk_bf16_f32 v9, v18, v19
    v_pk_mul_f32 v[22:23], v[22:23], v[178:179]
    v_cvt_pk_bf16_f32 v10, v20, v21
    v_pk_mul_f32 v[24:25], v[24:25], v[178:179]
    v_cvt_pk_bf16_f32 v11, v22, v23
    v_pk_mul_f32 v[26:27], v[26:27], v[178:179]
    v_cvt_pk_bf16_f32 v12, v24, v25
    v_pk_mul_f32 v[28:29], v[28:29], v[178:179]
    v_cvt_pk_bf16_f32 v13, v26, v27
    v_pk_mul_f32 v[30:31], v[30:31], v[178:179]
    v_cvt_pk_bf16_f32 v14, v28, v29
    v_pk_mul_f32 v[32:33], v[32:33], v[176:177]
    v_cvt_pk_bf16_f32 v15, v30, v31
    v_pk_mul_f32 v[34:35], v[34:35], v[176:177]
    v_cvt_pk_bf16_f32 v16, v32, v33
    v_pk_mul_f32 v[36:37], v[36:37], v[176:177]
    v_cvt_pk_bf16_f32 v17, v34, v35
    v_pk_mul_f32 v[38:39], v[38:39], v[176:177]
    v_cvt_pk_bf16_f32 v18, v36, v37
    v_pk_mul_f32 v[40:41], v[40:41], v[176:177]
    v_cvt_pk_bf16_f32 v19, v38, v39
    v_pk_mul_f32 v[42:43], v[42:43], v[176:177]
    v_cvt_pk_bf16_f32 v20, v40, v41
    v_pk_mul_f32 v[44:45], v[44:45], v[176:177]
    v_cvt_pk_bf16_f32 v21, v42, v43
    v_pk_mul_f32 v[46:47], v[46:47], v[176:177]
    v_cvt_pk_bf16_f32 v22, v44, v45
    v_pk_mul_f32 v[48:49], v[48:49], v[178:179]
    v_cvt_pk_bf16_f32 v23, v46, v47
    v_pk_mul_f32 v[50:51], v[50:51], v[178:179]
    v_cvt_pk_bf16_f32 v24, v48, v49
    v_pk_mul_f32 v[52:53], v[52:53], v[178:179]
    v_cvt_pk_bf16_f32 v25, v50, v51
    v_pk_mul_f32 v[54:55], v[54:55], v[178:179]
    v_cvt_pk_bf16_f32 v26, v52, v53
    v_pk_mul_f32 v[56:57], v[56:57], v[178:179]
    v_cvt_pk_bf16_f32 v27, v54, v55
    v_pk_mul_f32 v[58:59], v[58:59], v[178:179]
    v_cvt_pk_bf16_f32 v28, v56, v57
    v_pk_mul_f32 v[60:61], v[60:61], v[178:179]
    v_cvt_pk_bf16_f32 v29, v58, v59
    v_pk_mul_f32 v[62:63], v[62:63], v[178:179]
    v_cvt_pk_bf16_f32 v30, v60, v61
    v_pk_mul_f32 v[64:65], v[64:65], v[176:177]
    v_cvt_pk_bf16_f32 v31, v62, v63
    v_pk_mul_f32 v[66:67], v[66:67], v[176:177]
    v_cvt_pk_bf16_f32 v32, v64, v65
    v_pk_mul_f32 v[68:69], v[68:69], v[176:177]
    v_cvt_pk_bf16_f32 v33, v66, v67
    v_pk_mul_f32 v[70:71], v[70:71], v[176:177]
    v_cvt_pk_bf16_f32 v34, v68, v69
    v_pk_mul_f32 v[72:73], v[72:73], v[176:177]
    v_cvt_pk_bf16_f32 v35, v70, v71
    v_pk_mul_f32 v[74:75], v[74:75], v[176:177]
    v_cvt_pk_bf16_f32 v36, v72, v73
    v_pk_mul_f32 v[76:77], v[76:77], v[176:177]
    v_cvt_pk_bf16_f32 v37, v74, v75
    v_pk_mul_f32 v[78:79], v[78:79], v[176:177]
    v_cvt_pk_bf16_f32 v38, v76, v77
    v_pk_mul_f32 v[80:81], v[80:81], v[178:179]
    v_cvt_pk_bf16_f32 v39, v78, v79
    v_pk_mul_f32 v[82:83], v[82:83], v[178:179]
    v_cvt_pk_bf16_f32 v40, v80, v81
    v_pk_mul_f32 v[84:85], v[84:85], v[178:179]
    v_cvt_pk_bf16_f32 v41, v82, v83
    v_pk_mul_f32 v[86:87], v[86:87], v[178:179]
    v_cvt_pk_bf16_f32 v42, v84, v85
    v_pk_mul_f32 v[88:89], v[88:89], v[178:179]
    v_cvt_pk_bf16_f32 v43, v86, v87
    v_pk_mul_f32 v[90:91], v[90:91], v[178:179]
    v_cvt_pk_bf16_f32 v44, v88, v89
    v_pk_mul_f32 v[92:93], v[92:93], v[178:179]
    v_cvt_pk_bf16_f32 v45, v90, v91
    v_pk_mul_f32 v[94:95], v[94:95], v[178:179]
    v_cvt_pk_bf16_f32 v46, v92, v93
    v_pk_mul_f32 v[96:97], v[96:97], v[176:177]
    v_cvt_pk_bf16_f32 v47, v94, v95
    v_pk_mul_f32 v[98:99], v[98:99], v[176:177]
    v_cvt_pk_bf16_f32 v48, v96, v97
    v_pk_mul_f32 v[100:101], v[100:101], v[176:177]
    v_cvt_pk_bf16_f32 v49, v98, v99
    v_pk_mul_f32 v[102:103], v[102:103], v[176:177]
    v_cvt_pk_bf16_f32 v50, v100, v101
    v_pk_mul_f32 v[104:105], v[104:105], v[176:177]
    v_cvt_pk_bf16_f32 v51, v102, v103
    v_pk_mul_f32 v[106:107], v[106:107], v[176:177]
    v_cvt_pk_bf16_f32 v52, v104, v105
    v_pk_mul_f32 v[108:109], v[108:109], v[176:177]
    v_cvt_pk_bf16_f32 v53, v106, v107
    v_pk_mul_f32 v[110:111], v[110:111], v[176:177]
    v_cvt_pk_bf16_f32 v54, v108, v109
    v_pk_mul_f32 v[112:113], v[112:113], v[178:179]
    v_cvt_pk_bf16_f32 v55, v110, v111
    v_pk_mul_f32 v[114:115], v[114:115], v[178:179]
    v_cvt_pk_bf16_f32 v56, v112, v113
    v_pk_mul_f32 v[116:117], v[116:117], v[178:179]
    v_cvt_pk_bf16_f32 v57, v114, v115
    v_pk_mul_f32 v[118:119], v[118:119], v[178:179]
    v_cvt_pk_bf16_f32 v58, v116, v117
    v_pk_mul_f32 v[120:121], v[120:121], v[178:179]
    v_cvt_pk_bf16_f32 v59, v118, v119
    v_pk_mul_f32 v[122:123], v[122:123], v[178:179]
    v_cvt_pk_bf16_f32 v60, v120, v121
    v_pk_mul_f32 v[124:125], v[124:125], v[178:179]
    v_cvt_pk_bf16_f32 v61, v122, v123
    v_pk_mul_f32 v[126:127], v[126:127], v[178:179]
    v_cvt_pk_bf16_f32 v62, v124, v125
    v_cvt_pk_bf16_f32 v63, v126, v127
K2_ATT:
    s_waitcnt lgkmcnt(0)
    v_mfma_f32_32x32x16_bf16 v[64:79], a[192:195], v[0:3], 0
    v_accvgpr_write_b32 a0, 0
    v_accvgpr_write_b32 a1, 0
    v_accvgpr_write_b32 a2, 0
    v_accvgpr_write_b32 a3, 0
    v_accvgpr_write_b32 a4, 0
    v_accvgpr_write_b32 a5, 0
    v_accvgpr_write_b32 a6, 0
    v_accvgpr_write_b32 a7, 0
    v_mfma_f32_32x32x16_bf16 v[80:95], a[192:195], v[8:11], 0
    s_add_u32 m0, s39, 32768
    s_nop 0
    buffer_load_dwordx4 v224, s[28:31], s46 offen lds
    v_accvgpr_write_b32 a8, 0
    v_accvgpr_write_b32 a9, 0
    v_accvgpr_write_b32 a10, 0
    v_accvgpr_write_b32 a11, 0
    v_accvgpr_write_b32 a12, 0
    v_accvgpr_write_b32 a13, 0
    v_accvgpr_write_b32 a14, 0
    v_accvgpr_write_b32 a15, 0
    v_mfma_f32_32x32x16_bf16 v[64:79], a[196:199], v[4:7], v[64:79]
    v_accvgpr_write_b32 a16, 0
    v_accvgpr_write_b32 a17, 0
    v_accvgpr_write_b32 a18, 0
    v_accvgpr_write_b32 a19, 0
    v_accvgpr_write_b32 a20, 0
    v_accvgpr_write_b32 a21, 0
    v_accvgpr_write_b32 a22, 0
    v_accvgpr_write_b32 a23, 0
    v_mfma_f32_32x32x16_bf16 v[80:95], a[196:199], v[12:15], v[80:95]
    v_accvgpr_write_b32 a24, 0
    v_accvgpr_write_b32 a25, 0
    v_accvgpr_write_b32 a26, 0
    v_accvgpr_write_b32 a27, 0
    v_accvgpr_write_b32 a28, 0
    v_accvgpr_write_b32 a29, 0
    v_accvgpr_write_b32 a30, 0
    v_accvgpr_write_b32 a31, 0
    v_mfma_f32_32x32x16_bf16 v[64:79], a[200:203], v[16:19], v[64:79]
    v_accvgpr_write_b32 a32, 0
    v_accvgpr_write_b32 a33, 0
    v_accvgpr_write_b32 a34, 0
    v_accvgpr_write_b32 a35, 0
    v_accvgpr_write_b32 a36, 0
    v_accvgpr_write_b32 a37, 0
    v_accvgpr_write_b32 a38, 0
    v_accvgpr_write_b32 a39, 0
    v_mfma_f32_32x32x16_bf16 v[80:95], a[200:203], v[24:27], v[80:95]
    s_add_u32 m0, s39, 32768
    s_nop 0
    buffer_load_dwordx4 v224, s[28:31], s46 offen offset:1024 lds
    s_add_u32 s46, s46, 8192
    s_and_b32 s46, s46, 0x1ffff
    v_accvgpr_write_b32 a40, 0
    v_accvgpr_write_b32 a41, 0
    v_accvgpr_write_b32 a42, 0
    v_accvgpr_write_b32 a43, 0
    v_accvgpr_write_b32 a44, 0
    v_accvgpr_write_b32 a45, 0
    v_accvgpr_write_b32 a46, 0
    v_accvgpr_write_b32 a47, 0
    v_mfma_f32_32x32x16_bf16 v[64:79], a[204:207], v[20:23], v[64:79]
    v_accvgpr_write_b32 a48, 0
    v_accvgpr_write_b32 a49, 0
    v_accvgpr_write_b32 a50, 0
    v_accvgpr_write_b32 a51, 0
    v_accvgpr_write_b32 a52, 0
    v_accvgpr_write_b32 a53, 0
    v_accvgpr_write_b32 a54, 0
    v_accvgpr_write_b32 a55, 0
    v_mfma_f32_32x32x16_bf16 v[80:95], a[204:207], v[28:31], v[80:95]
    v_accvgpr_write_b32 a56, 0
    v_accvgpr_write_b32 a57, 0
    v_accvgpr_write_b32 a58, 0
    v_accvgpr_write_b32 a59, 0
    v_accvgpr_write_b32 a60, 0
    v_accvgpr_write_b32 a61, 0
    v_accvgpr_write_b32 a62, 0
    v_accvgpr_write_b32 a63, 0
    v_mfma_f32_32x32x16_bf16 v[64:79], a[208:211], v[32:35], v[64:79]
    v_accvgpr_write_b32 a64, 0
    v_accvgpr_write_b32 a65, 0
    v_accvgpr_write_b32 a66, 0
    v_accvgpr_write_b32 a67, 0
    v_accvgpr_write_b32 a68, 0
    v_accvgpr_write_b32 a69, 0
    v_accvgpr_write_b32 a70, 0
    v_accvgpr_write_b32 a71, 0
    v_mfma_f32_32x32x16_bf16 v[80:95], a[208:211], v[40:43], v[80:95]
    s_add_u32 m0, s39, 40960
    s_nop 0
    buffer_load_dwordx4 v222, s[24:27], s45 offen lds
    v_accvgpr_write_b32 a72, 0
    v_accvgpr_write_b32 a73, 0
    v_accvgpr_write_b32 a74, 0
    v_accvgpr_write_b32 a75, 0
    v_accvgpr_write_b32 a76, 0
    v_accvgpr_write_b32 a77, 0
    v_accvgpr_write_b32 a78, 0
    v_accvgpr_write_b32 a79, 0
    v_mfma_f32_32x32x16_bf16 v[64:79], a[212:215], v[36:39], v[64:79]
    v_accvgpr_write_b32 a80, 0
    v_accvgpr_write_b32 a81, 0
    v_accvgpr_write_b32 a82, 0
    v_accvgpr_write_b32 a83, 0
    v_accvgpr_write_b32 a84, 0
    v_accvgpr_write_b32 a85, 0
    v_accvgpr_write_b32 a86, 0
    v_accvgpr_write_b32 a87, 0
    v_mfma_f32_32x32x16_bf16 v[80:95], a[212:215], v[44:47], v[80:95]
    v_accvgpr_write_b32 a88, 0
    v_accvgpr_write_b32 a89, 0
    v_accvgpr_write_b32 a90, 0
    v_accvgpr_write_b32 a91, 0
    v_accvgpr_write_b32 a92, 0
    v_accvgpr_write_b32 a93, 0
    v_accvgpr_write_b32 a94, 0
    v_accvgpr_write_b32 a95, 0
    v_mfma_f32_32x32x16_bf16 v[64:79], a[216:219], v[48:51], v[64:79]
    v_accvgpr_write_b32 a96, 0
    v_accvgpr_write_b32 a97, 0
    v_accvgpr_write_b32 a98, 0
    v_accvgpr_write_b32 a99, 0
    v_accvgpr_write_b32 a100, 0
    v_accvgpr_write_b32 a101, 0
    v_accvgpr_write_b32 a102, 0
    v_accvgpr_write_b32 a103, 0
    v_mfma_f32_32x32x16_bf16 v[80:95], a[216:219], v[56:59], v[80:95]
    s_add_u32 m0, s39, 40960
    s_nop 0
    buffer_load_dwordx4 v223, s[24:27], s45 offen offset:1024 lds
    s_add_u32 s45, s45, 8192
    s_and_b32 s45, s45, 0x1ffff
    v_accvgpr_write_b32 a104, 0
    v_accvgpr_write_b32 a105, 0
    v_accvgpr_write_b32 a106, 0
    v_accvgpr_write_b32 a107, 0
    v_accvgpr_write_b32 a108, 0
    v_accvgpr_write_b32 a109, 0
    v_accvgpr_write_b32 a110, 0
    v_accvgpr_write_b32 a111, 0
    v_mfma_f32_32x32x16_bf16 v[64:79], a[220:223], v[52:55], v[64:79]
    v_accvgpr_write_b32 a112, 0
    v_accvgpr_write_b32 a113, 0
    v_accvgpr_write_b32 a114, 0
    v_accvgpr_write_b32 a115, 0
    v_accvgpr_write_b32 a116, 0
    v_accvgpr_write_b32 a117, 0
    v_accvgpr_write_b32 a118, 0
    v_accvgpr_write_b32 a119, 0
    v_mfma_f32_32x32x16_bf16 v[80:95], a[220:223], v[60:63], v[80:95]
    v_accvgpr_write_b32 a120, 0
    v_accvgpr_write_b32 a121, 0
    v_accvgpr_write_b32 a122, 0
    v_accvgpr_write_b32 a123, 0
    v_accvgpr_write_b32 a124, 0
    v_accvgpr_write_b32 a125, 0
    v_accvgpr_write_b32 a126, 0
    v_accvgpr_write_b32 a127, 0
    v_add_u32 v238, 0x10000, v210
    ds_read_b128 a[192:195], v238 offset:40960
    v_add_u32 v239, 0x10000, v211
    ds_read_b128 a[196:199], v239 offset:40960
    v_add_u32 v240, 0x10000, v212
    ds_read_b128 a[200:203], v240 offset:40960
    v_add_u32 v241, 0x10000, v213
    ds_read_b128 a[204:207], v241 offset:40960
    v_add_u32 v238, 0x10000, v214
    ds_read_b128 a[208:211], v238 offset:40960
    v_add_u32 v239, 0x10000, v215
    ds_read_b128 a[212:215], v239 offset:40960
    v_add_u32 v240, 0x10000, v216
    ds_read_b128 a[216:219], v240 offset:40960
    v_add_u32 v241, 0x10000, v217
    ds_read_b128 a[220:223], v241 offset:40960
    v_mov_b32 v246, 0
    v_mov_b32 v247, 0
    v_mov_b32 v248, 0
    v_mov_b32 v249, 0
    v_mov_b32 v228, 0
    v_mov_b32 v229, 0
    s_add_u32 s43, s39, 65536
    s_cmp_lg_u32 s48, 0
    s_cbranch_scc1 K2_HAVEM
    v_max3_f32 v230, v64, v65, v66
    v_max3_f32 v230, v230, v67, v68
    v_max3_f32 v230, v230, v69, v70
    v_max3_f32 v230, v230, v71, v72
    v_max3_f32 v230, v230, v73, v74
    v_max3_f32 v230, v230, v75, v76
    v_max3_f32 v230, v230, v77, v78
    v_max_f32 v230, v230, v79
    v_max3_f32 v231, v80, v81, v82
    v_max3_f32 v231, v231, v83, v84
    v_max3_f32 v231, v231, v85, v86
    v_max3_f32 v231, v231, v87, v88
    v_max3_f32 v231, v231, v89, v90
    v_max3_f32 v231, v231, v91, v92
    v_max3_f32 v231, v231, v93, v94
    v_max_f32 v231, v231, v95
    v_mov_b32 v232, v230
    v_mov_b32 v233, v231
    s_nop 1
    v_permlane32_swap_b32 v230, v232
    v_permlane32_swap_b32 v231, v233
    v_max_f32 v230, v230, v232
    v_max_f32 v231, v231, v233
    v_sub_f32 v160, 0, v230
    v_sub_f32 v161, 0, v230
    v_sub_f32 v162, 0, v230
    v_sub_f32 v163, 0, v230
    v_sub_f32 v164, 0, v230
    v_sub_f32 v165, 0, v230
    v_sub_f32 v166, 0, v230
    v_sub_f32 v167, 0, v230
    v_sub_f32 v168, 0, v230
    v_sub_f32 v169, 0, v230
    v_sub_f32 v170, 0, v230
    v_sub_f32 v171, 0, v230
    v_sub_f32 v172, 0, v230
    v_sub_f32 v173, 0, v230
    v_sub_f32 v174, 0, v230
    v_sub_f32 v175, 0, v230
    v_sub_f32 v176, 0, v231
    v_sub_f32 v177, 0, v231
    v_sub_f32 v178, 0, v231
    v_sub_f32 v179, 0, v231
    v_sub_f32 v180, 0, v231
    v_sub_f32 v181, 0, v231
    v_sub_f32 v182, 0, v231
    v_sub_f32 v183, 0, v231
    v_sub_f32 v184, 0, v231
    v_sub_f32 v185, 0, v231
    v_sub_f32 v186, 0, v231
    v_sub_f32 v187, 0, v231
    v_sub_f32 v188, 0, v231
    v_sub_f32 v189, 0, v231
    v_sub_f32 v190, 0, v231
    v_sub_f32 v191, 0, v231
K2_HAVEM:
    v_add_f32 v64, v64, v160
    v_add_f32 v65, v65, v161
    v_add_f32 v66, v66, v162
    v_add_f32 v67, v67, v163
    v_add_f32 v68, v68, v164
    v_add_f32 v69, v69, v165
    v_add_f32 v70, v70, v166
    v_add_f32 v71, v71, v167
    v_add_f32 v72, v72, v168
    v_add_f32 v73, v73, v169
    v_add_f32 v74, v74, v170
    v_add_f32 v75, v75, v171
    v_add_f32 v76, v76, v172
    v_add_f32 v77, v77, v173
    v_add_f32 v78, v78, v174
    v_add_f32 v79, v79, v175
    v_add_f32 v80, v80, v176
    v_add_f32 v81, v81, v177
    v_add_f32 v82, v82, v178
    v_add_f32 v83, v83, v179
    v_add_f32 v84, v84, v180
    v_add_f32 v85, v85, v181
    v_add_f32 v86, v86, v182
    v_add_f32 v87, v87, v183
    v_add_f32 v88, v88, v184
    v_add_f32 v89, v89, v185
    v_add_f32 v90, v90, v186
    v_add_f32 v91, v91, v187
    v_add_f32 v92, v92, v188
    v_add_f32 v93, v93, v189
    v_add_f32 v94, v94, v190
    v_add_f32 v95, v95, v191
    v_exp_f32 v64, v64
    v_exp_f32 v65, v65
    v_add_f32 v228, v228, v64
    v_add_f32 v228, v228, v65
    v_cvt_pk_bf16_f32 v128, v64, v65
    v_exp_f32 v66, v66
    v_exp_f32 v67, v67
    v_add_f32 v228, v228, v66
    v_add_f32 v228, v228, v67
    v_cvt_pk_bf16_f32 v129, v66, v67
    v_exp_f32 v68, v68
    v_exp_f32 v69, v69
    v_add_f32 v228, v228, v68
    v_add_f32 v228, v228, v69
    v_cvt_pk_bf16_f32 v130, v68, v69
    v_exp_f32 v70, v70
    v_exp_f32 v71, v71
    v_add_f32 v228, v228, v70
    v_add_f32 v228, v228, v71
    v_cvt_pk_bf16_f32 v131, v70, v71
    v_exp_f32 v80, v80
    v_exp_f32 v81, v81
    v_add_f32 v229, v229, v80
    v_add_f32 v229, v229, v81
    v_cvt_pk_bf16_f32 v136, v80, v81
    v_exp_f32 v82, v82
    v_exp_f32 v83, v83
    v_add_f32 v229, v229, v82
    v_add_f32 v229, v229, v83
    v_cvt_pk_bf16_f32 v137, v82, v83
    v_exp_f32 v84, v84
    v_exp_f32 v85, v85
    v_add_f32 v229, v229, v84
    v_add_f32 v229, v229, v85
    v_cvt_pk_bf16_f32 v138, v84, v85
    s_waitcnt vmcnt(10) lgkmcnt(0)
    s_barrier
    s_mov_b32 s47, 0
    s_lshr_b32 s54, s2, 3
    s_lshl_b32 s54, s54, 2
    s_add_u32 s54, s54, s36
    s_lshl_b32 s101, s54, 13
    s_lshl_b32 s59, s2, 2
    s_add_u32 s59, s59, s36
    s_lshl_b32 s59, s59, 13
    s_cmp_lt_u32 s59, 4194304
    s_cselect_b32 s72, s8, s64
    s_cselect_b32 s73, s9, s65
    s_cselect_b32 s74, s10, s66
    s_mov_b32 s75, 0x00020000
    s_and_b32 s59, s59, 4194303
    v_and_b32 v232, 0xf80, v252
    v_mfma_f32_32x32x16_bf16 v[96:111], a[192:195], v[0:3], v[160:175]
    ds_read_b64_tr_b16 a[224:225], v218 offset:0
    ds_read_b64_tr_b16 a[226:227], v218 offset:2048
    v_exp_f32 v86, v86
    v_exp_f32 v87, v87
    v_mfma_f32_32x32x16_bf16 v[112:127], a[192:195], v[8:11], v[176:191]
    s_add_u32 m0, s39, 49152
    s_nop 0
    buffer_load_dwordx4 v224, s[28:31], s46 offen lds
    ds_read_b64_tr_b16 a[228:229], v219 offset:0
    v_add_f32 v229, v229, v86
    v_add_f32 v229, v229, v87
    v_mfma_f32_32x32x16_bf16 v[96:111], a[196:199], v[4:7], v[96:111]
    ds_read_b64_tr_b16 a[230:231], v219 offset:2048
    ds_read_b64_tr_b16 a[232:233], v220 offset:0
    v_cvt_pk_bf16_f32 v139, v86, v87
    v_exp_f32 v72, v72
    v_mfma_f32_32x32x16_bf16 v[112:127], a[196:199], v[12:15], v[112:127]
    ds_read_b64_tr_b16 a[234:235], v220 offset:2048
    v_exp_f32 v73, v73
    v_add_f32 v228, v228, v72
    v_mfma_f32_32x32x16_bf16 v[96:111], a[200:203], v[16:19], v[96:111]
    ds_read_b64_tr_b16 a[236:237], v221 offset:0
    ds_read_b64_tr_b16 a[238:239], v221 offset:2048
    v_add_f32 v228, v228, v73
    v_cvt_pk_bf16_f32 v132, v72, v73
    v_exp_f32 v74, v74
    v_mfma_f32_32x32x16_bf16 v[112:127], a[200:203], v[24:27], v[112:127]
    ds_read_b64_tr_b16 a[240:241], v218 offset:4096
    ds_read_b64_tr_b16 a[242:243], v218 offset:6144
    v_exp_f32 v75, v75
    v_mfma_f32_32x32x16_bf16 v[96:111], a[204:207], v[20:23], v[96:111]
    ds_read_b64_tr_b16 a[244:245], v219 offset:4096
    v_add_f32 v228, v228, v74
    v_add_f32 v228, v228, v75
    v_cvt_pk_bf16_f32 v133, v74, v75
    v_mfma_f32_32x32x16_bf16 v[112:127], a[204:207], v[28:31], v[112:127]
    ds_read_b64_tr_b16 a[246:247], v219 offset:6144
    ds_read_b64_tr_b16 a[248:249], v220 offset:4096
    v_exp_f32 v76, v76
    v_exp_f32 v77, v77
    v_mfma_f32_32x32x16_bf16 v[96:111], a[208:211], v[32:35], v[96:111]
    s_add_u32 m0, s39, 49152
    s_nop 0
    buffer_load_dwordx4 v224, s[28:31], s46 offen offset:1024 lds
    s_add_u32 s46, s46, 8192
    s_and_b32 s46, s46, 0x1ffff
    ds_read_b64_tr_b16 a[250:251], v220 offset:6144
    v_add_f32 v228, v228, v76
    v_add_f32 v228, v228, v77
    v_cvt_pk_bf16_f32 v134, v76, v77
    v_mfma_f32_32x32x16_bf16 v[112:127], a[208:211], v[40:43], v[112:127]
    ds_read_b64_tr_b16 a[252:253], v221 offset:4096
    ds_read_b64_tr_b16 a[254:255], v221 offset:6144
    v_exp_f32 v78, v78
    v_mfma_f32_32x32x16_bf16 v[96:111], a[212:215], v[36:39], v[96:111]
    v_exp_f32 v79, v79
    v_add_f32 v228, v228, v78
    v_add_f32 v228, v228, v79
    v_mfma_f32_32x32x16_bf16 v[112:127], a[212:215], v[44:47], v[112:127]
    v_cvt_pk_bf16_f32 v135, v78, v79
    v_exp_f32 v88, v88
    v_mfma_f32_32x32x16_bf16 v[96:111], a[216:219], v[48:51], v[96:111]
    v_exp_f32 v89, v89
    v_add_f32 v229, v229, v88
    v_mfma_f32_32x32x16_bf16 v[112:127], a[216:219], v[56:59], v[112:127]
    v_add_f32 v229, v229, v89
    v_cvt_pk_bf16_f32 v140, v88, v89
    v_mfma_f32_32x32x16_bf16 v[96:111], a[220:223], v[52:55], v[96:111]
    v_exp_f32 v90, v90
    v_exp_f32 v91, v91
    v_mfma_f32_32x32x16_bf16 v[112:127], a[220:223], v[60:63], v[112:127]
    v_add_f32 v229, v229, v90
    v_add_f32 v229, v229, v91
    v_cvt_pk_bf16_f32 v141, v90, v91
    s_waitcnt lgkmcnt(0)
    v_mfma_f32_32x32x16_bf16 a[0:15], a[224:227], v[128:131], a[0:15]
    s_add_u32 m0, s39, 57344
    s_nop 0
    buffer_load_dwordx4 v222, s[24:27], s45 offen lds
    v_exp_f32 v92, v92
    v_exp_f32 v93, v93
    v_add_f32 v229, v229, v92
    v_mfma_f32_32x32x16_bf16 a[16:31], a[224:227], v[136:139], a[16:31]
    v_add_f32 v229, v229, v93
    v_cvt_pk_bf16_f32 v142, v92, v93
    v_exp_f32 v94, v94
    v_mfma_f32_32x32x16_bf16 a[32:47], a[228:231], v[128:131], a[32:47]
    v_exp_f32 v95, v95
    v_add_f32 v229, v229, v94
    v_add_f32 v229, v229, v95
    v_cvt_pk_bf16_f32 v143, v94, v95
    v_mfma_f32_32x32x16_bf16 a[48:63], a[228:231], v[136:139], a[48:63]
    ds_read_b128 a[192:195], v210 offset:8192
    v_exp_f32 v96, v96
    v_exp_f32 v97, v97
    v_mfma_f32_32x32x16_bf16 a[64:79], a[232:235], v[128:131], a[64:79]
    ds_read_b128 a[196:199], v211 offset:8192
    v_add_f32 v228, v228, v96
    v_add_f32 v228, v228, v97
    v_cvt_pk_bf16_f32 v144, v96, v97
    v_mfma_f32_32x32x16_bf16 a[80:95], a[232:235], v[136:139], a[80:95]
    ds_read_b128 a[200:203], v212 offset:8192
    v_exp_f32 v98, v98
    v_exp_f32 v99, v99
    v_mfma_f32_32x32x16_bf16 a[96:111], a[236:239], v[128:131], a[96:111]
    ds_read_b128 a[204:207], v213 offset:8192
    v_add_f32 v228, v228, v98
    v_add_f32 v228, v228, v99
    v_cvt_pk_bf16_f32 v145, v98, v99
    v_exp_f32 v100, v100
    v_mfma_f32_32x32x16_bf16 a[112:127], a[236:239], v[136:139], a[112:127]
    s_add_u32 m0, s39, 57344
    s_nop 0
    buffer_load_dwordx4 v223, s[24:27], s45 offen offset:1024 lds
    s_add_u32 s45, s45, 8192
    s_and_b32 s45, s45, 0x1ffff
    v_exp_f32 v101, v101
    v_add_f32 v228, v228, v100
    v_mfma_f32_32x32x16_bf16 a[0:15], a[240:243], v[132:135], a[0:15]
    ds_read_b128 a[208:211], v214 offset:8192
    v_add_f32 v228, v228, v101
    v_cvt_pk_bf16_f32 v146, v100, v101
    v_exp_f32 v102, v102
    v_mfma_f32_32x32x16_bf16 a[16:31], a[240:243], v[140:143], a[16:31]
    ds_read_b128 a[212:215], v215 offset:8192
    v_exp_f32 v103, v103
    v_add_f32 v228, v228, v102
    v_mfma_f32_32x32x16_bf16 a[32:47], a[244:247], v[132:135], a[32:47]
    ds_read_b128 a[216:219], v216 offset:8192
    v_add_f32 v228, v228, v103
    v_cvt_pk_bf16_f32 v147, v102, v103
    v_exp_f32 v112, v112
    v_mfma_f32_32x32x16_bf16 a[48:63], a[244:247], v[140:143], a[48:63]
    ds_read_b128 a[220:223], v217 offset:8192
    v_exp_f32 v113, v113
    v_add_f32 v229, v229, v112
    v_add_f32 v229, v229, v113
    v_mfma_f32_32x32x16_bf16 a[64:79], a[248:251], v[132:135], a[64:79]
    v_cvt_pk_bf16_f32 v152, v112, v113
    v_exp_f32 v114, v114
    v_mfma_f32_32x32x16_bf16 a[80:95], a[248:251], v[140:143], a[80:95]
    v_exp_f32 v115, v115
    v_add_f32 v229, v229, v114
    v_add_f32 v229, v229, v115
    v_mfma_f32_32x32x16_bf16 a[96:111], a[252:255], v[132:135], a[96:111]
    v_cvt_pk_bf16_f32 v153, v114, v115
    v_exp_f32 v116, v116
    v_exp_f32 v117, v117
    v_mfma_f32_32x32x16_bf16 a[112:127], a[252:255], v[140:143], a[112:127]
    v_add_f32 v229, v229, v116
    v_add_f32 v229, v229, v117
    v_cvt_pk_bf16_f32 v154, v116, v117
    s_waitcnt vmcnt(10) lgkmcnt(0)
    s_barrier
K2_LOOP:
    v_mfma_f32_32x32x16_bf16 v[64:79], a[192:195], v[0:3], v[160:175]
    ds_read_b64_tr_b16 a[224:225], v218 offset:16384
    ds_read_b64_tr_b16 a[226:227], v218 offset:18432
    v_exp_f32 v118, v118
    v_exp_f32 v119, v119
    v_mfma_f32_32x32x16_bf16 v[80:95], a[192:195], v[8:11], v[176:191]
    s_add_u32 m0, s39, 0
    s_nop 0
    buffer_load_dwordx4 v224, s[28:31], s46 offen lds
    ds_read_b64_tr_b16 a[228:229], v219 offset:16384
    v_add_f32 v229, v229, v118
    v_add_f32 v229, v229, v119
    v_mfma_f32_32x32x16_bf16 v[64:79], a[196:199], v[4:7], v[64:79]
    ds_read_b64_tr_b16 a[230:231], v219 offset:18432
    ds_read_b64_tr_b16 a[232:233], v220 offset:16384
    v_cvt_pk_bf16_f32 v155, v118, v119
    v_exp_f32 v104, v104
    v_mfma_f32_32x32x16_bf16 v[80:95], a[196:199], v[12:15], v[80:95]
    ds_read_b64_tr_b16 a[234:235], v220 offset:18432
    v_exp_f32 v105, v105
    v_add_f32 v228, v228, v104
    v_mfma_f32_32x32x16_bf16 v[64:79], a[200:203], v[16:19], v[64:79]
    ds_read_b64_tr_b16 a[236:237], v221 offset:16384
    ds_read_b64_tr_b16 a[238:239], v221 offset:18432
    v_add_f32 v228, v228, v105
    v_cvt_pk_bf16_f32 v148, v104, v105
    v_exp_f32 v106, v106
    v_mfma_f32_32x32x16_bf16 v[80:95], a[200:203], v[24:27], v[80:95]
    ds_read_b64_tr_b16 a[240:241], v218 offset:20480
    ds_read_b64_tr_b16 a[242:243], v218 offset:22528
    v_exp_f32 v107, v107
    v_mfma_f32_32x32x16_bf16 v[64:79], a[204:207], v[20:23], v[64:79]
    ds_read_b64_tr_b16 a[244:245], v219 offset:20480
    v_add_f32 v228, v228, v106
    v_add_f32 v228, v228, v107
    v_cvt_pk_bf16_f32 v149, v106, v107
    v_mfma_f32_32x32x16_bf16 v[80:95], a[204:207], v[28:31], v[80:95]
    ds_read_b64_tr_b16 a[246:247], v219 offset:22528
    ds_read_b64_tr_b16 a[248:249], v220 offset:20480
    v_exp_f32 v108, v108
    v_exp_f32 v109, v109
    v_mfma_f32_32x32x16_bf16 v[64:79], a[208:211], v[32:35], v[64:79]
    s_add_u32 m0, s39, 0
    s_nop 0
    buffer_load_dwordx4 v224, s[28:31], s46 offen offset:1024 lds
    s_add_u32 s46, s46, 8192
    s_and_b32 s46, s46, 0x1ffff
    ds_read_b64_tr_b16 a[250:251], v220 offset:22528
    v_add_f32 v228, v228, v108
    v_add_f32 v228, v228, v109
    v_cvt_pk_bf16_f32 v150, v108, v109
    v_mfma_f32_32x32x16_bf16 v[80:95], a[208:211], v[40:43], v[80:95]
    ds_read_b64_tr_b16 a[252:253], v221 offset:20480
    ds_read_b64_tr_b16 a[254:255], v221 offset:22528
    v_exp_f32 v110, v110
    v_mfma_f32_32x32x16_bf16 v[64:79], a[212:215], v[36:39], v[64:79]
    v_exp_f32 v111, v111
    v_add_f32 v228, v228, v110
    v_add_f32 v228, v228, v111
    v_mfma_f32_32x32x16_bf16 v[80:95], a[212:215], v[44:47], v[80:95]
    v_cvt_pk_bf16_f32 v151, v110, v111
    v_exp_f32 v120, v120
    v_mfma_f32_32x32x16_bf16 v[64:79], a[216:219], v[48:51], v[64:79]
    v_exp_f32 v121, v121
    v_add_f32 v229, v229, v120
    v_mfma_f32_32x32x16_bf16 v[80:95], a[216:219], v[56:59], v[80:95]
    v_add_f32 v229, v229, v121
    v_cvt_pk_bf16_f32 v156, v120, v121
    v_mfma_f32_32x32x16_bf16 v[64:79], a[220:223], v[52:55], v[64:79]
    v_exp_f32 v122, v122
    v_exp_f32 v123, v123
    v_mfma_f32_32x32x16_bf16 v[80:95], a[220:223], v[60:63], v[80:95]
    v_add_f32 v229, v229, v122
    v_add_f32 v229, v229, v123
    v_cvt_pk_bf16_f32 v157, v122, v123
    s_waitcnt lgkmcnt(0)
    v_mfma_f32_32x32x16_bf16 a[0:15], a[224:227], v[144:147], a[0:15]
    s_add_u32 m0, s39, 8192
    s_nop 0
    buffer_load_dwordx4 v222, s[24:27], s45 offen lds
    v_exp_f32 v124, v124
    v_exp_f32 v125, v125
    v_add_f32 v229, v229, v124
    v_mfma_f32_32x32x16_bf16 a[16:31], a[224:227], v[152:155], a[16:31]
    v_add_f32 v229, v229, v125
    v_cvt_pk_bf16_f32 v158, v124, v125
    v_exp_f32 v126, v126
    v_mfma_f32_32x32x16_bf16 a[32:47], a[228:231], v[144:147], a[32:47]
    v_exp_f32 v127, v127
    v_add_f32 v229, v229, v126
    v_add_f32 v229, v229, v127
    v_cvt_pk_bf16_f32 v159, v126, v127
    v_mfma_f32_32x32x16_bf16 a[48:63], a[228:231], v[152:155], a[48:63]
    ds_read_b128 a[192:195], v210 offset:24576
    v_exp_f32 v64, v64
    v_exp_f32 v65, v65
    v_mfma_f32_32x32x16_bf16 a[64:79], a[232:235], v[144:147], a[64:79]
    ds_read_b128 a[196:199], v211 offset:24576
    v_add_f32 v228, v228, v64
    v_add_f32 v228, v228, v65
    v_cvt_pk_bf16_f32 v128, v64, v65
    v_mfma_f32_32x32x16_bf16 a[80:95], a[232:235], v[152:155], a[80:95]
    ds_read_b128 a[200:203], v212 offset:24576
    v_exp_f32 v66, v66
    v_exp_f32 v67, v67
    v_mfma_f32_32x32x16_bf16 a[96:111], a[236:239], v[144:147], a[96:111]
    ds_read_b128 a[204:207], v213 offset:24576
    v_add_f32 v228, v228, v66
    v_add_f32 v228, v228, v67
    v_cvt_pk_bf16_f32 v129, v66, v67
    v_exp_f32 v68, v68
    v_mfma_f32_32x32x16_bf16 a[112:127], a[236:239], v[152:155], a[112:127]
    s_add_u32 m0, s39, 8192
    s_nop 0
    buffer_load_dwordx4 v223, s[24:27], s45 offen offset:1024 lds
    s_add_u32 s45, s45, 8192
    s_and_b32 s45, s45, 0x1ffff
    v_exp_f32 v69, v69
    v_add_f32 v228, v228, v68
    v_mfma_f32_32x32x16_bf16 a[0:15], a[240:243], v[148:151], a[0:15]
    ds_read_b128 a[208:211], v214 offset:24576
    v_add_f32 v228, v228, v69
    v_cvt_pk_bf16_f32 v130, v68, v69
    v_exp_f32 v70, v70
    v_mfma_f32_32x32x16_bf16 a[16:31], a[240:243], v[156:159], a[16:31]
    ds_read_b128 a[212:215], v215 offset:24576
    v_exp_f32 v71, v71
    v_add_f32 v228, v228, v70
    v_mfma_f32_32x32x16_bf16 a[32:47], a[244:247], v[148:151], a[32:47]
    ds_read_b128 a[216:219], v216 offset:24576
    v_add_f32 v228, v228, v71
    v_cvt_pk_bf16_f32 v131, v70, v71
    v_exp_f32 v80, v80
    v_mfma_f32_32x32x16_bf16 a[48:63], a[244:247], v[156:159], a[48:63]
    ds_read_b128 a[220:223], v217 offset:24576
    v_exp_f32 v81, v81
    v_add_f32 v229, v229, v80
    v_add_f32 v229, v229, v81
    v_mfma_f32_32x32x16_bf16 a[64:79], a[248:251], v[148:151], a[64:79]
    v_cvt_pk_bf16_f32 v136, v80, v81
    v_exp_f32 v82, v82
    v_mfma_f32_32x32x16_bf16 a[80:95], a[248:251], v[156:159], a[80:95]
    v_exp_f32 v83, v83
    v_add_f32 v229, v229, v82
    v_add_f32 v229, v229, v83
    v_mfma_f32_32x32x16_bf16 a[96:111], a[252:255], v[148:151], a[96:111]
    v_cvt_pk_bf16_f32 v137, v82, v83
    v_exp_f32 v84, v84
    v_exp_f32 v85, v85
    v_mfma_f32_32x32x16_bf16 a[112:127], a[252:255], v[156:159], a[112:127]
    v_add_f32 v229, v229, v84
    v_add_f32 v229, v229, v85
    v_cvt_pk_bf16_f32 v138, v84, v85
    s_waitcnt vmcnt(8) lgkmcnt(0)
    s_barrier
    v_mfma_f32_32x32x16_bf16 v[96:111], a[192:195], v[0:3], v[160:175]
    ds_read_b64_tr_b16 a[224:225], v218 offset:32768
    ds_read_b64_tr_b16 a[226:227], v218 offset:34816
    v_exp_f32 v86, v86
    v_exp_f32 v87, v87
    v_mfma_f32_32x32x16_bf16 v[112:127], a[192:195], v[8:11], v[176:191]
    s_add_u32 m0, s39, 16384
    s_nop 0
    buffer_load_dwordx4 v224, s[28:31], s46 offen lds
    ds_read_b64_tr_b16 a[228:229], v219 offset:32768
    v_add_f32 v229, v229, v86
    v_add_f32 v229, v229, v87
    v_mfma_f32_32x32x16_bf16 v[96:111], a[196:199], v[4:7], v[96:111]
    ds_read_b64_tr_b16 a[230:231], v219 offset:34816
    ds_read_b64_tr_b16 a[232:233], v220 offset:32768
    v_cvt_pk_bf16_f32 v139, v86, v87
    v_exp_f32 v72, v72
    v_mfma_f32_32x32x16_bf16 v[112:127], a[196:199], v[12:15], v[112:127]
    ds_read_b64_tr_b16 a[234:235], v220 offset:34816
    v_exp_f32 v73, v73
    v_add_f32 v228, v228, v72
    v_mfma_f32_32x32x16_bf16 v[96:111], a[200:203], v[16:19], v[96:111]
    ds_read_b64_tr_b16 a[236:237], v221 offset:32768
    ds_read_b64_tr_b16 a[238:239], v221 offset:34816
    v_add_f32 v228, v228, v73
    v_cvt_pk_bf16_f32 v132, v72, v73
    v_exp_f32 v74, v74
    v_mfma_f32_32x32x16_bf16 v[112:127], a[200:203], v[24:27], v[112:127]
    ds_read_b64_tr_b16 a[240:241], v218 offset:36864
    ds_read_b64_tr_b16 a[242:243], v218 offset:38912
    v_exp_f32 v75, v75
    v_mfma_f32_32x32x16_bf16 v[96:111], a[204:207], v[20:23], v[96:111]
    ds_read_b64_tr_b16 a[244:245], v219 offset:36864
    v_add_f32 v228, v228, v74
    v_add_f32 v228, v228, v75
    v_cvt_pk_bf16_f32 v133, v74, v75
    v_mfma_f32_32x32x16_bf16 v[112:127], a[204:207], v[28:31], v[112:127]
    s_add_u32 m0, s39, 16384
    s_nop 0
    buffer_load_dwordx4 v224, s[28:31], s46 offen offset:1024 lds
    s_add_u32 s46, s46, 8192
    s_and_b32 s46, s46, 0x1ffff
    ds_read_b64_tr_b16 a[246:247], v219 offset:38912
    ds_read_b64_tr_b16 a[248:249], v220 offset:36864
    v_exp_f32 v76, v76
    v_exp_f32 v77, v77
    v_mfma_f32_32x32x16_bf16 v[96:111], a[208:211], v[32:35], v[96:111]
    ds_read_b64_tr_b16 a[250:251], v220 offset:38912
    v_add_f32 v228, v228, v76
    v_add_f32 v228, v228, v77
    v_cvt_pk_bf16_f32 v134, v76, v77
    v_mfma_f32_32x32x16_bf16 v[112:127], a[208:211], v[40:43], v[112:127]
    ds_read_b64_tr_b16 a[252:253], v221 offset:36864
    ds_read_b64_tr_b16 a[254:255], v221 offset:38912
    v_exp_f32 v78, v78
    v_mfma_f32_32x32x16_bf16 v[96:111], a[212:215], v[36:39], v[96:111]
    v_exp_f32 v79, v79
    v_add_f32 v228, v228, v78
    v_add_f32 v228, v228, v79
    v_mfma_f32_32x32x16_bf16 v[112:127], a[212:215], v[44:47], v[112:127]
    v_cvt_pk_bf16_f32 v135, v78, v79
    v_exp_f32 v88, v88
    v_mfma_f32_32x32x16_bf16 v[96:111], a[216:219], v[48:51], v[96:111]
    v_exp_f32 v89, v89
    v_add_f32 v229, v229, v88
    v_mfma_f32_32x32x16_bf16 v[112:127], a[216:219], v[56:59], v[112:127]
    s_add_u32 m0, s39, 24576
    s_nop 0
    buffer_load_dwordx4 v222, s[24:27], s45 offen lds
    v_add_f32 v229, v229, v89
    v_cvt_pk_bf16_f32 v140, v88, v89
    v_mfma_f32_32x32x16_bf16 v[96:111], a[220:223], v[52:55], v[96:111]
    v_exp_f32 v90, v90
    v_exp_f32 v91, v91
    v_mfma_f32_32x32x16_bf16 v[112:127], a[220:223], v[60:63], v[112:127]
    v_add_f32 v229, v229, v90
    v_add_f32 v229, v229, v91
    v_cvt_pk_bf16_f32 v141, v90, v91
    s_waitcnt lgkmcnt(0)
    v_mfma_f32_32x32x16_bf16 a[0:15], a[224:227], v[128:131], a[0:15]
    v_exp_f32 v92, v92
    v_exp_f32 v93, v93
    v_add_f32 v229, v229, v92
    v_mfma_f32_32x32x16_bf16 a[16:31], a[224:227], v[136:139], a[16:31]
    v_add_f32 v229, v229, v93
    v_cvt_pk_bf16_f32 v142, v92, v93
    v_exp_f32 v94, v94
    v_mfma_f32_32x32x16_bf16 a[32:47], a[228:231], v[128:131], a[32:47]
    v_exp_f32 v95, v95
    v_add_f32 v229, v229, v94
    v_add_f32 v229, v229, v95
    v_cvt_pk_bf16_f32 v143, v94, v95
    v_mfma_f32_32x32x16_bf16 a[48:63], a[228:231], v[136:139], a[48:63]
    s_add_u32 m0, s39, 24576
    s_nop 0
    buffer_load_dwordx4 v223, s[24:27], s45 offen offset:1024 lds
    s_add_u32 s45, s45, 8192
    s_and_b32 s45, s45, 0x1ffff
    ds_read_b128 a[192:195], v210 offset:40960
    v_exp_f32 v96, v96
    v_exp_f32 v97, v97
    v_mfma_f32_32x32x16_bf16 a[64:79], a[232:235], v[128:131], a[64:79]
    ds_read_b128 a[196:199], v211 offset:40960
    v_add_f32 v228, v228, v96
    v_add_f32 v228, v228, v97
    v_cvt_pk_bf16_f32 v144, v96, v97
    v_mfma_f32_32x32x16_bf16 a[80:95], a[232:235], v[136:139], a[80:95]
    ds_read_b128 a[200:203], v212 offset:40960
    v_exp_f32 v98, v98
    v_exp_f32 v99, v99
    v_mfma_f32_32x32x16_bf16 a[96:111], a[236:239], v[128:131], a[96:111]
    ds_read_b128 a[204:207], v213 offset:40960
    v_add_f32 v228, v228, v98
    v_add_f32 v228, v228, v99
    v_cvt_pk_bf16_f32 v145, v98, v99
    v_exp_f32 v100, v100
    v_mfma_f32_32x32x16_bf16 a[112:127], a[236:239], v[136:139], a[112:127]
    v_exp_f32 v101, v101
    v_add_f32 v228, v228, v100
    v_mfma_f32_32x32x16_bf16 a[0:15], a[240:243], v[132:135], a[0:15]
    ds_read_b128 a[208:211], v214 offset:40960
    v_add_f32 v228, v228, v101
    v_cvt_pk_bf16_f32 v146, v100, v101
    v_exp_f32 v102, v102
    v_mfma_f32_32x32x16_bf16 a[16:31], a[240:243], v[140:143], a[16:31]
    buffer_load_dword v253, v232, s[72:75], s59 offen
    s_add_u32 s59, s59, 4096
    ds_read_b128 a[212:215], v215 offset:40960
    v_exp_f32 v103, v103
    v_add_f32 v228, v228, v102
    v_mfma_f32_32x32x16_bf16 a[32:47], a[244:247], v[132:135], a[32:47]
    ds_read_b128 a[216:219], v216 offset:40960
    v_add_f32 v228, v228, v103
    v_cvt_pk_bf16_f32 v147, v102, v103
    v_exp_f32 v112, v112
    v_mfma_f32_32x32x16_bf16 a[48:63], a[244:247], v[140:143], a[48:63]
    ds_read_b128 a[220:223], v217 offset:40960
    v_exp_f32 v113, v113
    v_add_f32 v229, v229, v112
    v_add_f32 v229, v229, v113
    v_mfma_f32_32x32x16_bf16 a[64:79], a[248:251], v[132:135], a[64:79]
    v_cvt_pk_bf16_f32 v152, v112, v113
    v_exp_f32 v114, v114
    v_mfma_f32_32x32x16_bf16 a[80:95], a[248:251], v[140:143], a[80:95]
    v_exp_f32 v115, v115
    v_add_f32 v229, v229, v114
    v_add_f32 v229, v229, v115
    v_mfma_f32_32x32x16_bf16 a[96:111], a[252:255], v[132:135], a[96:111]
    v_cvt_pk_bf16_f32 v153, v114, v115
    v_exp_f32 v116, v116
    v_exp_f32 v117, v117
    v_mfma_f32_32x32x16_bf16 a[112:127], a[252:255], v[140:143], a[112:127]
    v_add_f32 v229, v229, v116
    v_add_f32 v229, v229, v117
    v_cvt_pk_bf16_f32 v154, v116, v117
    s_waitcnt vmcnt(9) lgkmcnt(0)
    s_barrier
    v_mfma_f32_32x32x16_bf16 v[64:79], a[192:195], v[0:3], v[160:175]
    ds_read_b64_tr_b16 a[224:225], v218 offset:49152
    ds_read_b64_tr_b16 a[226:227], v218 offset:51200
    v_exp_f32 v118, v118
    v_exp_f32 v119, v119
    v_mfma_f32_32x32x16_bf16 v[80:95], a[192:195], v[8:11], v[176:191]
    s_add_u32 m0, s39, 32768
    s_nop 0
    buffer_load_dwordx4 v224, s[28:31], s46 offen lds
    ds_read_b64_tr_b16 a[228:229], v219 offset:49152
    v_add_f32 v229, v229, v118
    v_add_f32 v229, v229, v119
    v_mfma_f32_32x32x16_bf16 v[64:79], a[196:199], v[4:7], v[64:79]
    ds_read_b64_tr_b16 a[230:231], v219 offset:51200
    ds_read_b64_tr_b16 a[232:233], v220 offset:49152
    v_cvt_pk_bf16_f32 v155, v118, v119
    v_exp_f32 v104, v104
    v_mfma_f32_32x32x16_bf16 v[80:95], a[196:199], v[12:15], v[80:95]
    ds_read_b64_tr_b16 a[234:235], v220 offset:51200
    v_exp_f32 v105, v105
    v_add_f32 v228, v228, v104
    v_mfma_f32_32x32x16_bf16 v[64:79], a[200:203], v[16:19], v[64:79]
    s_add_u32 m0, s39, 32768
    s_nop 0
    buffer_load_dwordx4 v224, s[28:31], s46 offen offset:1024 lds
    s_add_u32 s46, s46, 8192
    s_and_b32 s46, s46, 0x1ffff
    ds_read_b64_tr_b16 a[236:237], v221 offset:49152
    ds_read_b64_tr_b16 a[238:239], v221 offset:51200
    v_add_f32 v228, v228, v105
    v_cvt_pk_bf16_f32 v148, v104, v105
    v_exp_f32 v106, v106
    v_mfma_f32_32x32x16_bf16 v[80:95], a[200:203], v[24:27], v[80:95]
    ds_read_b64_tr_b16 a[240:241], v218 offset:53248
    ds_read_b64_tr_b16 a[242:243], v218 offset:55296
    v_exp_f32 v107, v107
    v_mfma_f32_32x32x16_bf16 v[64:79], a[204:207], v[20:23], v[64:79]
    ds_read_b64_tr_b16 a[244:245], v219 offset:53248
    v_add_f32 v228, v228, v106
    v_add_f32 v228, v228, v107
    v_cvt_pk_bf16_f32 v149, v106, v107
    v_mfma_f32_32x32x16_bf16 v[80:95], a[204:207], v[28:31], v[80:95]
    ds_read_b64_tr_b16 a[246:247], v219 offset:55296
    ds_read_b64_tr_b16 a[248:249], v220 offset:53248
    v_exp_f32 v108, v108
    v_exp_f32 v109, v109
    v_mfma_f32_32x32x16_bf16 v[64:79], a[208:211], v[32:35], v[64:79]
    s_add_u32 m0, s39, 40960
    s_nop 0
    buffer_load_dwordx4 v222, s[24:27], s45 offen lds
    ds_read_b64_tr_b16 a[250:251], v220 offset:55296
    v_add_f32 v228, v228, v108
    v_add_f32 v228, v228, v109
    v_cvt_pk_bf16_f32 v150, v108, v109
    v_mfma_f32_32x32x16_bf16 v[80:95], a[208:211], v[40:43], v[80:95]
    ds_read_b64_tr_b16 a[252:253], v221 offset:53248
    ds_read_b64_tr_b16 a[254:255], v221 offset:55296
    v_exp_f32 v110, v110
    v_mfma_f32_32x32x16_bf16 v[64:79], a[212:215], v[36:39], v[64:79]
    v_exp_f32 v111, v111
    v_add_f32 v228, v228, v110
    v_add_f32 v228, v228, v111
    v_mfma_f32_32x32x16_bf16 v[80:95], a[212:215], v[44:47], v[80:95]
    v_cvt_pk_bf16_f32 v151, v110, v111
    v_exp_f32 v120, v120
    v_mfma_f32_32x32x16_bf16 v[64:79], a[216:219], v[48:51], v[64:79]
    s_add_u32 m0, s39, 40960
    s_nop 0
    buffer_load_dwordx4 v223, s[24:27], s45 offen offset:1024 lds
    s_add_u32 s45, s45, 8192
    s_and_b32 s45, s45, 0x1ffff
    v_exp_f32 v121, v121
    v_add_f32 v229, v229, v120
    v_mfma_f32_32x32x16_bf16 v[80:95], a[216:219], v[56:59], v[80:95]
    v_add_f32 v229, v229, v121
    v_cvt_pk_bf16_f32 v156, v120, v121
    v_mfma_f32_32x32x16_bf16 v[64:79], a[220:223], v[52:55], v[64:79]
    v_exp_f32 v122, v122
    v_exp_f32 v123, v123
    v_mfma_f32_32x32x16_bf16 v[80:95], a[220:223], v[60:63], v[80:95]
    v_add_f32 v229, v229, v122
    v_add_f32 v229, v229, v123
    v_cvt_pk_bf16_f32 v157, v122, v123
    s_waitcnt lgkmcnt(0)
    v_mfma_f32_32x32x16_bf16 a[0:15], a[224:227], v[144:147], a[0:15]
    s_mul_i32 s42, s41, 229376
    s_mov_b32 m0, s43
    s_add_u32 s41, s41, 1
    buffer_load_dwordx4 v207, s[12:15], s42 offen lds
    v_exp_f32 v124, v124
    v_exp_f32 v125, v125
    v_add_f32 v229, v229, v124
    v_mfma_f32_32x32x16_bf16 a[16:31], a[224:227], v[152:155], a[16:31]
    v_add_f32 v229, v229, v125
    v_cvt_pk_bf16_f32 v158, v124, v125
    v_exp_f32 v126, v126
    v_mfma_f32_32x32x16_bf16 a[32:47], a[228:231], v[144:147], a[32:47]
    v_exp_f32 v127, v127
    v_add_f32 v229, v229, v126
    v_add_f32 v229, v229, v127
    v_cvt_pk_bf16_f32 v159, v126, v127
    v_mfma_f32_32x32x16_bf16 a[48:63], a[228:231], v[152:155], a[48:63]
    s_add_u32 m0, s43, 8192
    s_and_b32 s41, s41, 7
    buffer_load_dwordx4 v207, s[16:19], s42 offen lds
    ds_read_b128 a[192:195], v210 offset:57344
    v_exp_f32 v64, v64
    v_exp_f32 v65, v65
    v_mfma_f32_32x32x16_bf16 a[64:79], a[232:235], v[144:147], a[64:79]
    ds_read_b128 a[196:199], v211 offset:57344
    v_add_f32 v228, v228, v64
    v_add_f32 v228, v228, v65
    v_cvt_pk_bf16_f32 v128, v64, v65
    v_mfma_f32_32x32x16_bf16 a[80:95], a[232:235], v[152:155], a[80:95]
    ds_read_b128 a[200:203], v212 offset:57344
    v_exp_f32 v66, v66
    v_exp_f32 v67, v67
    v_mfma_f32_32x32x16_bf16 a[96:111], a[236:239], v[144:147], a[96:111]
    ds_read_b128 a[204:207], v213 offset:57344
    v_add_f32 v228, v228, v66
    v_add_f32 v228, v228, v67
    v_cvt_pk_bf16_f32 v129, v66, v67
    v_exp_f32 v68, v68
    v_mfma_f32_32x32x16_bf16 a[112:127], a[236:239], v[152:155], a[112:127]
    s_add_u32 m0, s43, 8192
    s_add_u32 s42, s42, 27648
    buffer_load_dwordx4 v207, s[16:19], s42 offen offset:1024 lds
    v_exp_f32 v69, v69
    v_add_f32 v228, v228, v68
    v_mfma_f32_32x32x16_bf16 a[0:15], a[240:243], v[148:151], a[0:15]
    ds_read_b128 a[208:211], v214 offset:57344
    v_add_f32 v228, v228, v69
    v_cvt_pk_bf16_f32 v130, v68, v69
    v_exp_f32 v70, v70
    v_mfma_f32_32x32x16_bf16 a[16:31], a[240:243], v[156:159], a[16:31]
    ds_read_b128 a[212:215], v215 offset:57344
    v_exp_f32 v71, v71
    v_add_f32 v228, v228, v70
    v_mfma_f32_32x32x16_bf16 a[32:47], a[244:247], v[148:151], a[32:47]
    ds_read_b128 a[216:219], v216 offset:57344
    v_add_f32 v228, v228, v71
    v_cvt_pk_bf16_f32 v131, v70, v71
    v_exp_f32 v80, v80
    v_mfma_f32_32x32x16_bf16 a[48:63], a[244:247], v[156:159], a[48:63]
    s_mov_b32 m0, s43
    s_add_u32 s43, s43, 16384
    buffer_load_dwordx4 v207, s[12:15], s42 offen offset:1024 lds
    ds_read_b128 a[220:223], v217 offset:57344
    v_exp_f32 v81, v81
    v_add_f32 v229, v229, v80
    v_add_f32 v229, v229, v81
    v_mfma_f32_32x32x16_bf16 a[64:79], a[248:251], v[148:151], a[64:79]
    v_cvt_pk_bf16_f32 v136, v80, v81
    v_exp_f32 v82, v82
    v_mfma_f32_32x32x16_bf16 a[80:95], a[248:251], v[156:159], a[80:95]
    v_exp_f32 v83, v83
    v_add_f32 v229, v229, v82
    v_add_f32 v229, v229, v83
    v_mfma_f32_32x32x16_bf16 a[96:111], a[252:255], v[148:151], a[96:111]
    v_cvt_pk_bf16_f32 v137, v82, v83
    v_exp_f32 v84, v84
    v_exp_f32 v85, v85
    v_mfma_f32_32x32x16_bf16 a[112:127], a[252:255], v[156:159], a[112:127]
    v_add_f32 v229, v229, v84
    v_add_f32 v229, v229, v85
    v_cvt_pk_bf16_f32 v138, v84, v85
    s_waitcnt vmcnt(13) lgkmcnt(0)
    s_barrier
    v_mfma_f32_32x32x16_bf16 v[96:111], a[192:195], v[0:3], v[160:175]
    ds_read_b64_tr_b16 a[224:225], v218 offset:0
    ds_read_b64_tr_b16 a[226:227], v218 offset:2048
    v_exp_f32 v86, v86
    v_exp_f32 v87, v87
    v_mfma_f32_32x32x16_bf16 v[112:127], a[192:195], v[8:11], v[176:191]
    s_add_u32 m0, s39, 49152
    s_nop 0
    buffer_load_dwordx4 v224, s[28:31], s46 offen lds
    ds_read_b64_tr_b16 a[228:229], v219 offset:0
    v_add_f32 v229, v229, v86
    v_add_f32 v229, v229, v87
    v_mfma_f32_32x32x16_bf16 v[96:111], a[196:199], v[4:7], v[96:111]
    ds_read_b64_tr_b16 a[230:231], v219 offset:2048
    ds_read_b64_tr_b16 a[232:233], v220 offset:0
    v_cvt_pk_bf16_f32 v139, v86, v87
    v_exp_f32 v72, v72
    v_mfma_f32_32x32x16_bf16 v[112:127], a[196:199], v[12:15], v[112:127]
    ds_read_b64_tr_b16 a[234:235], v220 offset:2048
    v_exp_f32 v73, v73
    v_add_f32 v228, v228, v72
    v_mfma_f32_32x32x16_bf16 v[96:111], a[200:203], v[16:19], v[96:111]
    s_add_u32 m0, s39, 49152
    s_nop 0
    buffer_load_dwordx4 v224, s[28:31], s46 offen offset:1024 lds
    s_add_u32 s46, s46, 8192
    s_and_b32 s46, s46, 0x1ffff
    ds_read_b64_tr_b16 a[236:237], v221 offset:0
    ds_read_b64_tr_b16 a[238:239], v221 offset:2048
    v_add_f32 v228, v228, v73
    v_cvt_pk_bf16_f32 v132, v72, v73
    v_exp_f32 v74, v74
    v_mfma_f32_32x32x16_bf16 v[112:127], a[200:203], v[24:27], v[112:127]
    ds_read_b64_tr_b16 a[240:241], v218 offset:4096
    ds_read_b64_tr_b16 a[242:243], v218 offset:6144
    v_exp_f32 v75, v75
    v_mfma_f32_32x32x16_bf16 v[96:111], a[204:207], v[20:23], v[96:111]
    ds_read_b64_tr_b16 a[244:245], v219 offset:4096
    v_add_f32 v228, v228, v74
    v_add_f32 v228, v228, v75
    v_cvt_pk_bf16_f32 v133, v74, v75
    v_mfma_f32_32x32x16_bf16 v[112:127], a[204:207], v[28:31], v[112:127]
    ds_read_b64_tr_b16 a[246:247], v219 offset:6144
    ds_read_b64_tr_b16 a[248:249], v220 offset:4096
    v_exp_f32 v76, v76
    v_exp_f32 v77, v77
    v_mfma_f32_32x32x16_bf16 v[96:111], a[208:211], v[32:35], v[96:111]
    s_add_u32 m0, s39, 57344
    s_nop 0
    buffer_load_dwordx4 v222, s[24:27], s45 offen lds
    ds_read_b64_tr_b16 a[250:251], v220 offset:6144
    v_add_f32 v228, v228, v76
    v_add_f32 v228, v228, v77
    v_cvt_pk_bf16_f32 v134, v76, v77
    v_mfma_f32_32x32x16_bf16 v[112:127], a[208:211], v[40:43], v[112:127]
    ds_read_b64_tr_b16 a[252:253], v221 offset:4096
    ds_read_b64_tr_b16 a[254:255], v221 offset:6144
    v_exp_f32 v78, v78
    v_mfma_f32_32x32x16_bf16 v[96:111], a[212:215], v[36:39], v[96:111]
    v_exp_f32 v79, v79
    v_add_f32 v228, v228, v78
    v_add_f32 v228, v228, v79
    v_mfma_f32_32x32x16_bf16 v[112:127], a[212:215], v[44:47], v[112:127]
    v_cvt_pk_bf16_f32 v135, v78, v79
    v_exp_f32 v88, v88
    v_mfma_f32_32x32x16_bf16 v[96:111], a[216:219], v[48:51], v[96:111]
    s_add_u32 m0, s39, 57344
    s_nop 0
    buffer_load_dwordx4 v223, s[24:27], s45 offen offset:1024 lds
    s_add_u32 s45, s45, 8192
    s_and_b32 s45, s45, 0x1ffff
    v_exp_f32 v89, v89
    v_add_f32 v229, v229, v88
    v_mfma_f32_32x32x16_bf16 v[112:127], a[216:219], v[56:59], v[112:127]
    v_add_f32 v229, v229, v89
    v_cvt_pk_bf16_f32 v140, v88, v89
    v_mfma_f32_32x32x16_bf16 v[96:111], a[220:223], v[52:55], v[96:111]
    v_exp_f32 v90, v90
    v_exp_f32 v91, v91
    v_mfma_f32_32x32x16_bf16 v[112:127], a[220:223], v[60:63], v[112:127]
    v_add_f32 v229, v229, v90
    v_add_f32 v229, v229, v91
    v_cvt_pk_bf16_f32 v141, v90, v91
    s_waitcnt lgkmcnt(0)
    v_mfma_f32_32x32x16_bf16 a[0:15], a[224:227], v[128:131], a[0:15]
    s_mul_i32 s42, s41, 229376
    s_mov_b32 m0, s43
    s_add_u32 s41, s41, 1
    buffer_load_dwordx4 v207, s[12:15], s42 offen lds
    v_exp_f32 v92, v92
    v_exp_f32 v93, v93
    v_add_f32 v229, v229, v92
    v_mfma_f32_32x32x16_bf16 a[16:31], a[224:227], v[136:139], a[16:31]
    v_add_f32 v229, v229, v93
    v_cvt_pk_bf16_f32 v142, v92, v93
    v_exp_f32 v94, v94
    v_mfma_f32_32x32x16_bf16 a[32:47], a[228:231], v[128:131], a[32:47]
    v_exp_f32 v95, v95
    v_add_f32 v229, v229, v94
    v_add_f32 v229, v229, v95
    v_cvt_pk_bf16_f32 v143, v94, v95
    v_mfma_f32_32x32x16_bf16 a[48:63], a[228:231], v[136:139], a[48:63]
    s_add_u32 m0, s43, 8192
    s_and_b32 s41, s41, 7
    buffer_load_dwordx4 v207, s[16:19], s42 offen lds
    ds_read_b128 a[192:195], v210 offset:8192
    v_exp_f32 v96, v96
    v_exp_f32 v97, v97
    v_mfma_f32_32x32x16_bf16 a[64:79], a[232:235], v[128:131], a[64:79]
    ds_read_b128 a[196:199], v211 offset:8192
    v_add_f32 v228, v228, v96
    v_add_f32 v228, v228, v97
    v_cvt_pk_bf16_f32 v144, v96, v97
    v_mfma_f32_32x32x16_bf16 a[80:95], a[232:235], v[136:139], a[80:95]
    ds_read_b128 a[200:203], v212 offset:8192
    v_exp_f32 v98, v98
    v_exp_f32 v99, v99
    v_mfma_f32_32x32x16_bf16 a[96:111], a[236:239], v[128:131], a[96:111]
    ds_read_b128 a[204:207], v213 offset:8192
    v_add_f32 v228, v228, v98
    v_add_f32 v228, v228, v99
    v_cvt_pk_bf16_f32 v145, v98, v99
    v_exp_f32 v100, v100
    v_mfma_f32_32x32x16_bf16 a[112:127], a[236:239], v[136:139], a[112:127]
    s_add_u32 m0, s43, 8192
    s_add_u32 s42, s42, 27648
    buffer_load_dwordx4 v207, s[16:19], s42 offen offset:1024 lds
    v_exp_f32 v101, v101
    v_add_f32 v228, v228, v100
    v_mfma_f32_32x32x16_bf16 a[0:15], a[240:243], v[132:135], a[0:15]
    ds_read_b128 a[208:211], v214 offset:8192
    v_add_f32 v228, v228, v101
    v_cvt_pk_bf16_f32 v146, v100, v101
    v_exp_f32 v102, v102
    v_mfma_f32_32x32x16_bf16 a[16:31], a[240:243], v[140:143], a[16:31]
    ds_read_b128 a[212:215], v215 offset:8192
    v_exp_f32 v103, v103
    v_add_f32 v228, v228, v102
    v_mfma_f32_32x32x16_bf16 a[32:47], a[244:247], v[132:135], a[32:47]
    ds_read_b128 a[216:219], v216 offset:8192
    v_add_f32 v228, v228, v103
    v_cvt_pk_bf16_f32 v147, v102, v103
    v_exp_f32 v112, v112
    v_mfma_f32_32x32x16_bf16 a[48:63], a[244:247], v[140:143], a[48:63]
    s_mov_b32 m0, s43
    s_add_u32 s43, s43, 16384
    buffer_load_dwordx4 v207, s[12:15], s42 offen offset:1024 lds
    ds_read_b128 a[220:223], v217 offset:8192
    v_exp_f32 v113, v113
    v_add_f32 v229, v229, v112
    v_add_f32 v229, v229, v113
    v_mfma_f32_32x32x16_bf16 a[64:79], a[248:251], v[132:135], a[64:79]
    v_cvt_pk_bf16_f32 v152, v112, v113
    v_exp_f32 v114, v114
    v_mfma_f32_32x32x16_bf16 a[80:95], a[248:251], v[140:143], a[80:95]
    v_exp_f32 v115, v115
    v_add_f32 v229, v229, v114
    v_add_f32 v229, v229, v115
    v_mfma_f32_32x32x16_bf16 a[96:111], a[252:255], v[132:135], a[96:111]
    v_cvt_pk_bf16_f32 v153, v114, v115
    v_exp_f32 v116, v116
    v_exp_f32 v117, v117
    v_mfma_f32_32x32x16_bf16 a[112:127], a[252:255], v[140:143], a[112:127]
    v_add_f32 v229, v229, v116
    v_add_f32 v229, v229, v117
    v_cvt_pk_bf16_f32 v154, v116, v117
    s_waitcnt vmcnt(17) lgkmcnt(0)
    s_barrier
    s_add_u32 s47, s47, 1
    s_cmp_lt_u32 s47, 3
    s_cbranch_scc1 K2_LOOP
    v_mfma_f32_32x32x16_bf16 v[64:79], a[192:195], v[0:3], v[160:175]
    ds_read_b64_tr_b16 a[224:225], v218 offset:16384
    ds_read_b64_tr_b16 a[226:227], v218 offset:18432
    v_exp_f32 v118, v118
    v_exp_f32 v119, v119
    v_mfma_f32_32x32x16_bf16 v[80:95], a[192:195], v[8:11], v[176:191]
    buffer_load_dwordx4 a[160:163], v208, s[20:23], s44 offen offset:0 sc1
    ds_read_b64_tr_b16 a[228:229], v219 offset:16384
    v_add_f32 v229, v229, v118
    v_add_f32 v229, v229, v119
    v_mfma_f32_32x32x16_bf16 v[64:79], a[196:199], v[4:7], v[64:79]
    ds_read_b64_tr_b16 a[230:231], v219 offset:18432
    ds_read_b64_tr_b16 a[232:233], v220 offset:16384
    v_cvt_pk_bf16_f32 v155, v118, v119
    v_exp_f32 v104, v104
    v_mfma_f32_32x32x16_bf16 v[80:95], a[196:199], v[12:15], v[80:95]
    ds_read_b64_tr_b16 a[234:235], v220 offset:18432
    v_exp_f32 v105, v105
    v_add_f32 v228, v228, v104
    v_mfma_f32_32x32x16_bf16 v[64:79], a[200:203], v[16:19], v[64:79]
    buffer_load_dwordx4 a[164:167], v209, s[20:23], s44 offen offset:0 sc1
    ds_read_b64_tr_b16 a[236:237], v221 offset:16384
    ds_read_b64_tr_b16 a[238:239], v221 offset:18432
    v_add_f32 v228, v228, v105
    v_cvt_pk_bf16_f32 v148, v104, v105
    v_exp_f32 v106, v106
    v_mfma_f32_32x32x16_bf16 v[80:95], a[200:203], v[24:27], v[80:95]
    ds_read_b64_tr_b16 a[240:241], v218 offset:20480
    ds_read_b64_tr_b16 a[242:243], v218 offset:22528
    v_exp_f32 v107, v107
    v_mfma_f32_32x32x16_bf16 v[64:79], a[204:207], v[20:23], v[64:79]
    ds_read_b64_tr_b16 a[244:245], v219 offset:20480
    v_add_f32 v228, v228, v106
    v_add_f32 v228, v228, v107
    v_cvt_pk_bf16_f32 v149, v106, v107
    v_mfma_f32_32x32x16_bf16 v[80:95], a[204:207], v[28:31], v[80:95]
    ds_read_b64_tr_b16 a[246:247], v219 offset:22528
    ds_read_b64_tr_b16 a[248:249], v220 offset:20480
    v_exp_f32 v108, v108
    v_exp_f32 v109, v109
    v_mfma_f32_32x32x16_bf16 v[64:79], a[208:211], v[32:35], v[64:79]
    buffer_load_dwordx4 a[168:171], v208, s[20:23], s44 offen offset:1024 sc1
    ds_read_b64_tr_b16 a[250:251], v220 offset:22528
    v_add_f32 v228, v228, v108
    v_add_f32 v228, v228, v109
    v_cvt_pk_bf16_f32 v150, v108, v109
    v_mfma_f32_32x32x16_bf16 v[80:95], a[208:211], v[40:43], v[80:95]
    ds_read_b64_tr_b16 a[252:253], v221 offset:20480
    ds_read_b64_tr_b16 a[254:255], v221 offset:22528
    v_exp_f32 v110, v110
    v_mfma_f32_32x32x16_bf16 v[64:79], a[212:215], v[36:39], v[64:79]
    v_exp_f32 v111, v111
    v_add_f32 v228, v228, v110
    v_add_f32 v228, v228, v111
    v_mfma_f32_32x32x16_bf16 v[80:95], a[212:215], v[44:47], v[80:95]
    v_cvt_pk_bf16_f32 v151, v110, v111
    v_exp_f32 v120, v120
    v_mfma_f32_32x32x16_bf16 v[64:79], a[216:219], v[48:51], v[64:79]
    buffer_load_dwordx4 a[172:175], v209, s[20:23], s44 offen offset:1024 sc1
    v_exp_f32 v121, v121
    v_add_f32 v229, v229, v120
    v_mfma_f32_32x32x16_bf16 v[80:95], a[216:219], v[56:59], v[80:95]
    v_add_f32 v229, v229, v121
    v_cvt_pk_bf16_f32 v156, v120, v121
    v_mfma_f32_32x32x16_bf16 v[64:79], a[220:223], v[52:55], v[64:79]
    v_exp_f32 v122, v122
    v_exp_f32 v123, v123
    v_mfma_f32_32x32x16_bf16 v[80:95], a[220:223], v[60:63], v[80:95]
    v_add_f32 v229, v229, v122
    v_add_f32 v229, v229, v123
    v_cvt_pk_bf16_f32 v157, v122, v123
    s_waitcnt lgkmcnt(0)
    v_mfma_f32_32x32x16_bf16 a[0:15], a[224:227], v[144:147], a[0:15]
    buffer_load_dwordx4 a[176:179], v208, s[20:23], s44 offen offset:2048 sc1
    v_exp_f32 v124, v124
    v_exp_f32 v125, v125
    v_add_f32 v229, v229, v124
    v_mfma_f32_32x32x16_bf16 a[16:31], a[224:227], v[152:155], a[16:31]
    v_add_f32 v229, v229, v125
    v_cvt_pk_bf16_f32 v158, v124, v125
    v_exp_f32 v126, v126
    v_mfma_f32_32x32x16_bf16 a[32:47], a[228:231], v[144:147], a[32:47]
    v_exp_f32 v127, v127
    v_add_f32 v229, v229, v126
    v_add_f32 v229, v229, v127
    v_cvt_pk_bf16_f32 v159, v126, v127
    v_mfma_f32_32x32x16_bf16 a[48:63], a[228:231], v[152:155], a[48:63]
    buffer_load_dwordx4 a[180:183], v209, s[20:23], s44 offen offset:2048 sc1
    ds_read_b128 a[192:195], v210 offset:24576
    v_exp_f32 v64, v64
    v_exp_f32 v65, v65
    v_mfma_f32_32x32x16_bf16 a[64:79], a[232:235], v[144:147], a[64:79]
    ds_read_b128 a[196:199], v211 offset:24576
    v_add_f32 v228, v228, v64
    v_add_f32 v228, v228, v65
    v_cvt_pk_bf16_f32 v128, v64, v65
    v_mfma_f32_32x32x16_bf16 a[80:95], a[232:235], v[152:155], a[80:95]
    ds_read_b128 a[200:203], v212 offset:24576
    v_exp_f32 v66, v66
    v_exp_f32 v67, v67
    v_mfma_f32_32x32x16_bf16 a[96:111], a[236:239], v[144:147], a[96:111]
    ds_read_b128 a[204:207], v213 offset:24576
    v_add_f32 v228, v228, v66
    v_add_f32 v228, v228, v67
    v_cvt_pk_bf16_f32 v129, v66, v67
    v_exp_f32 v68, v68
    v_mfma_f32_32x32x16_bf16 a[112:127], a[236:239], v[152:155], a[112:127]
    buffer_load_dwordx4 a[184:187], v208, s[20:23], s44 offen offset:3072 sc1
    v_exp_f32 v69, v69
    v_add_f32 v228, v228, v68
    v_mfma_f32_32x32x16_bf16 a[0:15], a[240:243], v[148:151], a[0:15]
    ds_read_b128 a[208:211], v214 offset:24576
    v_add_f32 v228, v228, v69
    v_cvt_pk_bf16_f32 v130, v68, v69
    v_exp_f32 v70, v70
    v_mfma_f32_32x32x16_bf16 a[16:31], a[240:243], v[156:159], a[16:31]
    ds_read_b128 a[212:215], v215 offset:24576
    v_exp_f32 v71, v71
    v_add_f32 v228, v228, v70
    v_mfma_f32_32x32x16_bf16 a[32:47], a[244:247], v[148:151], a[32:47]
    ds_read_b128 a[216:219], v216 offset:24576
    v_add_f32 v228, v228, v71
    v_cvt_pk_bf16_f32 v131, v70, v71
    v_exp_f32 v80, v80
    v_mfma_f32_32x32x16_bf16 a[48:63], a[244:247], v[156:159], a[48:63]
    buffer_load_dwordx4 a[188:191], v209, s[20:23], s44 offen offset:3072 sc1
    s_add_u32 s44, s44, 4096
    s_and_b32 s44, s44, 0x7fff
    ds_read_b128 a[220:223], v217 offset:24576
    v_exp_f32 v81, v81
    v_add_f32 v229, v229, v80
    v_add_f32 v229, v229, v81
    v_mfma_f32_32x32x16_bf16 a[64:79], a[248:251], v[148:151], a[64:79]
    v_cvt_pk_bf16_f32 v136, v80, v81
    v_exp_f32 v82, v82
    v_mfma_f32_32x32x16_bf16 a[80:95], a[248:251], v[156:159], a[80:95]
    v_exp_f32 v83, v83
    v_add_f32 v229, v229, v82
    v_add_f32 v229, v229, v83
    v_mfma_f32_32x32x16_bf16 a[96:111], a[252:255], v[148:151], a[96:111]
    v_cvt_pk_bf16_f32 v137, v82, v83
    v_exp_f32 v84, v84
    v_exp_f32 v85, v85
    v_mfma_f32_32x32x16_bf16 a[112:127], a[252:255], v[156:159], a[112:127]
    v_add_f32 v229, v229, v84
    v_add_f32 v229, v229, v85
    v_cvt_pk_bf16_f32 v138, v84, v85
    s_waitcnt vmcnt(20) lgkmcnt(0)
    s_barrier
    v_mfma_f32_32x32x16_bf16 v[96:111], a[192:195], v[0:3], v[160:175]
    ds_read_b64_tr_b16 a[224:225], v218 offset:32768
    ds_read_b64_tr_b16 a[226:227], v218 offset:34816
    v_exp_f32 v86, v86
    v_exp_f32 v87, v87
    v_mfma_f32_32x32x16_bf16 v[112:127], a[192:195], v[8:11], v[176:191]
    s_mov_b32 s43, s39
    s_mul_i32 s42, s41, 229376
    s_mov_b32 m0, s43
    s_add_u32 s41, s41, 1
    buffer_load_dwordx4 v207, s[12:15], s42 offen lds
    ds_read_b64_tr_b16 a[228:229], v219 offset:32768
    v_add_f32 v229, v229, v86
    v_add_f32 v229, v229, v87
    v_mfma_f32_32x32x16_bf16 v[96:111], a[196:199], v[4:7], v[96:111]
    ds_read_b64_tr_b16 a[230:231], v219 offset:34816
    ds_read_b64_tr_b16 a[232:233], v220 offset:32768
    v_cvt_pk_bf16_f32 v139, v86, v87
    v_exp_f32 v72, v72
    v_mfma_f32_32x32x16_bf16 v[112:127], a[196:199], v[12:15], v[112:127]
    ds_read_b64_tr_b16 a[234:235], v220 offset:34816
    v_exp_f32 v73, v73
    v_add_f32 v228, v228, v72
    v_mfma_f32_32x32x16_bf16 v[96:111], a[200:203], v[16:19], v[96:111]
    s_add_u32 m0, s43, 8192
    s_and_b32 s41, s41, 7
    buffer_load_dwordx4 v207, s[16:19], s42 offen lds
    ds_read_b64_tr_b16 a[236:237], v221 offset:32768
    ds_read_b64_tr_b16 a[238:239], v221 offset:34816
    v_add_f32 v228, v228, v73
    v_cvt_pk_bf16_f32 v132, v72, v73
    v_exp_f32 v74, v74
    v_mfma_f32_32x32x16_bf16 v[112:127], a[200:203], v[24:27], v[112:127]
    ds_read_b64_tr_b16 a[240:241], v218 offset:36864
    ds_read_b64_tr_b16 a[242:243], v218 offset:38912
    v_exp_f32 v75, v75
    v_mfma_f32_32x32x16_bf16 v[96:111], a[204:207], v[20:23], v[96:111]
    ds_read_b64_tr_b16 a[244:245], v219 offset:36864
    v_add_f32 v228, v228, v74
    v_add_f32 v228, v228, v75
    v_cvt_pk_bf16_f32 v133, v74, v75
    v_mfma_f32_32x32x16_bf16 v[112:127], a[204:207], v[28:31], v[112:127]
    ds_read_b64_tr_b16 a[246:247], v219 offset:38912
    ds_read_b64_tr_b16 a[248:249], v220 offset:36864
    v_exp_f32 v76, v76
    v_exp_f32 v77, v77
    v_mfma_f32_32x32x16_bf16 v[96:111], a[208:211], v[32:35], v[96:111]
    s_add_u32 m0, s43, 8192
    s_add_u32 s42, s42, 27648
    buffer_load_dwordx4 v207, s[16:19], s42 offen offset:1024 lds
    ds_read_b64_tr_b16 a[250:251], v220 offset:38912
    v_add_f32 v228, v228, v76
    v_add_f32 v228, v228, v77
    v_cvt_pk_bf16_f32 v134, v76, v77
    v_mfma_f32_32x32x16_bf16 v[112:127], a[208:211], v[40:43], v[112:127]
    ds_read_b64_tr_b16 a[252:253], v221 offset:36864
    ds_read_b64_tr_b16 a[254:255], v221 offset:38912
    v_exp_f32 v78, v78
    v_mfma_f32_32x32x16_bf16 v[96:111], a[212:215], v[36:39], v[96:111]
    v_exp_f32 v79, v79
    v_add_f32 v228, v228, v78
    v_add_f32 v228, v228, v79
    v_mfma_f32_32x32x16_bf16 v[112:127], a[212:215], v[44:47], v[112:127]
    v_cvt_pk_bf16_f32 v135, v78, v79
    v_exp_f32 v88, v88
    v_mfma_f32_32x32x16_bf16 v[96:111], a[216:219], v[48:51], v[96:111]
    s_mov_b32 m0, s43
    s_add_u32 s43, s43, 16384
    buffer_load_dwordx4 v207, s[12:15], s42 offen offset:1024 lds
    v_exp_f32 v89, v89
    v_add_f32 v229, v229, v88
    v_mfma_f32_32x32x16_bf16 v[112:127], a[216:219], v[56:59], v[112:127]
    v_add_f32 v229, v229, v89
    v_cvt_pk_bf16_f32 v140, v88, v89
    v_mfma_f32_32x32x16_bf16 v[96:111], a[220:223], v[52:55], v[96:111]
    v_exp_f32 v90, v90
    v_exp_f32 v91, v91
    v_mfma_f32_32x32x16_bf16 v[112:127], a[220:223], v[60:63], v[112:127]
    v_add_f32 v229, v229, v90
    v_add_f32 v229, v229, v91
    v_cvt_pk_bf16_f32 v141, v90, v91
    s_waitcnt lgkmcnt(0)
    v_mfma_f32_32x32x16_bf16 a[0:15], a[224:227], v[128:131], a[0:15]
    s_mul_i32 s42, s41, 229376
    s_mov_b32 m0, s43
    s_add_u32 s41, s41, 1
    buffer_load_dwordx4 v207, s[12:15], s42 offen lds
    v_exp_f32 v92, v92
    v_exp_f32 v93, v93
    v_add_f32 v229, v229, v92
    v_mfma_f32_32x32x16_bf16 a[16:31], a[224:227], v[136:139], a[16:31]
    v_add_f32 v229, v229, v93
    v_cvt_pk_bf16_f32 v142, v92, v93
    v_exp_f32 v94, v94
    v_mfma_f32_32x32x16_bf16 a[32:47], a[228:231], v[128:131], a[32:47]
    v_exp_f32 v95, v95
    v_add_f32 v229, v229, v94
    v_add_f32 v229, v229, v95
    v_cvt_pk_bf16_f32 v143, v94, v95
    v_mfma_f32_32x32x16_bf16 a[48:63], a[228:231], v[136:139], a[48:63]
    s_add_u32 m0, s43, 8192
    s_and_b32 s41, s41, 7
    buffer_load_dwordx4 v207, s[16:19], s42 offen lds
    v_exp_f32 v96, v96
    v_exp_f32 v97, v97
    v_mfma_f32_32x32x16_bf16 a[64:79], a[232:235], v[128:131], a[64:79]
    v_add_f32 v228, v228, v96
    v_add_f32 v228, v228, v97
    v_cvt_pk_bf16_f32 v144, v96, v97
    v_mfma_f32_32x32x16_bf16 a[80:95], a[232:235], v[136:139], a[80:95]
    v_exp_f32 v98, v98
    v_exp_f32 v99, v99
    v_mfma_f32_32x32x16_bf16 a[96:111], a[236:239], v[128:131], a[96:111]
    v_add_f32 v228, v228, v98
    v_add_f32 v228, v228, v99
    v_cvt_pk_bf16_f32 v145, v98, v99
    v_exp_f32 v100, v100
    v_mfma_f32_32x32x16_bf16 a[112:127], a[236:239], v[136:139], a[112:127]
    s_add_u32 m0, s43, 8192
    s_add_u32 s42, s42, 27648
    buffer_load_dwordx4 v207, s[16:19], s42 offen offset:1024 lds
    v_exp_f32 v101, v101
    v_add_f32 v228, v228, v100
    v_mfma_f32_32x32x16_bf16 a[0:15], a[240:243], v[132:135], a[0:15]
    v_add_f32 v228, v228, v101
    v_cvt_pk_bf16_f32 v146, v100, v101
    v_exp_f32 v102, v102
    v_mfma_f32_32x32x16_bf16 a[16:31], a[240:243], v[140:143], a[16:31]
    v_exp_f32 v103, v103
    v_add_f32 v228, v228, v102
    v_mfma_f32_32x32x16_bf16 a[32:47], a[244:247], v[132:135], a[32:47]
    v_add_f32 v228, v228, v103
    v_cvt_pk_bf16_f32 v147, v102, v103
    v_exp_f32 v112, v112
    v_mfma_f32_32x32x16_bf16 a[48:63], a[244:247], v[140:143], a[48:63]
    s_mov_b32 m0, s43
    s_add_u32 s43, s43, 16384
    buffer_load_dwordx4 v207, s[12:15], s42 offen offset:1024 lds
    v_exp_f32 v113, v113
    v_add_f32 v229, v229, v112
    v_add_f32 v229, v229, v113
    v_mfma_f32_32x32x16_bf16 a[64:79], a[248:251], v[132:135], a[64:79]
    v_cvt_pk_bf16_f32 v152, v112, v113
    v_exp_f32 v114, v114
    v_mfma_f32_32x32x16_bf16 a[80:95], a[248:251], v[140:143], a[80:95]
    v_exp_f32 v115, v115
    v_add_f32 v229, v229, v114
    v_add_f32 v229, v229, v115
    v_mfma_f32_32x32x16_bf16 a[96:111], a[252:255], v[132:135], a[96:111]
    v_cvt_pk_bf16_f32 v153, v114, v115
    v_exp_f32 v116, v116
    v_exp_f32 v117, v117
    v_mfma_f32_32x32x16_bf16 a[112:127], a[252:255], v[140:143], a[112:127]
    v_add_f32 v229, v229, v116
    v_add_f32 v229, v229, v117
    v_cvt_pk_bf16_f32 v154, v116, v117
    s_waitcnt vmcnt(16) lgkmcnt(14)
    s_barrier
    ds_read_b64_tr_b16 a[224:225], v218 offset:49152
    ds_read_b64_tr_b16 a[226:227], v218 offset:51200
    ds_read_b64_tr_b16 a[228:229], v219 offset:49152
    ds_read_b64_tr_b16 a[230:231], v219 offset:51200
    ds_read_b64_tr_b16 a[232:233], v220 offset:49152
    ds_read_b64_tr_b16 a[234:235], v220 offset:51200
    ds_read_b64_tr_b16 a[236:237], v221 offset:49152
    ds_read_b64_tr_b16 a[238:239], v221 offset:51200
    ds_read_b64_tr_b16 a[240:241], v218 offset:53248
    ds_read_b64_tr_b16 a[242:243], v218 offset:55296
    ds_read_b64_tr_b16 a[244:245], v219 offset:53248
    ds_read_b64_tr_b16 a[246:247], v219 offset:55296
    ds_read_b64_tr_b16 a[248:249], v220 offset:53248
    ds_read_b64_tr_b16 a[250:251], v220 offset:55296
    ds_read_b64_tr_b16 a[252:253], v221 offset:53248
    ds_read_b64_tr_b16 a[254:255], v221 offset:55296
    v_exp_f32 v118, v118
    v_exp_f32 v119, v119
    v_add_f32 v229, v229, v118
    v_add_f32 v229, v229, v119
    v_cvt_pk_bf16_f32 v155, v118, v119
    v_exp_f32 v104, v104
    v_exp_f32 v105, v105
    v_add_f32 v228, v228, v104
    v_add_f32 v228, v228, v105
    v_cvt_pk_bf16_f32 v148, v104, v105
    v_exp_f32 v106, v106
    v_exp_f32 v107, v107
    v_add_f32 v228, v228, v106
    v_add_f32 v228, v228, v107
    v_cvt_pk_bf16_f32 v149, v106, v107
    v_exp_f32 v108, v108
    v_exp_f32 v109, v109
    v_add_f32 v228, v228, v108
    v_add_f32 v228, v228, v109
    v_cvt_pk_bf16_f32 v150, v108, v109
    v_exp_f32 v110, v110
    v_exp_f32 v111, v111
    v_add_f32 v228, v228, v110
    v_add_f32 v228, v228, v111
    v_cvt_pk_bf16_f32 v151, v110, v111
    v_exp_f32 v120, v120
    v_exp_f32 v121, v121
    v_add_f32 v229, v229, v120
    v_add_f32 v229, v229, v121
    v_cvt_pk_bf16_f32 v156, v120, v121
    v_exp_f32 v122, v122
    v_exp_f32 v123, v123
    v_add_f32 v229, v229, v122
    v_add_f32 v229, v229, v123
    v_cvt_pk_bf16_f32 v157, v122, v123
    s_nop 1
    s_waitcnt lgkmcnt(0)
    v_mfma_f32_32x32x16_bf16 a[0:15], a[224:227], v[144:147], a[0:15]
    v_exp_f32 v124, v124
    v_exp_f32 v125, v125
    v_add_f32 v229, v229, v124
    v_mfma_f32_32x32x16_bf16 a[16:31], a[224:227], v[152:155], a[16:31]
    buffer_load_dwordx4 a[192:195], v208, s[20:23], s44 offen offset:0 sc1
    v_add_f32 v229, v229, v125
    v_cvt_pk_bf16_f32 v158, v124, v125
    v_exp_f32 v126, v126
    v_mfma_f32_32x32x16_bf16 a[32:47], a[228:231], v[144:147], a[32:47]
    buffer_load_dwordx4 a[196:199], v209, s[20:23], s44 offen offset:0 sc1
    v_exp_f32 v127, v127
    v_add_f32 v229, v229, v126
    v_add_f32 v229, v229, v127
    v_cvt_pk_bf16_f32 v159, v126, v127
    v_mfma_f32_32x32x16_bf16 a[48:63], a[228:231], v[152:155], a[48:63]
    ds_read_b64_tr_b16 a[128:129], v202 offset:0
    v_mov_b32 v230, v228
    v_mov_b32 v231, v229
    s_nop 1
    v_permlane32_swap_b32 v228, v230
    v_mfma_f32_32x32x16_bf16 a[64:79], a[232:235], v[144:147], a[64:79]
    buffer_load_dwordx4 a[200:203], v208, s[20:23], s44 offen offset:1024 sc1
    ds_read_b64_tr_b16 a[130:131], v202 offset:512
    v_permlane32_swap_b32 v229, v231
    v_add_f32 v228, v228, v230
    v_mfma_f32_32x32x16_bf16 a[80:95], a[232:235], v[152:155], a[80:95]
    ds_read_b64_tr_b16 a[132:133], v203 offset:0
    v_add_f32 v229, v229, v231
    v_add_f32 v231, v228, v229
    s_mov_b32 s54, 0x5d800000
    v_mfma_f32_32x32x16_bf16 a[96:111], a[236:239], v[144:147], a[96:111]
    buffer_load_dwordx4 a[204:207], v209, s[20:23], s44 offen offset:1024 sc1
    ds_read_b64_tr_b16 a[134:135], v203 offset:512
    v_cmp_ngt_f32 vcc, s54, v231
    s_nop 1
    s_cmp_lg_u64 vcc, 0
    s_cselect_b32 s55, 1, 0
    v_mov_b32 v230, s55
    v_mfma_f32_32x32x16_bf16 a[112:127], a[236:239], v[152:155], a[112:127]
    v_mov_b32 v231, 57344
    v_mov_b32 v232, s36
    v_lshl_add_u32 v232, v232, 2, v231
    ds_write_b32 v232, v230
    v_mfma_f32_32x32x16_bf16 a[0:15], a[240:243], v[148:151], a[0:15]
    buffer_load_dwordx4 a[208:211], v208, s[20:23], s44 offen offset:2048 sc1
    ds_read_b64_tr_b16 a[136:137], v202 offset:8192
    v_mfma_f32_32x32x16_bf16 a[16:31], a[240:243], v[156:159], a[16:31]
    buffer_load_dwordx4 a[212:215], v209, s[20:23], s44 offen offset:2048 sc1
    ds_read_b64_tr_b16 a[138:139], v202 offset:8704
    s_waitcnt vmcnt(6) lgkmcnt(2)
    s_barrier
    ds_read_b128 v[234:237], v231
    v_mfma_f32_32x32x16_bf16 a[32:47], a[244:247], v[148:151], a[32:47]
    ds_read_b64_tr_b16 a[140:141], v203 offset:8192
    v_rcp_f32 v238, v228
    v_mfma_f32_32x32x16_bf16 a[48:63], a[244:247], v[156:159], a[48:63]
    buffer_load_dwordx4 a[216:219], v208, s[20:23], s44 offen offset:3072 sc1
    ds_read_b64_tr_b16 a[142:143], v203 offset:8704
    v_rcp_f32 v239, v229
    s_add_u32 s56, s58, 4096
    v_mfma_f32_32x32x16_bf16 a[64:79], a[248:251], v[148:151], a[64:79]
    v_mfma_f32_32x32x16_bf16 a[80:95], a[248:251], v[156:159], a[80:95]
    buffer_load_dwordx4 a[220:223], v209, s[20:23], s44 offen offset:3072 sc1
    s_add_u32 s44, s44, 4096
    s_and_b32 s44, s44, 0x7fff
    s_waitcnt lgkmcnt(2)
    v_or_b32 v234, v234, v235
    v_or3_b32 v234, v234, v236, v237
    v_mfma_f32_32x32x16_bf16 a[96:111], a[252:255], v[148:151], a[96:111]
    v_readfirstlane_b32 s55, v234
    v_mfma_f32_32x32x16_bf16 a[112:127], a[252:255], v[156:159], a[112:127]
    s_andn2_b32 s55, s55, s48
    s_cmp_lg_u32 s55, 0
    s_cbranch_scc1 K2_SLOW
    v_mov_b32 v48, v238
    v_mov_b32 v50, v239
    s_load_dwordx2 s[60:61], s[0:1], 88
    s_load_dwordx2 s[72:73], s[0:1], 72
    s_waitcnt vmcnt(22) lgkmcnt(0)
    v_mfma_f32_32x32x16_bf16 v[64:79], a[128:131], a[160:163], 0
    buffer_load_dwordx4 a[224:227], v208, s[20:23], s44 offen offset:0 sc1
    ds_read_b64_tr_b16 a[144:145], v202 offset:2048
    ds_read_b64_tr_b16 a[146:147], v202 offset:2560
    v_accvgpr_read_b32 v0, a0
    v_accvgpr_read_b32 v1, a1
    v_accvgpr_read_b32 v2, a2
    v_accvgpr_read_b32 v3, a3
    v_mfma_f32_32x32x16_bf16 v[80:95], a[128:131], a[164:167], 0
    ds_read_b64_tr_b16 a[148:149], v203 offset:2048
    ds_read_b64_tr_b16 a[150:151], v203 offset:2560
    v_accvgpr_read_b32 v4, a4
    v_accvgpr_read_b32 v5, a5
    v_accvgpr_read_b32 v6, a6
    v_accvgpr_read_b32 v7, a7
    v_mfma_f32_32x32x16_bf16 v[96:111], a[132:135], a[160:163], 0
    buffer_load_dwordx4 a[228:231], v209, s[20:23], s44 offen offset:0 sc1
    ds_read_b64_tr_b16 a[152:153], v202 offset:10240
    ds_read_b64_tr_b16 a[154:155], v202 offset:10752
    v_mul_f32 v0, v0, v48
    v_mul_f32 v1, v1, v48
    v_mul_f32 v2, v2, v48
    v_mul_f32 v3, v3, v48
    v_mfma_f32_32x32x16_bf16 v[112:127], a[132:135], a[164:167], 0
    ds_read_b64_tr_b16 a[156:157], v203 offset:10240
    ds_read_b64_tr_b16 a[158:159], v203 offset:10752
    v_mul_f32 v4, v4, v48
    v_mul_f32 v5, v5, v48
    v_mul_f32 v6, v6, v48
    v_mul_f32 v7, v7, v48
    v_mfma_f32_32x32x16_bf16 v[128:143], a[136:139], a[160:163], 0
    v_cvt_pk_bf16_f32 v32, v0, v1
    v_cvt_pk_bf16_f32 v33, v2, v3
    v_cvt_pk_bf16_f32 v34, v4, v5
    v_cvt_pk_bf16_f32 v35, v6, v7
    v_mfma_f32_32x32x16_bf16 v[144:159], a[136:139], a[164:167], 0
    buffer_store_dwordx4 v[32:35], v225, s[32:35], s58 offen offset:0 sc1
    v_accvgpr_read_b32 v8, a8
    v_accvgpr_read_b32 v9, a9
    v_accvgpr_read_b32 v10, a10
    v_mfma_f32_32x32x16_bf16 v[160:175], a[140:143], a[160:163], 0
    v_accvgpr_read_b32 v11, a11
    v_accvgpr_read_b32 v12, a12
    v_accvgpr_read_b32 v13, a13
    v_accvgpr_read_b32 v14, a14
    v_mfma_f32_32x32x16_bf16 v[176:191], a[140:143], a[164:167], 0
    buffer_load_dwordx4 a[232:235], v208, s[20:23], s44 offen offset:1024 sc1
    v_accvgpr_read_b32 v15, a15
    v_mul_f32 v8, v8, v48
    v_mul_f32 v9, v9, v48
    s_waitcnt vmcnt(24) lgkmcnt(0)
    s_waitcnt lgkmcnt(0)
    s_add_u32 s24, s60, 33554432
    s_addc_u32 s25, s61, 0
    s_mov_b32 s26, 8388608
    s_mov_b32 s27, 0x00020000
    s_mov_b32 s28, s72
    s_mov_b32 s29, s73
    s_mov_b32 s30, 2097152
    s_mov_b32 s31, 0x00020000
    v_mfma_f32_32x32x16_bf16 v[64:79], a[144:147], a[168:171], v[64:79]
    ds_read_b64_tr_b16 a[128:129], v202 offset:4096
    ds_read_b64_tr_b16 a[130:131], v202 offset:4608
    v_mul_f32 v10, v10, v48
    v_mul_f32 v11, v11, v48
    v_mul_f32 v12, v12, v48
    v_mbcnt_lo_u32_b32 v195, -1, 0
    v_mbcnt_hi_u32_b32 v195, -1, v195
    v_mfma_f32_32x32x16_bf16 v[80:95], a[144:147], a[172:175], v[80:95]
    buffer_load_dwordx4 a[236:239], v209, s[20:23], s44 offen offset:1024 sc1
    ds_read_b64_tr_b16 a[132:133], v203 offset:4096
    ds_read_b64_tr_b16 a[134:135], v203 offset:4608
    v_mul_f32 v13, v13, v48
    v_mul_f32 v14, v14, v48
    v_mul_f32 v15, v15, v48
    v_cvt_pk_bf16_f32 v36, v8, v9
    s_and_b32 s49, s2, 3
    s_bfe_u32 s38, s2, 65545
    s_xor_b32 s38, s38, s49
    s_lshr_b32 s54, s2, 3
    s_and_b32 s48, s54, 3
    v_mfma_f32_32x32x16_bf16 v[96:111], a[148:151], a[168:171], v[96:111]
    ds_read_b64_tr_b16 a[136:137], v202 offset:12288
    ds_read_b64_tr_b16 a[138:139], v202 offset:12800
    v_cvt_pk_bf16_f32 v37, v10, v11
    v_cvt_pk_bf16_f32 v38, v12, v13
    v_cvt_pk_bf16_f32 v39, v14, v15
    s_lshr_b32 s47, s54, 2
    s_lshl_b32 s47, s47, 2
    s_and_b32 s54, s2, 4
    s_lshr_b32 s3, s2, 6
    v_mfma_f32_32x32x16_bf16 v[112:127], a[148:151], a[172:175], v[112:127]
    buffer_store_dwordx4 v[36:39], v225, s[32:35], s58 offen offset:1024 sc1
    ds_read_b64_tr_b16 a[140:141], v203 offset:12288
    ds_read_b64_tr_b16 a[142:143], v203 offset:12800
    v_accvgpr_read_b32 v16, a16
    v_accvgpr_read_b32 v17, a17
    v_accvgpr_read_b32 v18, a18
    s_add_u32 s3, s3, s54
    s_lshl_b32 s3, s3, 12
    s_lshl_b32 s54, s54, 3
    s_add_u32 s47, s47, s54
    v_mfma_f32_32x32x16_bf16 v[128:143], a[152:155], a[168:171], v[128:143]
    v_accvgpr_read_b32 v19, a19
    v_accvgpr_read_b32 v20, a20
    v_accvgpr_read_b32 v21, a21
    v_accvgpr_read_b32 v22, a22
    v_lshlrev_b32 v194, 4, v195
    v_and_b32 v230, 3, v195
    v_mfma_f32_32x32x16_bf16 v[144:159], a[152:155], a[172:175], v[144:159]
    buffer_load_dwordx4 a[240:243], v208, s[20:23], s44 offen offset:2048 sc1
    v_accvgpr_read_b32 v23, a23
    v_mul_f32 v16, v16, v50
    v_mul_f32 v17, v17, v50
    v_bfe_u32 v231, v195, 2, 1
    v_lshl_add_u32 v230, v230, 3, v231
    s_lshl_b32 s54, s49, 1
    v_mfma_f32_32x32x16_bf16 v[160:175], a[156:159], a[168:171], v[160:175]
    v_mul_f32 v18, v18, v50
    v_mul_f32 v19, v19, v50
    v_mul_f32 v20, v20, v50
    v_add_u32 v230, s54, v230
    v_lshlrev_b32 v227, 7, v230
    v_mfma_f32_32x32x16_bf16 v[176:191], a[156:159], a[172:175], v[176:191]
    buffer_load_dwordx4 a[244:247], v209, s[20:23], s44 offen offset:2048 sc1
    v_mul_f32 v21, v21, v50
    v_mul_f32 v22, v22, v50
    v_mul_f32 v23, v23, v50
    v_cvt_pk_bf16_f32 v40, v16, v17
    v_lshrrev_b32 v230, 4, v195
    v_and_b32 v231, 15, v195
    s_waitcnt vmcnt(26) lgkmcnt(0)
    v_mfma_f32_32x32x16_bf16 v[64:79], a[128:131], a[176:179], v[64:79]
    ds_read_b64_tr_b16 a[144:145], v202 offset:6144
    ds_read_b64_tr_b16 a[146:147], v202 offset:6656
    v_cvt_pk_bf16_f32 v41, v18, v19
    v_cvt_pk_bf16_f32 v42, v20, v21
    v_cvt_pk_bf16_f32 v43, v22, v23
    v_lshlrev_b32 v232, 2, v230
    v_xor_b32 v231, v231, v232
    v_lshlrev_b32 v231, 4, v231
    v_mfma_f32_32x32x16_bf16 v[80:95], a[128:131], a[180:183], v[80:95]
    buffer_store_dwordx4 v[40:43], v226, s[32:35], s58 offen offset:0 sc1
    ds_read_b64_tr_b16 a[148:149], v203 offset:6144
    ds_read_b64_tr_b16 a[150:151], v203 offset:6656
    v_accvgpr_read_b32 v24, a24
    v_accvgpr_read_b32 v25, a25
    v_accvgpr_read_b32 v26, a26
    v_lshl_add_u32 v192, v230, 10, v231
    s_lshl_b32 s54, s36, 12
    s_lshl_b32 s55, s48, 8
    v_mfma_f32_32x32x16_bf16 v[96:111], a[132:135], a[176:179], v[96:111]
    ds_read_b64_tr_b16 a[152:153], v202 offset:14336
    ds_read_b64_tr_b16 a[154:155], v202 offset:14848
    v_accvgpr_read_b32 v27, a27
    v_accvgpr_read_b32 v28, a28
    v_accvgpr_read_b32 v29, a29
    v_accvgpr_read_b32 v30, a30
    s_add_u32 s54, s54, s55
    v_add_u32 v192, s54, v192
    s_add_u32 s54, s47, s36
    v_mfma_f32_32x32x16_bf16 v[112:127], a[132:135], a[180:183], v[112:127]
    buffer_load_dwordx4 a[248:251], v208, s[20:23], s44 offen offset:3072 sc1
    ds_read_b64_tr_b16 a[156:157], v203 offset:14336
    ds_read_b64_tr_b16 a[158:159], v203 offset:14848
    v_accvgpr_read_b32 v31, a31
    v_mul_f32 v24, v24, v50
    v_mul_f32 v25, v25, v50
    s_mul_i32 s54, s54, 376832
    v_add_u32 v193, s54, v194
    s_lshl_b32 s45, s49, 20
    v_mfma_f32_32x32x16_bf16 v[128:143], a[136:139], a[176:179], v[128:143]
    v_mul_f32 v26, v26, v50
    v_mul_f32 v27, v27, v50
    v_mul_f32 v28, v28, v50
    s_lshl_b32 s46, s49, 16
    s_mul_i32 s54, s48, 0
    s_lshr_b32 s55, s2, 5
    s_mul_i32 s55, s55, 0
    s_add_u32 s54, s54, s55
    v_mfma_f32_32x32x16_bf16 v[144:159], a[136:139], a[180:183], v[144:159]
    buffer_load_dwordx4 a[252:255], v209, s[20:23], s44 offen offset:3072 sc1
    s_add_u32 s44, s44, 4096
    s_and_b32 s44, s44, 0x7fff
    v_mul_f32 v29, v29, v50
    v_mul_f32 v30, v30, v50
    v_mul_f32 v31, v31, v50
    v_cvt_pk_bf16_f32 v44, v24, v25
    s_and_b32 s54, s54, 15
    s_lshl_b32 s55, s54, 16
    s_or_b32 s45, s45, s55
    s_lshl_b32 s55, s54, 12
    v_mfma_f32_32x32x16_bf16 v[160:175], a[140:143], a[176:179], v[160:175]
    v_cvt_pk_bf16_f32 v45, v26, v27
    v_cvt_pk_bf16_f32 v46, v28, v29
    v_cvt_pk_bf16_f32 v47, v30, v31
    s_or_b32 s46, s46, s55
    v_lshrrev_b32 v230, 5, v195
    v_bfe_u32 v231, v195, 2, 2
    v_mfma_f32_32x32x16_bf16 v[176:191], a[140:143], a[180:183], v[176:191]
    buffer_store_dwordx4 v[44:47], v226, s[32:35], s58 offen offset:1024 sc1
    v_accvgpr_read_b32 v0, a32
    v_accvgpr_read_b32 v1, a33
    v_accvgpr_read_b32 v2, a34
    v_bfe_u32 v232, v195, 4, 1
    v_and_b32 v233, 3, v195
    s_waitcnt vmcnt(28) lgkmcnt(0)
    v_mfma_f32_32x32x16_bf16 v[64:79], a[144:147], a[184:187], v[64:79]
    ds_read_b64_tr_b16 a[128:129], v202 offset:16384
    ds_read_b64_tr_b16 a[130:131], v202 offset:16896
    v_accvgpr_read_b32 v3, a35
    v_accvgpr_read_b32 v4, a36
    v_accvgpr_read_b32 v5, a37
    v_accvgpr_read_b32 v6, a38
    v_and_b32 v234, 1, v233
    v_lshrrev_b32 v235, 1, v233
    v_mfma_f32_32x32x16_bf16 v[80:95], a[144:147], a[188:191], v[80:95]
    buffer_load_dwordx4 a[160:163], v208, s[20:23], s44 offen offset:0 sc1
    ds_read_b64_tr_b16 a[132:133], v203 offset:16384
    ds_read_b64_tr_b16 a[134:135], v203 offset:16896
    v_accvgpr_read_b32 v7, a39
    v_mul_f32 v0, v0, v48
    v_mul_f32 v1, v1, v48
    v_lshl_add_u32 v234, v234, 1, v235
    v_lshlrev_b32 v235, 5, v232
    v_mfma_f32_32x32x16_bf16 v[96:111], a[148:151], a[184:187], v[96:111]
    ds_read_b64_tr_b16 a[136:137], v202 offset:24576
    ds_read_b64_tr_b16 a[138:139], v202 offset:25088
    v_mul_f32 v2, v2, v48
    v_mul_f32 v3, v3, v48
    v_mul_f32 v4, v4, v48
    v_lshl_add_u32 v234, v234, 3, v235
    v_lshl_add_u32 v235, v230, 2, v231
    v_lshl_add_u32 v236, v235, 8, v234
    v_mfma_f32_32x32x16_bf16 v[112:127], a[148:151], a[188:191], v[112:127]
    buffer_load_dwordx4 a[164:167], v209, s[20:23], s44 offen offset:0 sc1
    ds_read_b64_tr_b16 a[140:141], v203 offset:24576
    ds_read_b64_tr_b16 a[142:143], v203 offset:25088
    v_mul_f32 v5, v5, v48
    v_mul_f32 v6, v6, v48
    v_mul_f32 v7, v7, v48
    v_cvt_pk_bf16_f32 v32, v0, v1
    s_and_b32 s54, s36, 1
    s_lshl_b32 s54, s54, 1
    v_xor_b32 v237, s54, v231
    v_mfma_f32_32x32x16_bf16 v[128:143], a[152:155], a[184:187], v[128:143]
    v_cvt_pk_bf16_f32 v33, v2, v3
    v_cvt_pk_bf16_f32 v34, v4, v5
    v_cvt_pk_bf16_f32 v35, v6, v7
    v_lshl_add_u32 v210, v237, 6, v236
    v_xor_b32 v237, 1, v237
    v_mfma_f32_32x32x16_bf16 v[144:159], a[152:155], a[188:191], v[144:159]
    buffer_store_dwordx4 v[32:35], v225, s[32:35], s58 offen offset:2048 sc1
    v_accvgpr_read_b32 v8, a40
    v_accvgpr_read_b32 v9, a41
    v_accvgpr_read_b32 v10, a42
    v_lshl_add_u32 v211, v237, 6, v236
    v_add_u32 v212, 0x10000, v210
    v_mfma_f32_32x32x16_bf16 v[160:175], a[156:159], a[184:187], v[160:175]
    v_accvgpr_read_b32 v11, a43
    v_accvgpr_read_b32 v12, a44
    v_accvgpr_read_b32 v13, a45
    v_accvgpr_read_b32 v14, a46
    v_add_u32 v213, 0x10000, v211
    v_add_u32 v214, 0x20000, v210
    v_mfma_f32_32x32x16_bf16 v[176:191], a[156:159], a[188:191], v[176:191]
    buffer_load_dwordx4 a[168:171], v208, s[20:23], s44 offen offset:1024 sc1
    v_accvgpr_read_b32 v15, a47
    v_mul_f32 v8, v8, v48
    v_mul_f32 v9, v9, v48
    v_add_u32 v215, 0x20000, v211
    s_and_b32 s54, s36, 2
    s_lshl_b32 s54, s54, 12
    s_waitcnt vmcnt(22) lgkmcnt(0)
    v_mfma_f32_32x32x16_bf16 v[64:79], a[128:131], a[192:195], v[64:79]
    ds_read_b64_tr_b16 a[144:145], v202 offset:18432
    ds_read_b64_tr_b16 a[146:147], v202 offset:18944
    v_mul_f32 v10, v10, v48
    v_mul_f32 v11, v11, v48
    v_mul_f32 v12, v12, v48
    v_add_u32 v196, s54, v194
    v_add_u32 v197, 0x10000, v196
    v_add_u32 v198, 0x20000, v196
    v_mfma_f32_32x32x16_bf16 v[80:95], a[128:131], a[196:199], v[80:95]
    buffer_load_dwordx4 a[172:175], v209, s[20:23], s44 offen offset:1024 sc1
    ds_read_b64_tr_b16 a[148:149], v203 offset:18432
    ds_read_b64_tr_b16 a[150:151], v203 offset:18944
    v_mul_f32 v13, v13, v48
    v_mul_f32 v14, v14, v48
    v_mul_f32 v15, v15, v48
    v_cvt_pk_bf16_f32 v36, v8, v9
    s_lshl_b32 s75, s36, 14
    s_add_u32 s75, s75, 65536
    v_lshl_add_u32 v236, v235, 7, v234
    v_mfma_f32_32x32x16_bf16 v[96:111], a[132:135], a[192:195], v[96:111]
    ds_read_b64_tr_b16 a[152:153], v202 offset:26624
    ds_read_b64_tr_b16 a[154:155], v202 offset:27136
    v_cvt_pk_bf16_f32 v37, v10, v11
    v_cvt_pk_bf16_f32 v38, v12, v13
    v_cvt_pk_bf16_f32 v39, v14, v15
    v_add_u32 v236, s75, v236
    v_lshrrev_b32 v237, 1, v231
    v_mfma_f32_32x32x16_bf16 v[112:127], a[132:135], a[196:199], v[112:127]
    buffer_store_dwordx4 v[36:39], v225, s[32:35], s58 offen offset:3072 sc1
    ds_read_b64_tr_b16 a[156:157], v203 offset:26624
    ds_read_b64_tr_b16 a[158:159], v203 offset:27136
    v_accvgpr_read_b32 v16, a48
    v_accvgpr_read_b32 v17, a49
    v_accvgpr_read_b32 v18, a50
    v_lshl_add_u32 v220, v237, 6, v236
    v_xor_b32 v237, 1, v237
    v_mfma_f32_32x32x16_bf16 v[128:143], a[136:139], a[192:195], v[128:143]
    v_accvgpr_read_b32 v19, a51
    v_accvgpr_read_b32 v20, a52
    v_accvgpr_read_b32 v21, a53
    v_accvgpr_read_b32 v22, a54
    v_lshl_add_u32 v221, v237, 6, v236
    v_subrev_u32 v222, 0x10000, v220
    v_mfma_f32_32x32x16_bf16 v[144:159], a[136:139], a[196:199], v[144:159]
    buffer_load_dwordx4 a[176:179], v208, s[20:23], s44 offen offset:2048 sc1
    v_accvgpr_read_b32 v23, a55
    v_mul_f32 v16, v16, v50
    v_mul_f32 v17, v17, v50
    v_subrev_u32 v223, 0x10000, v221
    s_sub_u32 s54, s75, s100
    v_subrev_u32 v238, s54, v220
    v_mfma_f32_32x32x16_bf16 v[160:175], a[140:143], a[192:195], v[160:175]
    v_mul_f32 v18, v18, v50
    v_mul_f32 v19, v19, v50
    v_mul_f32 v20, v20, v50
    v_subrev_u32 v239, s54, v221
    v_add_u32 v240, 0x10000, v238
    v_mfma_f32_32x32x16_bf16 v[176:191], a[140:143], a[196:199], v[176:191]
    buffer_load_dwordx4 a[180:183], v209, s[20:23], s44 offen offset:2048 sc1
    v_mul_f32 v21, v21, v50
    v_mul_f32 v22, v22, v50
    v_mul_f32 v23, v23, v50
    v_cvt_pk_bf16_f32 v40, v16, v17
    v_add_u32 v241, 0x10000, v239
    v_add_u32 v242, 0x20000, v238
    s_waitcnt vmcnt(24) lgkmcnt(0)
    v_mfma_f32_32x32x16_bf16 v[64:79], a[144:147], a[200:203], v[64:79]
    ds_read_b64_tr_b16 a[128:129], v202 offset:20480
    ds_read_b64_tr_b16 a[130:131], v202 offset:20992
    v_cvt_pk_bf16_f32 v41, v18, v19
    v_cvt_pk_bf16_f32 v42, v20, v21
    v_cvt_pk_bf16_f32 v43, v22, v23
    v_add_u32 v243, 0x20000, v239
    s_mul_i32 s73, s36, 458752
    s_mul_i32 s74, s36, 28672
    s_add_u32 s74, s74, 262144
    v_mfma_f32_32x32x16_bf16 v[80:95], a[144:147], a[204:207], v[80:95]
    buffer_store_dwordx4 v[40:43], v226, s[32:35], s58 offen offset:2048 sc1
    ds_read_b64_tr_b16 a[132:133], v203 offset:20480
    ds_read_b64_tr_b16 a[134:135], v203 offset:20992
    v_accvgpr_read_b32 v24, a56
    v_accvgpr_read_b32 v25, a57
    v_accvgpr_read_b32 v26, a58
    s_add_u32 s41, s73, 458752
    s_add_u32 s43, s74, 28672
    s_mul_i32 s54, s48, 0
    s_bfe_u32 s55, s2, 0x20006
    s_mul_i32 s55, s55, 0
    v_mfma_f32_32x32x16_bf16 v[96:111], a[148:151], a[200:203], v[96:111]
    ds_read_b64_tr_b16 a[136:137], v202 offset:28672
    ds_read_b64_tr_b16 a[138:139], v202 offset:29184
    v_accvgpr_read_b32 v27, a59
    v_accvgpr_read_b32 v28, a60
    v_accvgpr_read_b32 v29, a61
    v_accvgpr_read_b32 v30, a62
    s_add_u32 s54, s54, s55
    s_lshl_b32 s55, s54, 14
    s_add_u32 s73, s73, s55
    s_lshl_b32 s55, s54, 10
    v_mfma_f32_32x32x16_bf16 v[112:127], a[148:151], a[204:207], v[112:127]
    buffer_load_dwordx4 a[184:187], v208, s[20:23], s44 offen offset:3072 sc1
    ds_read_b64_tr_b16 a[140:141], v203 offset:28672
    ds_read_b64_tr_b16 a[142:143], v203 offset:29184
    v_accvgpr_read_b32 v31, a63
    v_mul_f32 v24, v24, v50
    v_mul_f32 v25, v25, v50
    s_add_u32 s74, s74, s55
    s_and_b32 s55, s38, 2
    s_add_u32 s55, s55, s47
    s_mul_i32 s54, s55, 376832
    v_mfma_f32_32x32x16_bf16 v[128:143], a[152:155], a[200:203], v[128:143]
    v_mul_f32 v26, v26, v50
    v_mul_f32 v27, v27, v50
    v_mul_f32 v28, v28, v50
    v_add_u32 v216, s54, v194
    v_add_u32 v217, 376832, v216
    s_lshr_b32 s54, s36, 1
    v_mfma_f32_32x32x16_bf16 v[144:159], a[152:155], a[204:207], v[144:159]
    buffer_load_dwordx4 a[188:191], v209, s[20:23], s44 offen offset:3072 sc1
    s_add_u32 s44, s44, 4096
    s_and_b32 s44, s44, 0x7fff
    v_mul_f32 v29, v29, v50
    v_mul_f32 v30, v30, v50
    v_mul_f32 v31, v31, v50
    v_cvt_pk_bf16_f32 v44, v24, v25
    s_add_u32 s54, s54, s55
    s_lshl_b32 s54, s54, 15
    s_and_b32 s55, s36, 1
    s_lshl_b32 s55, s55, 6
    v_mfma_f32_32x32x16_bf16 v[160:175], a[156:159], a[200:203], v[160:175]
    v_cvt_pk_bf16_f32 v45, v26, v27
    v_cvt_pk_bf16_f32 v46, v28, v29
    v_cvt_pk_bf16_f32 v47, v30, v31
    s_add_u32 s54, s54, s55
    s_lshl_b32 s55, s48, 8
    s_and_b32 s50, s38, 1
    s_lshl_b32 s50, s50, 7
    s_add_u32 s55, s55, s50
    v_mfma_f32_32x32x16_bf16 v[176:191], a[156:159], a[204:207], v[176:191]
    buffer_store_dwordx4 v[44:47], v226, s[32:35], s58 offen offset:3072 sc1
    v_accvgpr_read_b32 v0, a64
    v_accvgpr_read_b32 v1, a65
    v_accvgpr_read_b32 v2, a66
    s_add_u32 s54, s54, s55
    v_and_b32 v236, 31, v195
    s_waitcnt vmcnt(26) lgkmcnt(0)
    v_mfma_f32_32x32x16_bf16 v[64:79], a[128:131], a[208:211], v[64:79]
    ds_read_b64_tr_b16 a[144:145], v202 offset:22528
    ds_read_b64_tr_b16 a[146:147], v202 offset:23040
    v_accvgpr_read_b32 v3, a67
    v_accvgpr_read_b32 v4, a68
    v_accvgpr_read_b32 v5, a69
    v_accvgpr_read_b32 v6, a70
    v_lshlrev_b32 v236, 10, v236
    v_lshl_add_u32 v236, v230, 4, v236
    v_add_u32 v199, s54, v236
    v_mfma_f32_32x32x16_bf16 v[80:95], a[128:131], a[212:215], v[80:95]
    buffer_load_dwordx4 a[192:195], v208, s[20:23], s44 offen offset:0 sc1
    ds_read_b64_tr_b16 a[148:149], v203 offset:22528
    ds_read_b64_tr_b16 a[150:151], v203 offset:23040
    v_accvgpr_read_b32 v7, a71
    v_mul_f32 v0, v0, v48
    v_mul_f32 v1, v1, v48
    v_lshrrev_b32 v236, 3, v195
    v_and_b32 v237, 7, v195
    v_mfma_f32_32x32x16_bf16 v[96:111], a[132:135], a[208:211], v[96:111]
    ds_read_b64_tr_b16 a[152:153], v202 offset:30720
    ds_read_b64_tr_b16 a[154:155], v202 offset:31232
    v_mul_f32 v2, v2, v48
    v_mul_f32 v3, v3, v48
    v_mul_f32 v4, v4, v48
    v_lshlrev_b32 v235, 2, v232
    v_xor_b32 v237, v237, v235
    v_mfma_f32_32x32x16_bf16 v[112:127], a[132:135], a[212:215], v[112:127]
    buffer_load_dwordx4 a[196:199], v209, s[20:23], s44 offen offset:0 sc1
    ds_read_b64_tr_b16 a[156:157], v203 offset:30720
    ds_read_b64_tr_b16 a[158:159], v203 offset:31232
    v_mul_f32 v5, v5, v48
    v_mul_f32 v6, v6, v48
    v_mul_f32 v7, v7, v48
    v_cvt_pk_bf16_f32 v32, v0, v1
    v_lshlrev_b32 v237, 4, v237
    v_lshl_add_u32 v218, v236, 10, v237
    v_mfma_f32_32x32x16_bf16 v[128:143], a[136:139], a[208:211], v[128:143]
    v_cvt_pk_bf16_f32 v33, v2, v3
    v_cvt_pk_bf16_f32 v34, v4, v5
    v_cvt_pk_bf16_f32 v35, v6, v7
    v_add_u32 v218, s55, v218
    v_add_u32 v219, 7168, v218
    s_lshr_b32 s54, s2, 2
    v_mfma_f32_32x32x16_bf16 v[144:159], a[136:139], a[212:215], v[144:159]
    buffer_store_dwordx4 v[32:35], v225, s[32:35], s56 offen offset:0 sc1
    v_accvgpr_read_b32 v8, a72
    v_accvgpr_read_b32 v9, a73
    v_accvgpr_read_b32 v10, a74
    s_lshl_b32 s50, s54, 11
    s_add_u32 s50, s50, 65536
    s_lshl_b32 s54, s54, 17
    s_lshl_b32 s55, s36, 15
    v_mfma_f32_32x32x16_bf16 v[160:175], a[140:143], a[208:211], v[160:175]
    v_accvgpr_read_b32 v11, a75
    v_accvgpr_read_b32 v12, a76
    v_accvgpr_read_b32 v13, a77
    v_accvgpr_read_b32 v14, a78
    s_add_u32 s59, s54, s55
    s_lshl_b32 s55, s49, 13
    s_add_u32 s59, s59, s55
    s_lshl_b32 s55, s38, 15
    s_add_u32 s54, s54, s55
    v_mfma_f32_32x32x16_bf16 v[176:191], a[140:143], a[212:215], v[176:191]
    buffer_load_dwordx4 a[200:203], v208, s[20:23], s44 offen offset:1024 sc1
    v_accvgpr_read_b32 v15, a79
    v_mul_f32 v8, v8, v48
    v_mul_f32 v9, v9, v48
    s_lshl_b32 s55, s36, 11
    s_add_u32 s72, s54, s55
    s_cmp_eq_u32 s36, s38
    s_cselect_b32 s59, 0x40000000, s59
    s_waitcnt lgkmcnt(0)
    s_barrier
    s_waitcnt vmcnt(28) lgkmcnt(0)
    v_mfma_f32_32x32x16_bf16 v[64:79], a[144:147], a[216:219], v[64:79]
    ds_read_b64_tr_b16 a[128:129], v202 offset:32768
    ds_read_b64_tr_b16 a[130:131], v202 offset:33280
    v_mul_f32 v10, v10, v48
    v_mul_f32 v11, v11, v48
    v_mul_f32 v12, v12, v48
    v_mfma_f32_32x32x16_bf16 v[80:95], a[144:147], a[220:223], v[80:95]
    buffer_load_dwordx4 a[204:207], v209, s[20:23], s44 offen offset:1024 sc1
    ds_read_b64_tr_b16 a[132:133], v203 offset:32768
    ds_read_b64_tr_b16 a[134:135], v203 offset:33280
    v_mul_f32 v13, v13, v48
    v_mul_f32 v14, v14, v48
    v_mul_f32 v15, v15, v48
    v_cvt_pk_bf16_f32 v36, v8, v9
    v_mfma_f32_32x32x16_bf16 v[96:111], a[148:151], a[216:219], v[96:111]
    ds_read_b64_tr_b16 a[136:137], v202 offset:40960
    ds_read_b64_tr_b16 a[138:139], v202 offset:41472
    v_cvt_pk_bf16_f32 v37, v10, v11
    v_cvt_pk_bf16_f32 v38, v12, v13
    v_cvt_pk_bf16_f32 v39, v14, v15
    v_mfma_f32_32x32x16_bf16 v[112:127], a[148:151], a[220:223], v[112:127]
    buffer_store_dwordx4 v[36:39], v225, s[32:35], s56 offen offset:1024 sc1
    ds_read_b64_tr_b16 a[140:141], v203 offset:40960
    ds_read_b64_tr_b16 a[142:143], v203 offset:41472
    v_accvgpr_read_b32 v16, a80
    v_accvgpr_read_b32 v17, a81
    v_accvgpr_read_b32 v18, a82
    v_mfma_f32_32x32x16_bf16 v[128:143], a[152:155], a[216:219], v[128:143]
    v_accvgpr_read_b32 v19, a83
    v_accvgpr_read_b32 v20, a84
    v_accvgpr_read_b32 v21, a85
    v_accvgpr_read_b32 v22, a86
    v_and_b32 v252, 0x380, v252
    v_mfma_f32_32x32x16_bf16 v[144:159], a[152:155], a[220:223], v[144:159]
    buffer_load_dwordx4 a[208:211], v208, s[20:23], s44 offen offset:2048 sc1
    v_accvgpr_read_b32 v23, a87
    v_mul_f32 v16, v16, v50
    v_mul_f32 v17, v17, v50
    v_lshlrev_b32 v252, 3, v252
    v_mfma_f32_32x32x16_bf16 v[160:175], a[156:159], a[216:219], v[160:175]
    v_mul_f32 v18, v18, v50
    v_mul_f32 v19, v19, v50
    v_mul_f32 v20, v20, v50
    v_add_u32 v252, 384, v252
    v_mfma_f32_32x32x16_bf16 v[176:191], a[156:159], a[220:223], v[176:191]
    buffer_load_dwordx4 a[212:215], v209, s[20:23], s44 offen offset:2048 sc1
    v_mul_f32 v21, v21, v50
    v_mul_f32 v22, v22, v50
    v_mul_f32 v23, v23, v50
    v_cvt_pk_bf16_f32 v40, v16, v17
    s_waitcnt vmcnt(30) lgkmcnt(0)
    v_mfma_f32_32x32x16_bf16 v[64:79], a[128:131], a[224:227], v[64:79]
    ds_read_b64_tr_b16 a[144:145], v202 offset:34816
    ds_read_b64_tr_b16 a[146:147], v202 offset:35328
    v_cvt_pk_bf16_f32 v41, v18, v19
    v_cvt_pk_bf16_f32 v42, v20, v21
    v_cvt_pk_bf16_f32 v43, v22, v23
    v_mfma_f32_32x32x16_bf16 v[80:95], a[128:131], a[228:231], v[80:95]
    buffer_store_dwordx4 v[40:43], v226, s[32:35], s56 offen offset:0 sc1
    ds_read_b64_tr_b16 a[148:149], v203 offset:34816
    ds_read_b64_tr_b16 a[150:151], v203 offset:35328
    v_accvgpr_read_b32 v24, a88
    v_accvgpr_read_b32 v25, a89
    v_accvgpr_read_b32 v26, a90
    v_mfma_f32_32x32x16_bf16 v[96:111], a[132:135], a[224:227], v[96:111]
    ds_read_b64_tr_b16 a[152:153], v202 offset:43008
    ds_read_b64_tr_b16 a[154:155], v202 offset:43520
    v_accvgpr_read_b32 v27, a91
    v_accvgpr_read_b32 v28, a92
    v_accvgpr_read_b32 v29, a93
    v_accvgpr_read_b32 v30, a94
    v_mfma_f32_32x32x16_bf16 v[112:127], a[132:135], a[228:231], v[112:127]
    buffer_load_dwordx4 a[216:219], v208, s[20:23], s44 offen offset:3072 sc1
    ds_read_b64_tr_b16 a[156:157], v203 offset:43008
    ds_read_b64_tr_b16 a[158:159], v203 offset:43520
    v_accvgpr_read_b32 v31, a95
    v_mul_f32 v24, v24, v50
    v_mul_f32 v25, v25, v50
    v_mfma_f32_32x32x16_bf16 v[128:143], a[136:139], a[224:227], v[128:143]
    v_mul_f32 v26, v26, v50
    v_mul_f32 v27, v27, v50
    v_mul_f32 v28, v28, v50
    v_mfma_f32_32x32x16_bf16 v[144:159], a[136:139], a[228:231], v[144:159]
    buffer_load_dwordx4 a[220:223], v209, s[20:23], s44 offen offset:3072 sc1
    s_add_u32 s44, s44, 4096
    s_and_b32 s44, s44, 0x7fff
    v_mul_f32 v29, v29, v50
    v_mul_f32 v30, v30, v50
    v_mul_f32 v31, v31, v50
    v_cvt_pk_bf16_f32 v44, v24, v25
    v_mfma_f32_32x32x16_bf16 v[160:175], a[140:143], a[224:227], v[160:175]
    v_cvt_pk_bf16_f32 v45, v26, v27
    v_cvt_pk_bf16_f32 v46, v28, v29
    v_cvt_pk_bf16_f32 v47, v30, v31
    v_mfma_f32_32x32x16_bf16 v[176:191], a[140:143], a[228:231], v[176:191]
    buffer_store_dwordx4 v[44:47], v226, s[32:35], s56 offen offset:1024 sc1
    v_accvgpr_read_b32 v0, a96
    v_accvgpr_read_b32 v1, a97
    v_accvgpr_read_b32 v2, a98
    s_waitcnt vmcnt(31) lgkmcnt(0)
    v_mfma_f32_32x32x16_bf16 v[64:79], a[144:147], a[232:235], v[64:79]
    ds_read_b64_tr_b16 a[128:129], v202 offset:36864
    ds_read_b64_tr_b16 a[130:131], v202 offset:37376
    v_accvgpr_read_b32 v3, a99
    v_accvgpr_read_b32 v4, a100
    v_accvgpr_read_b32 v5, a101
    v_accvgpr_read_b32 v6, a102
    v_mfma_f32_32x32x16_bf16 v[80:95], a[144:147], a[236:239], v[80:95]
    buffer_load_dwordx4 a[224:227], v208, s[20:23], s44 offen offset:0 sc1
    ds_read_b64_tr_b16 a[132:133], v203 offset:36864
    ds_read_b64_tr_b16 a[134:135], v203 offset:37376
    v_accvgpr_read_b32 v7, a103
    v_mul_f32 v0, v0, v48
    v_mul_f32 v1, v1, v48
    v_mfma_f32_32x32x16_bf16 v[96:111], a[148:151], a[232:235], v[96:111]
    ds_read_b64_tr_b16 a[136:137], v202 offset:45056
    ds_read_b64_tr_b16 a[138:139], v202 offset:45568
    v_mul_f32 v2, v2, v48
    v_mul_f32 v3, v3, v48
    v_mul_f32 v4, v4, v48
    v_mfma_f32_32x32x16_bf16 v[112:127], a[148:151], a[236:239], v[112:127]
    buffer_load_dwordx4 a[228:231], v209, s[20:23], s44 offen offset:0 sc1
    ds_read_b64_tr_b16 a[140:141], v203 offset:45056
    ds_read_b64_tr_b16 a[142:143], v203 offset:45568
    v_mul_f32 v5, v5, v48
    v_mul_f32 v6, v6, v48
    v_mul_f32 v7, v7, v48
    v_cvt_pk_bf16_f32 v32, v0, v1
    v_mfma_f32_32x32x16_bf16 v[128:143], a[152:155], a[232:235], v[128:143]
    v_cvt_pk_bf16_f32 v33, v2, v3
    v_cvt_pk_bf16_f32 v34, v4, v5
    v_cvt_pk_bf16_f32 v35, v6, v7
    v_mfma_f32_32x32x16_bf16 v[144:159], a[152:155], a[236:239], v[144:159]
    buffer_store_dwordx4 v[32:35], v225, s[32:35], s56 offen offset:2048 sc1
    v_accvgpr_read_b32 v8, a104
    v_accvgpr_read_b32 v9, a105
    v_accvgpr_read_b32 v10, a106
    v_mfma_f32_32x32x16_bf16 v[160:175], a[156:159], a[232:235], v[160:175]
    v_accvgpr_read_b32 v11, a107
    v_accvgpr_read_b32 v12, a108
    v_accvgpr_read_b32 v13, a109
    v_accvgpr_read_b32 v14, a110
    v_mfma_f32_32x32x16_bf16 v[176:191], a[156:159], a[236:239], v[176:191]
    buffer_load_dwordx4 a[232:235], v208, s[20:23], s44 offen offset:1024 sc1
    v_accvgpr_read_b32 v15, a111
    v_mul_f32 v8, v8, v48
    v_mul_f32 v9, v9, v48
    s_waitcnt vmcnt(32) lgkmcnt(0)
    v_mfma_f32_32x32x16_bf16 v[64:79], a[128:131], a[240:243], v[64:79]
    ds_read_b64_tr_b16 a[144:145], v202 offset:38912
    ds_read_b64_tr_b16 a[146:147], v202 offset:39424
    v_mul_f32 v10, v10, v48
    v_mul_f32 v11, v11, v48
    v_mul_f32 v12, v12, v48
    v_mfma_f32_32x32x16_bf16 v[80:95], a[128:131], a[244:247], v[80:95]
    buffer_load_dwordx4 a[236:239], v209, s[20:23], s44 offen offset:1024 sc1
    ds_read_b64_tr_b16 a[148:149], v203 offset:38912
    ds_read_b64_tr_b16 a[150:151], v203 offset:39424
    v_mul_f32 v13, v13, v48
    v_mul_f32 v14, v14, v48
    v_mul_f32 v15, v15, v48
    v_cvt_pk_bf16_f32 v36, v8, v9
    v_mfma_f32_32x32x16_bf16 v[96:111], a[132:135], a[240:243], v[96:111]
    ds_read_b64_tr_b16 a[152:153], v202 offset:47104
    ds_read_b64_tr_b16 a[154:155], v202 offset:47616
    v_cvt_pk_bf16_f32 v37, v10, v11
    v_cvt_pk_bf16_f32 v38, v12, v13
    v_cvt_pk_bf16_f32 v39, v14, v15
    v_mfma_f32_32x32x16_bf16 v[112:127], a[132:135], a[244:247], v[112:127]
    buffer_store_dwordx4 v[36:39], v225, s[32:35], s56 offen offset:3072 sc1
    ds_read_b64_tr_b16 a[156:157], v203 offset:47104
    ds_read_b64_tr_b16 a[158:159], v203 offset:47616
    v_accvgpr_read_b32 v16, a112
    v_accvgpr_read_b32 v17, a113
    v_accvgpr_read_b32 v18, a114
    v_mfma_f32_32x32x16_bf16 v[128:143], a[136:139], a[240:243], v[128:143]
    v_accvgpr_read_b32 v19, a115
    v_accvgpr_read_b32 v20, a116
    v_accvgpr_read_b32 v21, a117
    v_accvgpr_read_b32 v22, a118
    v_mfma_f32_32x32x16_bf16 v[144:159], a[136:139], a[244:247], v[144:159]
    s_add_u32 m0, s40, 32768
    s_nop 0
    buffer_load_dwordx4 v192, s[8:11], s45 offen lds
    s_add_u32 s45, s45, 16384
    v_accvgpr_read_b32 v23, a119
    v_mul_f32 v16, v16, v50
    v_mul_f32 v17, v17, v50
    v_mfma_f32_32x32x16_bf16 v[160:175], a[140:143], a[240:243], v[160:175]
    v_mul_f32 v18, v18, v50
    v_mul_f32 v19, v19, v50
    v_mul_f32 v20, v20, v50
    v_mfma_f32_32x32x16_bf16 v[176:191], a[140:143], a[244:247], v[176:191]
    buffer_load_dwordx4 a[240:243], v208, s[20:23], s44 offen offset:2048 sc1
    v_mul_f32 v21, v21, v50
    v_mul_f32 v22, v22, v50
    v_mul_f32 v23, v23, v50
    v_cvt_pk_bf16_f32 v40, v16, v17
    s_waitcnt vmcnt(33) lgkmcnt(0)
    v_mfma_f32_32x32x16_bf16 v[64:79], a[144:147], a[248:251], v[64:79]
    ds_read_b64_tr_b16 a[128:129], v202 offset:49152
    ds_read_b64_tr_b16 a[130:131], v202 offset:49664
    v_cvt_pk_bf16_f32 v41, v18, v19
    v_cvt_pk_bf16_f32 v42, v20, v21
    v_cvt_pk_bf16_f32 v43, v22, v23
    v_mfma_f32_32x32x16_bf16 v[80:95], a[144:147], a[252:255], v[80:95]
    buffer_store_dwordx4 v[40:43], v226, s[32:35], s56 offen offset:2048 sc1
    ds_read_b64_tr_b16 a[132:133], v203 offset:49152
    ds_read_b64_tr_b16 a[134:135], v203 offset:49664
    v_accvgpr_read_b32 v24, a120
    v_accvgpr_read_b32 v25, a121
    v_accvgpr_read_b32 v26, a122
    v_mfma_f32_32x32x16_bf16 v[96:111], a[148:151], a[248:251], v[96:111]
    ds_read_b64_tr_b16 a[136:137], v202 offset:57344
    ds_read_b64_tr_b16 a[138:139], v202 offset:57856
    v_accvgpr_read_b32 v27, a123
    v_accvgpr_read_b32 v28, a124
    v_accvgpr_read_b32 v29, a125
    v_accvgpr_read_b32 v30, a126
    v_mfma_f32_32x32x16_bf16 v[112:127], a[148:151], a[252:255], v[112:127]
    buffer_load_dwordx4 a[244:247], v209, s[20:23], s44 offen offset:2048 sc1
    ds_read_b64_tr_b16 a[140:141], v203 offset:57344
    ds_read_b64_tr_b16 a[142:143], v203 offset:57856
    v_accvgpr_read_b32 v31, a127
    v_mul_f32 v24, v24, v50
    v_mul_f32 v25, v25, v50
    v_mfma_f32_32x32x16_bf16 v[128:143], a[152:155], a[248:251], v[128:143]
    v_mul_f32 v26, v26, v50
    v_mul_f32 v27, v27, v50
    v_mul_f32 v28, v28, v50
    v_mfma_f32_32x32x16_bf16 v[144:159], a[152:155], a[252:255], v[144:159]
    s_add_u32 m0, s40, 36864
    s_nop 0
    buffer_load_dwordx4 v192, s[8:11], s45 offen lds
    s_add_u32 s45, s45, 16384
    v_mul_f32 v29, v29, v50
    v_mul_f32 v30, v30, v50
    v_mul_f32 v31, v31, v50
    v_cvt_pk_bf16_f32 v44, v24, v25
    v_mfma_f32_32x32x16_bf16 v[160:175], a[156:159], a[248:251], v[160:175]
    v_cvt_pk_bf16_f32 v45, v26, v27
    v_cvt_pk_bf16_f32 v46, v28, v29
    v_cvt_pk_bf16_f32 v47, v30, v31
    v_mfma_f32_32x32x16_bf16 v[176:191], a[156:159], a[252:255], v[176:191]
    buffer_store_dwordx4 v[44:47], v226, s[32:35], s56 offen offset:3072 sc1
    s_waitcnt vmcnt(34) lgkmcnt(0)
    v_mfma_f32_32x32x16_bf16 v[64:79], a[128:131], a[160:163], v[64:79]
    ds_read_b64_tr_b16 a[144:145], v202 offset:51200
    ds_read_b64_tr_b16 a[146:147], v202 offset:51712
    v_mfma_f32_32x32x16_bf16 v[80:95], a[128:131], a[164:167], v[80:95]
    buffer_load_dwordx4 a[248:251], v208, s[20:23], s44 offen offset:3072 sc1
    ds_read_b64_tr_b16 a[148:149], v203 offset:51200
    ds_read_b64_tr_b16 a[150:151], v203 offset:51712
    v_mfma_f32_32x32x16_bf16 v[96:111], a[132:135], a[160:163], v[96:111]
    ds_read_b64_tr_b16 a[152:153], v202 offset:59392
    ds_read_b64_tr_b16 a[154:155], v202 offset:59904
    v_mfma_f32_32x32x16_bf16 v[112:127], a[132:135], a[164:167], v[112:127]
    buffer_load_dwordx4 a[252:255], v209, s[20:23], s44 offen offset:3072 sc1
    s_add_u32 s44, s44, 4096
    s_and_b32 s44, s44, 0x7fff
    ds_read_b64_tr_b16 a[156:157], v203 offset:59392
    ds_read_b64_tr_b16 a[158:159], v203 offset:59904
    v_mfma_f32_32x32x16_bf16 v[128:143], a[136:139], a[160:163], v[128:143]
    v_mfma_f32_32x32x16_bf16 v[144:159], a[136:139], a[164:167], v[144:159]
    s_add_u32 m0, s40, 40960
    s_nop 0
    buffer_load_dwordx4 v192, s[8:11], s45 offen lds
    s_add_u32 s45, s45, 16384
    v_mfma_f32_32x32x16_bf16 v[160:175], a[140:143], a[160:163], v[160:175]
    v_mfma_f32_32x32x16_bf16 v[176:191], a[140:143], a[164:167], v[176:191]
    buffer_load_dwordx4 a[160:163], v208, s[20:23], s44 offen offset:0 sc1
    s_waitcnt vmcnt(35) lgkmcnt(0)
    v_mfma_f32_32x32x16_bf16 v[64:79], a[144:147], a[168:171], v[64:79]
    ds_read_b64_tr_b16 a[128:129], v202 offset:53248
    ds_read_b64_tr_b16 a[130:131], v202 offset:53760
    v_mfma_f32_32x32x16_bf16 v[80:95], a[144:147], a[172:175], v[80:95]
    buffer_load_dwordx4 a[164:167], v209, s[20:23], s44 offen offset:0 sc1
    ds_read_b64_tr_b16 a[132:133], v203 offset:53248
    ds_read_b64_tr_b16 a[134:135], v203 offset:53760
    v_mfma_f32_32x32x16_bf16 v[96:111], a[148:151], a[168:171], v[96:111]
    ds_read_b64_tr_b16 a[136:137], v202 offset:61440
    ds_read_b64_tr_b16 a[138:139], v202 offset:61952
    v_mfma_f32_32x32x16_bf16 v[112:127], a[148:151], a[172:175], v[112:127]
    s_add_u32 m0, s40, 45056
    s_nop 0
    buffer_load_dwordx4 v192, s[8:11], s45 offen lds
    s_add_u32 s45, s45, 16384
    ds_read_b64_tr_b16 a[140:141], v203 offset:61440
    ds_read_b64_tr_b16 a[142:143], v203 offset:61952
    v_mfma_f32_32x32x16_bf16 v[128:143], a[152:155], a[168:171], v[128:143]
    v_mfma_f32_32x32x16_bf16 v[144:159], a[152:155], a[172:175], v[144:159]
    s_add_u32 m0, s40, 65536
    s_nop 0
    buffer_load_dwordx4 v192, s[8:11], s45 offen lds
    s_add_u32 s45, s45, 16384
    v_mfma_f32_32x32x16_bf16 v[160:175], a[156:159], a[168:171], v[160:175]
    v_mfma_f32_32x32x16_bf16 v[176:191], a[156:159], a[172:175], v[176:191]
    buffer_load_dwordx4 a[168:171], v208, s[20:23], s44 offen offset:1024 sc1
    s_waitcnt vmcnt(36) lgkmcnt(0)
    v_mfma_f32_32x32x16_bf16 v[64:79], a[128:131], a[176:179], v[64:79]
    ds_read_b64_tr_b16 a[144:145], v202 offset:55296
    ds_read_b64_tr_b16 a[146:147], v202 offset:55808
    v_mfma_f32_32x32x16_bf16 v[80:95], a[128:131], a[180:183], v[80:95]
    buffer_load_dwordx4 a[172:175], v209, s[20:23], s44 offen offset:1024 sc1
    ds_read_b64_tr_b16 a[148:149], v203 offset:55296
    ds_read_b64_tr_b16 a[150:151], v203 offset:55808
    v_mfma_f32_32x32x16_bf16 v[96:111], a[132:135], a[176:179], v[96:111]
    ds_read_b64_tr_b16 a[152:153], v202 offset:63488
    ds_read_b64_tr_b16 a[154:155], v202 offset:64000
    v_mfma_f32_32x32x16_bf16 v[112:127], a[132:135], a[180:183], v[112:127]
    s_add_u32 m0, s40, 69632
    s_nop 0
    buffer_load_dwordx4 v192, s[8:11], s45 offen lds
    s_add_u32 s45, s45, 16384
    ds_read_b64_tr_b16 a[156:157], v203 offset:63488
    ds_read_b64_tr_b16 a[158:159], v203 offset:64000
    v_mfma_f32_32x32x16_bf16 v[128:143], a[136:139], a[176:179], v[128:143]
    v_mfma_f32_32x32x16_bf16 v[144:159], a[136:139], a[180:183], v[144:159]
    s_add_u32 m0, s40, 73728
    s_nop 0
    buffer_load_dwordx4 v192, s[8:11], s45 offen lds
    s_add_u32 s45, s45, 16384
    v_mfma_f32_32x32x16_bf16 v[160:175], a[140:143], a[176:179], v[160:175]
    v_mfma_f32_32x32x16_bf16 v[176:191], a[140:143], a[180:183], v[176:191]
    s_waitcnt vmcnt(11) lgkmcnt(0)
    s_barrier
    s_waitcnt vmcnt(36) lgkmcnt(0)
    v_mfma_f32_32x32x16_bf16 v[64:79], a[144:147], a[184:187], v[64:79]
    s_cmp_lg_u32 s36, 0
    s_cbranch_scc1 FS_O
    v_mov_b32 v248, s62
    v_mov_b32 v249, 0
    s_mov_b64 exec, 1
    buffer_store_dword v248, v249, s[68:71], s63 offen offset:4 sc1
    s_mov_b64 exec, -1
FS_O:
    ds_read_b64_tr_b16 a[128:129], v204 offset:0
    ds_read_b64_tr_b16 a[130:131], v204 offset:512
    v_mfma_f32_32x32x16_bf16 v[80:95], a[144:147], a[188:191], v[80:95]
    ds_read_b64_tr_b16 a[132:133], v205 offset:0
    ds_read_b64_tr_b16 a[134:135], v205 offset:512
    v_mfma_f32_32x32x16_bf16 v[96:111], a[148:151], a[184:187], v[96:111]
    buffer_load_dwordx4 a[176:179], v208, s[20:23], s44 offen offset:2048 sc1
    ds_read_b64_tr_b16 a[136:137], v204 offset:8192
    ds_read_b64_tr_b16 a[138:139], v204 offset:8704
    v_mfma_f32_32x32x16_bf16 v[112:127], a[148:151], a[188:191], v[112:127]
    ds_read_b64_tr_b16 a[140:141], v205 offset:8192
    ds_read_b64_tr_b16 a[142:143], v205 offset:8704
    v_mfma_f32_32x32x16_bf16 v[128:143], a[152:155], a[184:187], v[128:143]
    buffer_load_dwordx4 a[180:183], v209, s[20:23], s44 offen offset:2048 sc1
    v_mfma_f32_32x32x16_bf16 v[144:159], a[152:155], a[188:191], v[144:159]
    v_mfma_f32_32x32x16_bf16 v[160:175], a[156:159], a[184:187], v[160:175]
    s_add_u32 m0, s40, 77824
    s_nop 0
    buffer_load_dwordx4 v192, s[8:11], s45 offen lds
    s_add_u32 s45, s45, 16384
    v_mfma_f32_32x32x16_bf16 v[176:191], a[156:159], a[188:191], v[176:191]
    s_waitcnt vmcnt(36) lgkmcnt(0)
    v_mfma_f32_32x32x16_bf16 v[64:79], a[128:131], a[192:195], v[64:79]
    buffer_load_dwordx4 a[184:187], v208, s[20:23], s44 offen offset:3072 sc1
    ds_read_b64_tr_b16 a[144:145], v204 offset:2048
    ds_read_b64_tr_b16 a[146:147], v204 offset:2560
    v_mfma_f32_32x32x16_bf16 v[80:95], a[128:131], a[196:199], v[80:95]
    ds_read_b64_tr_b16 a[148:149], v205 offset:2048
    ds_read_b64_tr_b16 a[150:151], v205 offset:2560
    v_mfma_f32_32x32x16_bf16 v[96:111], a[132:135], a[192:195], v[96:111]
    buffer_load_dwordx4 a[188:191], v209, s[20:23], s44 offen offset:3072 sc1
    s_add_u32 s44, s44, 4096
    s_and_b32 s44, s44, 0x7fff
    ds_read_b64_tr_b16 a[152:153], v204 offset:10240
    ds_read_b64_tr_b16 a[154:155], v204 offset:10752
    v_mfma_f32_32x32x16_bf16 v[112:127], a[132:135], a[196:199], v[112:127]
    ds_read_b64_tr_b16 a[156:157], v205 offset:10240
    ds_read_b64_tr_b16 a[158:159], v205 offset:10752
    v_mfma_f32_32x32x16_bf16 v[128:143], a[136:139], a[192:195], v[128:143]
    s_add_u32 m0, s100, 49152
    s_nop 0
    buffer_load_dwordx4 v218, s[64:67], s73 offen lds
    v_mfma_f32_32x32x16_bf16 v[144:159], a[136:139], a[196:199], v[144:159]
    v_mfma_f32_32x32x16_bf16 v[160:175], a[140:143], a[192:195], v[160:175]
    s_add_u32 m0, s100, 49152
    s_nop 0
    buffer_load_dwordx4 v219, s[64:67], s73 offen offset:1024 lds
    s_add_u32 s73, s73, 16384
    v_mfma_f32_32x32x16_bf16 v[176:191], a[140:143], a[196:199], v[176:191]
    s_waitcnt vmcnt(37) lgkmcnt(0)
    v_mfma_f32_32x32x16_bf16 v[64:79], a[144:147], a[200:203], v[64:79]
    buffer_load_dwordx4 a[192:195], v208, s[20:23], s44 offen offset:0 sc1
    ds_read_b64_tr_b16 a[128:129], v204 offset:4096
    ds_read_b64_tr_b16 a[130:131], v204 offset:4608
    v_mfma_f32_32x32x16_bf16 v[80:95], a[144:147], a[204:207], v[80:95]
    ds_read_b64_tr_b16 a[132:133], v205 offset:4096
    ds_read_b64_tr_b16 a[134:135], v205 offset:4608
    v_mfma_f32_32x32x16_bf16 v[96:111], a[148:151], a[200:203], v[96:111]
    buffer_load_dwordx4 a[196:199], v209, s[20:23], s44 offen offset:0 sc1
    ds_read_b64_tr_b16 a[136:137], v204 offset:12288
    ds_read_b64_tr_b16 a[138:139], v204 offset:12800
    v_mfma_f32_32x32x16_bf16 v[112:127], a[148:151], a[204:207], v[112:127]
    ds_read_b64_tr_b16 a[140:141], v205 offset:12288
    ds_read_b64_tr_b16 a[142:143], v205 offset:12800
    v_mfma_f32_32x32x16_bf16 v[128:143], a[152:155], a[200:203], v[128:143]
    s_add_u32 m0, s100, 51200
    s_nop 0
    buffer_load_dwordx4 v218, s[64:67], s73 offen lds
    v_mfma_f32_32x32x16_bf16 v[144:159], a[152:155], a[204:207], v[144:159]
    v_mfma_f32_32x32x16_bf16 v[160:175], a[156:159], a[200:203], v[160:175]
    s_add_u32 m0, s100, 51200
    s_nop 0
    buffer_load_dwordx4 v219, s[64:67], s73 offen offset:1024 lds
    s_add_u32 s73, s73, 16384
    v_mfma_f32_32x32x16_bf16 v[176:191], a[156:159], a[204:207], v[176:191]
    s_waitcnt vmcnt(38) lgkmcnt(0)
    v_mfma_f32_32x32x16_bf16 v[64:79], a[128:131], a[208:211], v[64:79]
    buffer_load_dwordx4 a[200:203], v208, s[20:23], s44 offen offset:1024 sc1
    ds_read_b64_tr_b16 a[144:145], v204 offset:6144
    ds_read_b64_tr_b16 a[146:147], v204 offset:6656
    v_mfma_f32_32x32x16_bf16 v[80:95], a[128:131], a[212:215], v[80:95]
    ds_read_b64_tr_b16 a[148:149], v205 offset:6144
    ds_read_b64_tr_b16 a[150:151], v205 offset:6656
    v_mfma_f32_32x32x16_bf16 v[96:111], a[132:135], a[208:211], v[96:111]
    buffer_load_dwordx4 a[204:207], v209, s[20:23], s44 offen offset:1024 sc1
    ds_read_b64_tr_b16 a[152:153], v204 offset:14336
    ds_read_b64_tr_b16 a[154:155], v204 offset:14848
    v_mfma_f32_32x32x16_bf16 v[112:127], a[132:135], a[212:215], v[112:127]
    ds_read_b64_tr_b16 a[156:157], v205 offset:14336
    ds_read_b64_tr_b16 a[158:159], v205 offset:14848
    v_mfma_f32_32x32x16_bf16 v[128:143], a[136:139], a[208:211], v[128:143]
    s_add_u32 m0, s100, 81920
    s_nop 0
    buffer_load_dwordx4 v218, s[64:67], s73 offen lds
    v_mfma_f32_32x32x16_bf16 v[144:159], a[136:139], a[212:215], v[144:159]
    v_mfma_f32_32x32x16_bf16 v[160:175], a[140:143], a[208:211], v[160:175]
    s_lshl_b32 s55, s49, 20
    s_add_u32 s54, s101, s55
    buffer_load_dword v253, v252, s[8:11], s54 offen
    v_mfma_f32_32x32x16_bf16 v[176:191], a[140:143], a[212:215], v[176:191]
    s_waitcnt vmcnt(39) lgkmcnt(0)
    v_mfma_f32_32x32x16_bf16 v[64:79], a[144:147], a[216:219], v[64:79]
    buffer_load_dwordx4 a[208:211], v208, s[20:23], s44 offen offset:2048 sc1
    ds_read_b64_tr_b16 a[128:129], v204 offset:16384
    ds_read_b64_tr_b16 a[130:131], v204 offset:16896
    v_mfma_f32_32x32x16_bf16 v[80:95], a[144:147], a[220:223], v[80:95]
    ds_read_b64_tr_b16 a[132:133], v205 offset:16384
    ds_read_b64_tr_b16 a[134:135], v205 offset:16896
    v_mfma_f32_32x32x16_bf16 v[96:111], a[148:151], a[216:219], v[96:111]
    buffer_load_dwordx4 a[212:215], v209, s[20:23], s44 offen offset:2048 sc1
    ds_read_b64_tr_b16 a[136:137], v204 offset:24576
    ds_read_b64_tr_b16 a[138:139], v204 offset:25088
    v_mfma_f32_32x32x16_bf16 v[112:127], a[148:151], a[220:223], v[112:127]
    ds_read_b64_tr_b16 a[140:141], v205 offset:24576
    ds_read_b64_tr_b16 a[142:143], v205 offset:25088
    v_mfma_f32_32x32x16_bf16 v[128:143], a[152:155], a[216:219], v[128:143]
    s_add_u32 m0, s100, 81920
    s_nop 0
    buffer_load_dwordx4 v219, s[64:67], s73 offen offset:1024 lds
    s_add_u32 s73, s73, 16384
    v_mfma_f32_32x32x16_bf16 v[144:159], a[152:155], a[220:223], v[144:159]
    v_mfma_f32_32x32x16_bf16 v[160:175], a[156:159], a[216:219], v[160:175]
    s_add_u32 m0, s100, 83968
    s_nop 0
    buffer_load_dwordx4 v218, s[64:67], s73 offen lds
    v_mfma_f32_32x32x16_bf16 v[176:191], a[156:159], a[220:223], v[176:191]
    s_waitcnt vmcnt(40) lgkmcnt(0)
    v_mfma_f32_32x32x16_bf16 v[64:79], a[128:131], a[224:227], v[64:79]
    buffer_load_dwordx4 a[216:219], v208, s[20:23], s44 offen offset:3072 sc1
    ds_read_b64_tr_b16 a[144:145], v204 offset:18432
    ds_read_b64_tr_b16 a[146:147], v204 offset:18944
    v_mfma_f32_32x32x16_bf16 v[80:95], a[128:131], a[228:231], v[80:95]
    ds_read_b64_tr_b16 a[148:149], v205 offset:18432
    ds_read_b64_tr_b16 a[150:151], v205 offset:18944
    v_mfma_f32_32x32x16_bf16 v[96:111], a[132:135], a[224:227], v[96:111]
    buffer_load_dwordx4 a[220:223], v209, s[20:23], s44 offen offset:3072 sc1
    s_add_u32 s44, s44, 4096
    s_and_b32 s44, s44, 0x7fff
    ds_read_b64_tr_b16 a[152:153], v204 offset:26624
    ds_read_b64_tr_b16 a[154:155], v204 offset:27136
    v_mfma_f32_32x32x16_bf16 v[112:127], a[132:135], a[228:231], v[112:127]
    ds_read_b64_tr_b16 a[156:157], v205 offset:26624
    ds_read_b64_tr_b16 a[158:159], v205 offset:27136
    v_mfma_f32_32x32x16_bf16 v[128:143], a[136:139], a[224:227], v[128:143]
    s_add_u32 m0, s100, 83968
    s_nop 0
    buffer_load_dwordx4 v219, s[64:67], s73 offen offset:1024 lds
    s_add_u32 s73, s73, 16384
    v_mfma_f32_32x32x16_bf16 v[144:159], a[136:139], a[228:231], v[144:159]
    v_mfma_f32_32x32x16_bf16 v[160:175], a[140:143], a[224:227], v[160:175]
    s_add_u32 m0, s100, 114688
    s_nop 0
    buffer_load_dwordx4 v218, s[64:67], s73 offen lds
    v_mfma_f32_32x32x16_bf16 v[176:191], a[140:143], a[228:231], v[176:191]
    s_waitcnt vmcnt(41) lgkmcnt(0)
    v_mfma_f32_32x32x16_bf16 v[64:79], a[144:147], a[232:235], v[64:79]
    s_add_u32 m0, s100, 114688
    s_nop 0
    buffer_load_dwordx4 v219, s[64:67], s73 offen offset:1024 lds
    s_add_u32 s73, s73, 16384
    ds_read_b64_tr_b16 a[128:129], v204 offset:20480
    ds_read_b64_tr_b16 a[130:131], v204 offset:20992
    v_mfma_f32_32x32x16_bf16 v[80:95], a[144:147], a[236:239], v[80:95]
    ds_read_b64_tr_b16 a[132:133], v205 offset:20480
    ds_read_b64_tr_b16 a[134:135], v205 offset:20992
    v_mfma_f32_32x32x16_bf16 v[96:111], a[148:151], a[232:235], v[96:111]
    s_add_u32 m0, s100, 116736
    s_nop 0
    buffer_load_dwordx4 v218, s[64:67], s73 offen lds
    ds_read_b64_tr_b16 a[136:137], v204 offset:28672
    ds_read_b64_tr_b16 a[138:139], v204 offset:29184
    v_mfma_f32_32x32x16_bf16 v[112:127], a[148:151], a[236:239], v[112:127]
    ds_read_b64_tr_b16 a[140:141], v205 offset:28672
    ds_read_b64_tr_b16 a[142:143], v205 offset:29184
    v_mfma_f32_32x32x16_bf16 v[128:143], a[152:155], a[232:235], v[128:143]
    s_add_u32 m0, s100, 116736
    s_nop 0
    buffer_load_dwordx4 v219, s[64:67], s73 offen offset:1024 lds
    s_add_u32 s73, s73, 16384
    v_mfma_f32_32x32x16_bf16 v[144:159], a[152:155], a[236:239], v[144:159]
    v_mfma_f32_32x32x16_bf16 v[160:175], a[156:159], a[232:235], v[160:175]
    s_add_u32 m0, s40, 98304
    s_nop 0
    buffer_load_dwordx4 v192, s[8:11], s45 offen lds
    s_add_u32 s45, s45, 16384
    v_mfma_f32_32x32x16_bf16 v[176:191], a[156:159], a[236:239], v[176:191]
    s_waitcnt vmcnt(40) lgkmcnt(0)
    v_mfma_f32_32x32x16_bf16 v[64:79], a[128:131], a[240:243], v[64:79]
    s_add_u32 m0, s40, 102400
    s_nop 0
    buffer_load_dwordx4 v192, s[8:11], s45 offen lds
    s_add_u32 s45, s45, 16384
    ds_read_b64_tr_b16 a[144:145], v204 offset:22528
    ds_read_b64_tr_b16 a[146:147], v204 offset:23040
    v_mfma_f32_32x32x16_bf16 v[80:95], a[128:131], a[244:247], v[80:95]
    ds_read_b64_tr_b16 a[148:149], v205 offset:22528
    ds_read_b64_tr_b16 a[150:151], v205 offset:23040
    v_mfma_f32_32x32x16_bf16 v[96:111], a[132:135], a[240:243], v[96:111]
    s_add_u32 m0, s40, 106496
    s_nop 0
    buffer_load_dwordx4 v192, s[8:11], s45 offen lds
    s_add_u32 s45, s45, 16384
    ds_read_b64_tr_b16 a[152:153], v204 offset:30720
    ds_read_b64_tr_b16 a[154:155], v204 offset:31232
    v_mfma_f32_32x32x16_bf16 v[112:127], a[132:135], a[244:247], v[112:127]
    ds_read_b64_tr_b16 a[156:157], v205 offset:30720
    ds_read_b64_tr_b16 a[158:159], v205 offset:31232
    v_mfma_f32_32x32x16_bf16 v[128:143], a[136:139], a[240:243], v[128:143]
    s_add_u32 m0, s40, 110592
    s_nop 0
    buffer_load_dwordx4 v192, s[8:11], s45 offen lds
    s_add_u32 s45, s45, 16384
    v_mfma_f32_32x32x16_bf16 v[144:159], a[136:139], a[244:247], v[144:159]
    v_mfma_f32_32x32x16_bf16 v[160:175], a[140:143], a[240:243], v[160:175]
    v_mfma_f32_32x32x16_bf16 v[176:191], a[140:143], a[244:247], v[176:191]
    s_waitcnt lgkmcnt(0)
    s_barrier
    s_waitcnt vmcnt(39) lgkmcnt(0)
    v_mfma_f32_32x32x16_bf16 v[64:79], a[144:147], a[248:251], v[64:79]
    s_add_u32 m0, s100, 147456
    s_nop 0
    buffer_load_dwordx4 v218, s[64:67], s73 offen lds
    ds_read_b64_tr_b16 a[128:129], v200 offset:0
    ds_read_b64_tr_b16 a[130:131], v200 offset:512
    v_mfma_f32_32x32x16_bf16 v[80:95], a[144:147], a[252:255], v[80:95]
    ds_read_b64_tr_b16 a[132:133], v201 offset:0
    ds_read_b64_tr_b16 a[134:135], v201 offset:512
    v_mfma_f32_32x32x16_bf16 v[96:111], a[148:151], a[248:251], v[96:111]
    s_add_u32 m0, s100, 147456
    s_nop 0
    buffer_load_dwordx4 v219, s[64:67], s73 offen offset:1024 lds
    s_add_u32 s73, s73, 16384
    ds_read_b64_tr_b16 a[136:137], v200 offset:8192
    ds_read_b64_tr_b16 a[138:139], v200 offset:8704
    v_mfma_f32_32x32x16_bf16 v[112:127], a[148:151], a[252:255], v[112:127]
    ds_read_b64_tr_b16 a[140:141], v201 offset:8192
    ds_read_b64_tr_b16 a[142:143], v201 offset:8704
    v_mfma_f32_32x32x16_bf16 v[128:143], a[152:155], a[248:251], v[128:143]
    s_add_u32 m0, s100, 149504
    s_nop 0
    buffer_load_dwordx4 v218, s[64:67], s73 offen lds
    v_mfma_f32_32x32x16_bf16 v[144:159], a[152:155], a[252:255], v[144:159]
    v_mfma_f32_32x32x16_bf16 v[160:175], a[156:159], a[248:251], v[160:175]
    s_add_u32 m0, s100, 149504
    s_nop 0
    buffer_load_dwordx4 v219, s[64:67], s73 offen offset:1024 lds
    s_add_u32 s73, s73, 16384
    v_mfma_f32_32x32x16_bf16 v[176:191], a[156:159], a[252:255], v[176:191]
    s_waitcnt vmcnt(40) lgkmcnt(0)
    v_mfma_f32_32x32x16_bf16 v[64:79], a[128:131], a[160:163], v[64:79]
    s_add_u32 m0, s40, 131072
    s_nop 0
    buffer_load_dwordx4 v192, s[8:11], s45 offen lds
    s_add_u32 s45, s45, 16384
    ds_read_b64_tr_b16 a[144:145], v200 offset:2048
    ds_read_b64_tr_b16 a[146:147], v200 offset:2560
    v_mfma_f32_32x32x16_bf16 v[80:95], a[128:131], a[164:167], v[80:95]
    ds_read_b64_tr_b16 a[148:149], v201 offset:2048
    ds_read_b64_tr_b16 a[150:151], v201 offset:2560
    v_mfma_f32_32x32x16_bf16 v[96:111], a[132:135], a[160:163], v[96:111]
    buffer_load_dword v255, v227, s[68:71], s3 offen offset:4 sc1
    ds_read_b64_tr_b16 a[152:153], v200 offset:10240
    ds_read_b64_tr_b16 a[154:155], v200 offset:10752
    v_mfma_f32_32x32x16_bf16 v[112:127], a[132:135], a[164:167], v[112:127]
    ds_read_b64_tr_b16 a[156:157], v201 offset:10240
    ds_read_b64_tr_b16 a[158:159], v201 offset:10752
    v_mfma_f32_32x32x16_bf16 v[128:143], a[136:139], a[160:163], v[128:143]
    s_add_u32 m0, s40, 135168
    s_nop 0
    buffer_load_dwordx4 v192, s[8:11], s45 offen lds
    s_add_u32 s45, s45, 16384
    v_mfma_f32_32x32x16_bf16 v[144:159], a[136:139], a[164:167], v[144:159]
    v_mfma_f32_32x32x16_bf16 v[160:175], a[140:143], a[160:163], v[160:175]
    s_add_u32 m0, s40, 139264
    s_nop 0
    buffer_load_dwordx4 v192, s[8:11], s45 offen lds
    s_add_u32 s45, s45, 16384
    v_mfma_f32_32x32x16_bf16 v[176:191], a[140:143], a[164:167], v[176:191]
    s_waitcnt vmcnt(40) lgkmcnt(0)
    s_waitcnt vmcnt(12)
    v_mfma_f32_32x32x16_bf16 v[64:79], a[144:147], a[168:171], v[64:79]
    s_add_u32 m0, s40, 143360
    s_nop 0
    buffer_load_dwordx4 v192, s[8:11], s45 offen lds
    s_add_u32 s45, s45, 16384
    ds_read_b64_tr_b16 a[128:129], v200 offset:4096
    ds_read_b64_tr_b16 a[130:131], v200 offset:4608
    v_mfma_f32_32x32x16_bf16 v[80:95], a[144:147], a[172:175], v[80:95]
    ds_read_b64_tr_b16 a[132:133], v201 offset:4096
    ds_read_b64_tr_b16 a[134:135], v201 offset:4608
    v_mfma_f32_32x32x16_bf16 v[96:111], a[148:151], a[168:171], v[96:111]
    ds_read_b64_tr_b16 a[136:137], v200 offset:12288
    ds_read_b64_tr_b16 a[138:139], v200 offset:12800
    v_mfma_f32_32x32x16_bf16 v[112:127], a[148:151], a[172:175], v[112:127]
    ds_read_b64_tr_b16 a[140:141], v201 offset:12288
    ds_read_b64_tr_b16 a[142:143], v201 offset:12800
    v_mfma_f32_32x32x16_bf16 v[128:143], a[152:155], a[168:171], v[128:143]
    ds_read_b64_tr_b16 a[48:49], v238 offset:49152
    v_mfma_f32_32x32x16_bf16 v[144:159], a[152:155], a[172:175], v[144:159]
    ds_read_b64_tr_b16 a[50:51], v238 offset:50176
    v_mfma_f32_32x32x16_bf16 v[160:175], a[156:159], a[168:171], v[160:175]
    ds_read_b64_tr_b16 a[52:53], v239 offset:49152
    ds_read_b64_tr_b16 a[54:55], v239 offset:50176
    v_mfma_f32_32x32x16_bf16 v[176:191], a[156:159], a[172:175], v[176:191]
    ds_read_b64_tr_b16 a[56:57], v238 offset:51200
    s_waitcnt vmcnt(37) lgkmcnt(5)
    v_mfma_f32_32x32x16_bf16 v[64:79], a[128:131], a[176:179], v[64:79]
    ds_read_b64_tr_b16 a[144:145], v200 offset:6144
    ds_read_b64_tr_b16 a[146:147], v200 offset:6656
    ds_read_b64_tr_b16 a[58:59], v238 offset:52224
    v_mfma_f32_32x32x16_bf16 v[80:95], a[128:131], a[180:183], v[80:95]
    ds_read_b64_tr_b16 a[148:149], v201 offset:6144
    ds_read_b64_tr_b16 a[150:151], v201 offset:6656
    ds_read_b64_tr_b16 a[60:61], v239 offset:51200
    v_mfma_f32_32x32x16_bf16 v[96:111], a[132:135], a[176:179], v[96:111]
    ds_read_b64_tr_b16 a[152:153], v200 offset:14336
    ds_read_b64_tr_b16 a[154:155], v200 offset:14848
    ds_read_b64_tr_b16 a[62:63], v239 offset:52224
    v_mfma_f32_32x32x16_bf16 v[112:127], a[132:135], a[180:183], v[112:127]
    ds_read_b64_tr_b16 a[156:157], v201 offset:14336
    ds_read_b64_tr_b16 a[158:159], v201 offset:14848
    ds_read_b64_tr_b16 a[64:65], v240 offset:16384
    ds_read_b64_tr_b16 a[66:67], v240 offset:17408
    v_mfma_f32_32x32x16_bf16 v[128:143], a[136:139], a[176:179], v[128:143]
    ds_read_b64_tr_b16 a[68:69], v241 offset:16384
    v_mfma_f32_32x32x16_bf16 v[144:159], a[136:139], a[180:183], v[144:159]
    ds_read_b64_tr_b16 a[70:71], v241 offset:17408
    v_mfma_f32_32x32x16_bf16 v[160:175], a[140:143], a[176:179], v[160:175]
    ds_read_b64_tr_b16 a[72:73], v240 offset:18432
    v_mfma_f32_32x32x16_bf16 v[176:191], a[140:143], a[180:183], v[176:191]
    ds_read_b64_tr_b16 a[74:75], v240 offset:19456
    s_waitcnt vmcnt(34) lgkmcnt(6)
    v_mfma_f32_32x32x16_bf16 v[64:79], a[144:147], a[184:187], v[64:79]
    ds_read_b64_tr_b16 a[128:129], v200 offset:16384
    ds_read_b64_tr_b16 a[130:131], v200 offset:16896
    ds_read_b64_tr_b16 a[76:77], v241 offset:18432
    ds_read_b64_tr_b16 a[78:79], v241 offset:19456
    v_mfma_f32_32x32x16_bf16 v[80:95], a[144:147], a[188:191], v[80:95]
    ds_read_b64_tr_b16 a[132:133], v201 offset:16384
    ds_read_b64_tr_b16 a[134:135], v201 offset:16896
    ds_read_b64_tr_b16 a[80:81], v240 offset:49152
    v_mfma_f32_32x32x16_bf16 v[96:111], a[148:151], a[184:187], v[96:111]
    ds_read_b64_tr_b16 a[136:137], v200 offset:24576
    ds_read_b64_tr_b16 a[138:139], v200 offset:25088
    ds_read_b64_tr_b16 a[82:83], v240 offset:50176
    v_mfma_f32_32x32x16_bf16 v[112:127], a[148:151], a[188:191], v[112:127]
    ds_read_b64_tr_b16 a[140:141], v201 offset:24576
    ds_read_b64_tr_b16 a[142:143], v201 offset:25088
    ds_read_b64_tr_b16 a[84:85], v241 offset:49152
    v_mfma_f32_32x32x16_bf16 v[128:143], a[152:155], a[184:187], v[128:143]
    ds_read_b64_tr_b16 a[86:87], v241 offset:50176
    v_mfma_f32_32x32x16_bf16 v[144:159], a[152:155], a[188:191], v[144:159]
    ds_read_b64_tr_b16 a[88:89], v240 offset:51200
    ds_read_b64_tr_b16 a[90:91], v240 offset:52224
    v_mfma_f32_32x32x16_bf16 v[160:175], a[156:159], a[184:187], v[160:175]
    ds_read_b64_tr_b16 a[92:93], v241 offset:51200
    v_mfma_f32_32x32x16_bf16 v[176:191], a[156:159], a[188:191], v[176:191]
    ds_read_b64_tr_b16 a[94:95], v241 offset:52224
    s_waitcnt vmcnt(30) lgkmcnt(6)
    s_waitcnt lgkmcnt(0)
    s_waitcnt vmcnt(3)
    v_cmp_ne_u32 vcc, s62, v255
    s_mov_b32 s51, 0
    s_cbranch_vccz SYO_OK
SYO_P:
    s_sleep 2
    buffer_load_dword v255, v227, s[68:71], s3 offen offset:4 sc1
    s_add_u32 s51, s51, 1
    s_waitcnt vmcnt(0)
    v_cmp_ne_u32 vcc, s62, v255
    s_cmp_gt_u32 s51, 0x40000
    s_cbranch_scc1 SYO_OK
    s_cbranch_vccnz SYO_P
SYO_OK:
    v_mfma_f32_32x32x16_bf16 v[64:79], a[128:131], a[192:195], v[64:79]
    s_add_u32 m0, s100, 49152
    s_nop 0
    buffer_load_dwordx4 v193, s[32:35], s46 offen offset:0 sc1 lds
    ds_read_b64_tr_b16 a[144:145], v200 offset:18432
    ds_read_b64_tr_b16 a[146:147], v200 offset:18944
    v_mfma_f32_32x32x16_bf16 v[80:95], a[128:131], a[196:199], v[80:95]
    ds_read_b64_tr_b16 a[148:149], v201 offset:18432
    ds_read_b64_tr_b16 a[150:151], v201 offset:18944
    v_mfma_f32_32x32x16_bf16 v[96:111], a[132:135], a[192:195], v[96:111]
    s_add_u32 m0, s100, 49152
    s_nop 0
    buffer_load_dwordx4 v193, s[32:35], s46 offen offset:1024 sc1 lds
    ds_read_b64_tr_b16 a[152:153], v200 offset:26624
    ds_read_b64_tr_b16 a[154:155], v200 offset:27136
    v_mfma_f32_32x32x16_bf16 v[112:127], a[132:135], a[196:199], v[112:127]
    ds_read_b64_tr_b16 a[156:157], v201 offset:26624
    ds_read_b64_tr_b16 a[158:159], v201 offset:27136
    v_mfma_f32_32x32x16_bf16 v[128:143], a[136:139], a[192:195], v[128:143]
    s_add_u32 m0, s100, 49152
    s_nop 0
    buffer_load_dwordx4 v193, s[32:35], s46 offen offset:2048 sc1 lds
    v_mfma_f32_32x32x16_bf16 v[144:159], a[136:139], a[196:199], v[144:159]
    v_mfma_f32_32x32x16_bf16 v[160:175], a[140:143], a[192:195], v[160:175]
    s_add_u32 m0, s100, 49152
    s_nop 0
    buffer_load_dwordx4 v193, s[32:35], s46 offen offset:3072 sc1 lds
    s_add_u32 s46, s46, 4096
    v_mfma_f32_32x32x16_bf16 v[176:191], a[140:143], a[196:199], v[176:191]
    s_waitcnt vmcnt(30) lgkmcnt(0)
    v_mfma_f32_32x32x16_bf16 v[64:79], a[144:147], a[200:203], v[64:79]
    s_add_u32 m0, s100, 81920
    s_nop 0
    buffer_load_dwordx4 v193, s[32:35], s46 offen offset:0 sc1 lds
    ds_read_b64_tr_b16 a[128:129], v200 offset:20480
    ds_read_b64_tr_b16 a[130:131], v200 offset:20992
    v_mfma_f32_32x32x16_bf16 v[80:95], a[144:147], a[204:207], v[80:95]
    ds_read_b64_tr_b16 a[132:133], v201 offset:20480
    ds_read_b64_tr_b16 a[134:135], v201 offset:20992
    v_mfma_f32_32x32x16_bf16 v[96:111], a[148:151], a[200:203], v[96:111]
    s_add_u32 m0, s100, 81920
    s_nop 0
    buffer_load_dwordx4 v193, s[32:35], s46 offen offset:1024 sc1 lds
    ds_read_b64_tr_b16 a[136:137], v200 offset:28672
    ds_read_b64_tr_b16 a[138:139], v200 offset:29184
    v_mfma_f32_32x32x16_bf16 v[112:127], a[148:151], a[204:207], v[112:127]
    ds_read_b64_tr_b16 a[140:141], v201 offset:28672
    ds_read_b64_tr_b16 a[142:143], v201 offset:29184
    v_mfma_f32_32x32x16_bf16 v[128:143], a[152:155], a[200:203], v[128:143]
    s_add_u32 m0, s100, 81920
    s_nop 0
    buffer_load_dwordx4 v193, s[32:35], s46 offen offset:2048 sc1 lds
    v_mfma_f32_32x32x16_bf16 v[144:159], a[152:155], a[204:207], v[144:159]
    v_mfma_f32_32x32x16_bf16 v[160:175], a[156:159], a[200:203], v[160:175]
    s_add_u32 m0, s100, 81920
    s_nop 0
    buffer_load_dwordx4 v193, s[32:35], s46 offen offset:3072 sc1 lds
    s_add_u32 s46, s46, 4096
    v_mfma_f32_32x32x16_bf16 v[176:191], a[156:159], a[204:207], v[176:191]
    s_waitcnt vmcnt(30) lgkmcnt(0)
    v_mfma_f32_32x32x16_bf16 v[64:79], a[128:131], a[208:211], v[64:79]
    s_add_u32 m0, s100, 114688
    s_nop 0
    buffer_load_dwordx4 v193, s[32:35], s46 offen offset:0 sc1 lds
    ds_read_b64_tr_b16 a[144:145], v200 offset:22528
    ds_read_b64_tr_b16 a[146:147], v200 offset:23040
    v_mfma_f32_32x32x16_bf16 v[80:95], a[128:131], a[212:215], v[80:95]
    ds_read_b64_tr_b16 a[148:149], v201 offset:22528
    ds_read_b64_tr_b16 a[150:151], v201 offset:23040
    v_mfma_f32_32x32x16_bf16 v[96:111], a[132:135], a[208:211], v[96:111]
    s_add_u32 m0, s100, 114688
    s_nop 0
    buffer_load_dwordx4 v193, s[32:35], s46 offen offset:1024 sc1 lds
    ds_read_b64_tr_b16 a[152:153], v200 offset:30720
    ds_read_b64_tr_b16 a[154:155], v200 offset:31232
    v_mfma_f32_32x32x16_bf16 v[112:127], a[132:135], a[212:215], v[112:127]
    ds_read_b64_tr_b16 a[156:157], v201 offset:30720
    ds_read_b64_tr_b16 a[158:159], v201 offset:31232
    v_mfma_f32_32x32x16_bf16 v[128:143], a[136:139], a[208:211], v[128:143]
    s_add_u32 m0, s100, 114688
    s_nop 0
    buffer_load_dwordx4 v193, s[32:35], s46 offen offset:2048 sc1 lds
    v_mfma_f32_32x32x16_bf16 v[144:159], a[136:139], a[212:215], v[144:159]
    v_mfma_f32_32x32x16_bf16 v[160:175], a[140:143], a[208:211], v[160:175]
    s_add_u32 m0, s100, 114688
    s_nop 0
    buffer_load_dwordx4 v193, s[32:35], s46 offen offset:3072 sc1 lds
    s_add_u32 s46, s46, 4096
    v_mfma_f32_32x32x16_bf16 v[176:191], a[140:143], a[212:215], v[176:191]
    s_waitcnt lgkmcnt(0)
    s_barrier
    s_waitcnt vmcnt(30) lgkmcnt(0)
    s_waitcnt vmcnt(17)
    v_mfma_f32_32x32x16_bf16 v[64:79], a[144:147], a[216:219], v[64:79]
    s_add_u32 m0, s100, 147456
    s_nop 0
    buffer_load_dwordx4 v193, s[32:35], s46 offen offset:0 sc1 lds
    ds_read_b64_tr_b16 a[96:97], v242 offset:16384
    v_mfma_f32_32x32x16_bf16 v[80:95], a[144:147], a[220:223], v[80:95]
    ds_read_b64_tr_b16 a[98:99], v242 offset:17408
    ds_read_b64_tr_b16 a[100:101], v243 offset:16384
    v_mfma_f32_32x32x16_bf16 v[96:111], a[148:151], a[216:219], v[96:111]
    s_add_u32 m0, s100, 147456
    s_nop 0
    buffer_load_dwordx4 v193, s[32:35], s46 offen offset:1024 sc1 lds
    ds_read_b64_tr_b16 a[102:103], v243 offset:17408
    v_mfma_f32_32x32x16_bf16 v[112:127], a[148:151], a[220:223], v[112:127]
    ds_read_b64_tr_b16 a[104:105], v242 offset:18432
    v_mfma_f32_32x32x16_bf16 v[128:143], a[152:155], a[216:219], v[128:143]
    s_add_u32 m0, s100, 147456
    s_nop 0
    buffer_load_dwordx4 v193, s[32:35], s46 offen offset:2048 sc1 lds
    ds_read_b64_tr_b16 a[106:107], v242 offset:19456
    ds_read_b64_tr_b16 a[108:109], v243 offset:18432
    v_mfma_f32_32x32x16_bf16 v[144:159], a[152:155], a[220:223], v[144:159]
    ds_read_b64_tr_b16 a[110:111], v243 offset:19456
    v_mfma_f32_32x32x16_bf16 v[160:175], a[156:159], a[216:219], v[160:175]
    s_add_u32 m0, s100, 147456
    s_nop 0
    buffer_load_dwordx4 v193, s[32:35], s46 offen offset:3072 sc1 lds
    s_add_u32 s46, s46, 4096
    v_mfma_f32_32x32x16_bf16 v[176:191], a[156:159], a[220:223], v[176:191]
    s_waitcnt lgkmcnt(0)
    s_nop 7
    s_add_u32 m0, s100, 16384
    s_nop 0
    buffer_load_dwordx4 v193, s[32:35], s46 offen offset:0 sc1 lds
    s_add_u32 m0, s100, 16384
    s_nop 0
    buffer_load_dwordx4 v193, s[32:35], s46 offen offset:1024 sc1 lds
    s_add_u32 m0, s100, 16384
    s_nop 0
    buffer_load_dwordx4 v193, s[32:35], s46 offen offset:2048 sc1 lds
    s_add_u32 m0, s100, 16384
    s_nop 0
    buffer_load_dwordx4 v193, s[32:35], s46 offen offset:3072 sc1 lds
    s_add_u32 s46, s46, 4096
    v_pk_mul_f32 v[64:65], v[64:65], s[52:53]
    v_pk_mul_f32 v[66:67], v[66:67], s[52:53]
    v_pk_mul_f32 v[68:69], v[68:69], s[52:53]
    v_pk_mul_f32 v[70:71], v[70:71], s[52:53]
    v_exp_f32 v64, v64
    v_exp_f32 v65, v65
    v_exp_f32 v66, v66
    v_exp_f32 v67, v67
    v_exp_f32 v68, v68
    v_exp_f32 v69, v69
    v_exp_f32 v70, v70
    v_exp_f32 v71, v71
    v_add_f32 v64, 1.0, v64
    v_add_f32 v65, 1.0, v65
    v_add_f32 v66, 1.0, v66
    v_add_f32 v67, 1.0, v67
    v_add_f32 v68, 1.0, v68
    v_add_f32 v69, 1.0, v69
    v_add_f32 v70, 1.0, v70
    v_add_f32 v71, 1.0, v71
    v_rcp_f32 v64, v64
    v_rcp_f32 v65, v65
    v_rcp_f32 v66, v66
    v_rcp_f32 v67, v67
    v_rcp_f32 v68, v68
    v_rcp_f32 v69, v69
    v_rcp_f32 v70, v70
    v_rcp_f32 v71, v71
    s_nop 0
    v_pk_mul_f32 v[64:65], v[64:65], v[128:129]
    v_pk_mul_f32 v[66:67], v[66:67], v[130:131]
    v_pk_mul_f32 v[68:69], v[68:69], v[132:133]
    v_pk_mul_f32 v[70:71], v[70:71], v[134:135]
    v_cvt_pk_bf16_f32 v128, v64, v65
    v_cvt_pk_bf16_f32 v129, v66, v67
    v_cvt_pk_bf16_f32 v130, v68, v69
    v_cvt_pk_bf16_f32 v131, v70, v71
    buffer_store_dwordx4 v[128:131], v225, s[32:35], s57 offen offset:0 sc1
    v_pk_mul_f32 v[72:73], v[72:73], s[52:53]
    v_pk_mul_f32 v[74:75], v[74:75], s[52:53]
    v_pk_mul_f32 v[76:77], v[76:77], s[52:53]
    v_pk_mul_f32 v[78:79], v[78:79], s[52:53]
    v_exp_f32 v72, v72
    v_exp_f32 v73, v73
    v_exp_f32 v74, v74
    v_exp_f32 v75, v75
    v_exp_f32 v76, v76
    v_exp_f32 v77, v77
    v_exp_f32 v78, v78
    v_exp_f32 v79, v79
    v_add_f32 v72, 1.0, v72
    v_add_f32 v73, 1.0, v73
    v_add_f32 v74, 1.0, v74
    v_add_f32 v75, 1.0, v75
    v_add_f32 v76, 1.0, v76
    v_add_f32 v77, 1.0, v77
    v_add_f32 v78, 1.0, v78
    v_add_f32 v79, 1.0, v79
    v_rcp_f32 v72, v72
    v_rcp_f32 v73, v73
    v_rcp_f32 v74, v74
    v_rcp_f32 v75, v75
    v_rcp_f32 v76, v76
    v_rcp_f32 v77, v77
    v_rcp_f32 v78, v78
    v_rcp_f32 v79, v79
    s_nop 0
    v_pk_mul_f32 v[72:73], v[72:73], v[136:137]
    v_pk_mul_f32 v[74:75], v[74:75], v[138:139]
    v_pk_mul_f32 v[76:77], v[76:77], v[140:141]
    v_pk_mul_f32 v[78:79], v[78:79], v[142:143]
    v_cvt_pk_bf16_f32 v136, v72, v73
    v_cvt_pk_bf16_f32 v137, v74, v75
    v_cvt_pk_bf16_f32 v138, v76, v77
    v_cvt_pk_bf16_f32 v139, v78, v79
    buffer_store_dwordx4 v[136:139], v225, s[32:35], s57 offen offset:1024 sc1
    v_pk_mul_f32 v[80:81], v[80:81], s[52:53]
    v_pk_mul_f32 v[82:83], v[82:83], s[52:53]
    v_pk_mul_f32 v[84:85], v[84:85], s[52:53]
    v_pk_mul_f32 v[86:87], v[86:87], s[52:53]
    v_exp_f32 v80, v80
    v_exp_f32 v81, v81
    v_exp_f32 v82, v82
    v_exp_f32 v83, v83
    v_exp_f32 v84, v84
    v_exp_f32 v85, v85
    v_exp_f32 v86, v86
    v_exp_f32 v87, v87
    v_add_f32 v80, 1.0, v80
    v_add_f32 v81, 1.0, v81
    v_add_f32 v82, 1.0, v82
    v_add_f32 v83, 1.0, v83
    v_add_f32 v84, 1.0, v84
    v_add_f32 v85, 1.0, v85
    v_add_f32 v86, 1.0, v86
    v_add_f32 v87, 1.0, v87
    v_rcp_f32 v80, v80
    v_rcp_f32 v81, v81
    v_rcp_f32 v82, v82
    v_rcp_f32 v83, v83
    v_rcp_f32 v84, v84
    v_rcp_f32 v85, v85
    v_rcp_f32 v86, v86
    v_rcp_f32 v87, v87
    s_nop 0
    v_pk_mul_f32 v[80:81], v[80:81], v[144:145]
    v_pk_mul_f32 v[82:83], v[82:83], v[146:147]
    v_pk_mul_f32 v[84:85], v[84:85], v[148:149]
    v_pk_mul_f32 v[86:87], v[86:87], v[150:151]
    v_cvt_pk_bf16_f32 v144, v80, v81
    v_cvt_pk_bf16_f32 v145, v82, v83
    v_cvt_pk_bf16_f32 v146, v84, v85
    v_cvt_pk_bf16_f32 v147, v86, v87
    buffer_store_dwordx4 v[144:147], v226, s[32:35], s57 offen offset:0 sc1
    v_pk_mul_f32 v[88:89], v[88:89], s[52:53]
    v_pk_mul_f32 v[90:91], v[90:91], s[52:53]
    v_pk_mul_f32 v[92:93], v[92:93], s[52:53]
    v_pk_mul_f32 v[94:95], v[94:95], s[52:53]
    v_exp_f32 v88, v88
    v_exp_f32 v89, v89
    v_exp_f32 v90, v90
    v_exp_f32 v91, v91
    v_exp_f32 v92, v92
    v_exp_f32 v93, v93
    v_exp_f32 v94, v94
    v_exp_f32 v95, v95
    v_add_f32 v88, 1.0, v88
    v_add_f32 v89, 1.0, v89
    v_add_f32 v90, 1.0, v90
    v_add_f32 v91, 1.0, v91
    v_add_f32 v92, 1.0, v92
    v_add_f32 v93, 1.0, v93
    v_add_f32 v94, 1.0, v94
    v_add_f32 v95, 1.0, v95
    v_rcp_f32 v88, v88
    v_rcp_f32 v89, v89
    v_rcp_f32 v90, v90
    v_rcp_f32 v91, v91
    v_rcp_f32 v92, v92
    v_rcp_f32 v93, v93
    v_rcp_f32 v94, v94
    v_rcp_f32 v95, v95
    s_nop 0
    v_pk_mul_f32 v[88:89], v[88:89], v[152:153]
    v_pk_mul_f32 v[90:91], v[90:91], v[154:155]
    v_pk_mul_f32 v[92:93], v[92:93], v[156:157]
    v_pk_mul_f32 v[94:95], v[94:95], v[158:159]
    v_cvt_pk_bf16_f32 v152, v88, v89
    v_cvt_pk_bf16_f32 v153, v90, v91
    v_cvt_pk_bf16_f32 v154, v92, v93
    v_cvt_pk_bf16_f32 v155, v94, v95
    buffer_store_dwordx4 v[152:155], v226, s[32:35], s57 offen offset:1024 sc1
    v_pk_mul_f32 v[96:97], v[96:97], s[52:53]
    v_pk_mul_f32 v[98:99], v[98:99], s[52:53]
    v_pk_mul_f32 v[100:101], v[100:101], s[52:53]
    v_pk_mul_f32 v[102:103], v[102:103], s[52:53]
    v_exp_f32 v96, v96
    v_exp_f32 v97, v97
    v_exp_f32 v98, v98
    v_exp_f32 v99, v99
    v_exp_f32 v100, v100
    v_exp_f32 v101, v101
    v_exp_f32 v102, v102
    v_exp_f32 v103, v103
    v_add_f32 v96, 1.0, v96
    v_add_f32 v97, 1.0, v97
    v_add_f32 v98, 1.0, v98
    v_add_f32 v99, 1.0, v99
    v_add_f32 v100, 1.0, v100
    v_add_f32 v101, 1.0, v101
    v_add_f32 v102, 1.0, v102
    v_add_f32 v103, 1.0, v103
    v_rcp_f32 v96, v96
    v_rcp_f32 v97, v97
    v_rcp_f32 v98, v98
    v_rcp_f32 v99, v99
    v_rcp_f32 v100, v100
    v_rcp_f32 v101, v101
    v_rcp_f32 v102, v102
    v_rcp_f32 v103, v103
    s_nop 0
    v_pk_mul_f32 v[96:97], v[96:97], v[160:161]
    v_pk_mul_f32 v[98:99], v[98:99], v[162:163]
    v_pk_mul_f32 v[100:101], v[100:101], v[164:165]
    v_pk_mul_f32 v[102:103], v[102:103], v[166:167]
    v_cvt_pk_bf16_f32 v160, v96, v97
    v_cvt_pk_bf16_f32 v161, v98, v99
    v_cvt_pk_bf16_f32 v162, v100, v101
    v_cvt_pk_bf16_f32 v163, v102, v103
    buffer_store_dwordx4 v[160:163], v225, s[32:35], s57 offen offset:2048 sc1
    v_pk_mul_f32 v[104:105], v[104:105], s[52:53]
    v_pk_mul_f32 v[106:107], v[106:107], s[52:53]
    v_pk_mul_f32 v[108:109], v[108:109], s[52:53]
    v_pk_mul_f32 v[110:111], v[110:111], s[52:53]
    v_exp_f32 v104, v104
    v_exp_f32 v105, v105
    v_exp_f32 v106, v106
    v_exp_f32 v107, v107
    v_exp_f32 v108, v108
    v_exp_f32 v109, v109
    v_exp_f32 v110, v110
    v_exp_f32 v111, v111
    v_add_f32 v104, 1.0, v104
    v_add_f32 v105, 1.0, v105
    v_add_f32 v106, 1.0, v106
    v_add_f32 v107, 1.0, v107
    v_add_f32 v108, 1.0, v108
    v_add_f32 v109, 1.0, v109
    v_add_f32 v110, 1.0, v110
    v_add_f32 v111, 1.0, v111
    v_rcp_f32 v104, v104
    v_rcp_f32 v105, v105
    v_rcp_f32 v106, v106
    v_rcp_f32 v107, v107
    v_rcp_f32 v108, v108
    v_rcp_f32 v109, v109
    v_rcp_f32 v110, v110
    v_rcp_f32 v111, v111
    s_nop 0
    v_pk_mul_f32 v[104:105], v[104:105], v[168:169]
    v_pk_mul_f32 v[106:107], v[106:107], v[170:171]
    v_pk_mul_f32 v[108:109], v[108:109], v[172:173]
    v_pk_mul_f32 v[110:111], v[110:111], v[174:175]
    v_cvt_pk_bf16_f32 v168, v104, v105
    v_cvt_pk_bf16_f32 v169, v106, v107
    v_cvt_pk_bf16_f32 v170, v108, v109
    v_cvt_pk_bf16_f32 v171, v110, v111
    buffer_store_dwordx4 v[168:171], v225, s[32:35], s57 offen offset:3072 sc1
    v_pk_mul_f32 v[112:113], v[112:113], s[52:53]
    v_pk_mul_f32 v[114:115], v[114:115], s[52:53]
    v_pk_mul_f32 v[116:117], v[116:117], s[52:53]
    v_pk_mul_f32 v[118:119], v[118:119], s[52:53]
    v_exp_f32 v112, v112
    v_exp_f32 v113, v113
    v_exp_f32 v114, v114
    v_exp_f32 v115, v115
    v_exp_f32 v116, v116
    v_exp_f32 v117, v117
    v_exp_f32 v118, v118
    v_exp_f32 v119, v119
    v_add_f32 v112, 1.0, v112
    v_add_f32 v113, 1.0, v113
    v_add_f32 v114, 1.0, v114
    v_add_f32 v115, 1.0, v115
    v_add_f32 v116, 1.0, v116
    v_add_f32 v117, 1.0, v117
    v_add_f32 v118, 1.0, v118
    v_add_f32 v119, 1.0, v119
    v_rcp_f32 v112, v112
    v_rcp_f32 v113, v113
    v_rcp_f32 v114, v114
    v_rcp_f32 v115, v115
    v_rcp_f32 v116, v116
    v_rcp_f32 v117, v117
    v_rcp_f32 v118, v118
    v_rcp_f32 v119, v119
    s_nop 0
    v_pk_mul_f32 v[112:113], v[112:113], v[176:177]
    v_pk_mul_f32 v[114:115], v[114:115], v[178:179]
    v_pk_mul_f32 v[116:117], v[116:117], v[180:181]
    v_pk_mul_f32 v[118:119], v[118:119], v[182:183]
    v_cvt_pk_bf16_f32 v176, v112, v113
    v_cvt_pk_bf16_f32 v177, v114, v115
    v_cvt_pk_bf16_f32 v178, v116, v117
    v_cvt_pk_bf16_f32 v179, v118, v119
    buffer_store_dwordx4 v[176:179], v226, s[32:35], s57 offen offset:2048 sc1
    v_pk_mul_f32 v[120:121], v[120:121], s[52:53]
    v_pk_mul_f32 v[122:123], v[122:123], s[52:53]
    v_pk_mul_f32 v[124:125], v[124:125], s[52:53]
    v_pk_mul_f32 v[126:127], v[126:127], s[52:53]
    v_exp_f32 v120, v120
    v_exp_f32 v121, v121
    v_exp_f32 v122, v122
    v_exp_f32 v123, v123
    v_exp_f32 v124, v124
    v_exp_f32 v125, v125
    v_exp_f32 v126, v126
    v_exp_f32 v127, v127
    v_add_f32 v120, 1.0, v120
    v_add_f32 v121, 1.0, v121
    v_add_f32 v122, 1.0, v122
    v_add_f32 v123, 1.0, v123
    v_add_f32 v124, 1.0, v124
    v_add_f32 v125, 1.0, v125
    v_add_f32 v126, 1.0, v126
    v_add_f32 v127, 1.0, v127
    v_rcp_f32 v120, v120
    v_rcp_f32 v121, v121
    v_rcp_f32 v122, v122
    v_rcp_f32 v123, v123
    v_rcp_f32 v124, v124
    v_rcp_f32 v125, v125
    v_rcp_f32 v126, v126
    v_rcp_f32 v127, v127
    s_nop 0
    v_pk_mul_f32 v[120:121], v[120:121], v[184:185]
    v_pk_mul_f32 v[122:123], v[122:123], v[186:187]
    v_pk_mul_f32 v[124:125], v[124:125], v[188:189]
    v_pk_mul_f32 v[126:127], v[126:127], v[190:191]
    v_cvt_pk_bf16_f32 v184, v120, v121
    v_cvt_pk_bf16_f32 v185, v122, v123
    v_cvt_pk_bf16_f32 v186, v124, v125
    v_cvt_pk_bf16_f32 v187, v126, v127
    buffer_store_dwordx4 v[184:187], v226, s[32:35], s57 offen offset:3072 sc1
    s_waitcnt vmcnt(24)
    s_barrier
    ds_read_b64_tr_b16 a[0:1], v210 offset:32768
    ds_read_b64_tr_b16 a[2:3], v210 offset:34816
    ds_read_b64_tr_b16 a[4:5], v211 offset:32768
    ds_read_b64_tr_b16 a[6:7], v211 offset:34816
    ds_read_b128 a[8:11], v196 offset:49152
    ds_read_b128 a[12:15], v196 offset:53248
    ds_read_b64_tr_b16 a[16:17], v210 offset:36864
    ds_read_b64_tr_b16 a[18:19], v210 offset:38912
    ds_read_b64_tr_b16 a[20:21], v211 offset:36864
    ds_read_b64_tr_b16 a[22:23], v211 offset:38912
    ds_read_b128 a[24:27], v196 offset:50176
    ds_read_b128 a[28:31], v196 offset:54272
    s_waitcnt lgkmcnt(6)
    v_mfma_f32_32x32x16_bf16 v[0:15], a[0:3], a[8:11], 0
    s_add_u32 m0, s40, 0
    s_nop 0
    buffer_load_dwordx4 v192, s[8:11], s45 offen lds
    s_add_u32 s45, s45, 16384
    ds_read_b64_tr_b16 a[32:33], v210 offset:40960
    v_mfma_f32_32x32x16_bf16 v[16:31], a[4:7], a[8:11], 0
    ds_read_b64_tr_b16 a[34:35], v210 offset:43008
    ds_read_b64_tr_b16 a[36:37], v211 offset:40960
    v_mfma_f32_32x32x16_bf16 v[32:47], a[0:3], a[12:15], 0
    s_add_u32 m0, s40, 4096
    s_nop 0
    buffer_load_dwordx4 v192, s[8:11], s45 offen lds
    s_add_u32 s45, s45, 16384
    ds_read_b64_tr_b16 a[38:39], v211 offset:43008
    v_mfma_f32_32x32x16_bf16 v[48:63], a[4:7], a[12:15], 0
    ds_read_b128 a[40:43], v196 offset:51200
    ds_read_b128 a[44:47], v196 offset:55296
    s_waitcnt lgkmcnt(6)
    v_mfma_f32_32x32x16_bf16 v[0:15], a[16:19], a[24:27], v[0:15]
    s_add_u32 m0, s40, 8192
    s_nop 0
    buffer_load_dwordx4 v192, s[8:11], s45 offen lds
    s_add_u32 s45, s45, 16384
    ds_read_b64_tr_b16 a[0:1], v210 offset:45056
    v_mfma_f32_32x32x16_bf16 v[16:31], a[20:23], a[24:27], v[16:31]
    ds_read_b64_tr_b16 a[2:3], v210 offset:47104
    ds_read_b64_tr_b16 a[4:5], v211 offset:45056
    v_mfma_f32_32x32x16_bf16 v[32:47], a[16:19], a[28:31], v[32:47]
    s_add_u32 m0, s40, 12288
    s_nop 0
    buffer_load_dwordx4 v192, s[8:11], s45 offen lds
    s_add_u32 s45, s45, 16384
    ds_read_b64_tr_b16 a[6:7], v211 offset:47104
    v_mfma_f32_32x32x16_bf16 v[48:63], a[20:23], a[28:31], v[48:63]
    ds_read_b128 a[8:11], v196 offset:52224
    ds_read_b128 a[12:15], v196 offset:56320
    s_waitcnt vmcnt(24) lgkmcnt(0)
    s_barrier
    s_waitcnt lgkmcnt(6)
    v_mfma_f32_32x32x16_bf16 v[0:15], a[32:35], a[40:43], v[0:15]
    s_add_u32 m0, s100, 49152
    s_nop 0
    buffer_load_dwordx4 v193, s[32:35], s46 offen offset:0 sc1 lds
    ds_read_b64_tr_b16 a[16:17], v212 offset:0
    v_mfma_f32_32x32x16_bf16 v[16:31], a[36:39], a[40:43], v[16:31]
    ds_read_b64_tr_b16 a[18:19], v212 offset:2048
    ds_read_b64_tr_b16 a[20:21], v213 offset:0
    v_mfma_f32_32x32x16_bf16 v[32:47], a[32:35], a[44:47], v[32:47]
    s_add_u32 m0, s100, 49152
    s_nop 0
    buffer_load_dwordx4 v193, s[32:35], s46 offen offset:1024 sc1 lds
    ds_read_b64_tr_b16 a[22:23], v213 offset:2048
    v_mfma_f32_32x32x16_bf16 v[48:63], a[36:39], a[44:47], v[48:63]
    ds_read_b128 a[24:27], v197 offset:16384
    ds_read_b128 a[28:31], v197 offset:20480
    s_waitcnt lgkmcnt(6)
    v_mfma_f32_32x32x16_bf16 v[0:15], a[0:3], a[8:11], v[0:15]
    s_add_u32 m0, s100, 49152
    s_nop 0
    buffer_load_dwordx4 v193, s[32:35], s46 offen offset:2048 sc1 lds
    ds_read_b64_tr_b16 a[32:33], v212 offset:4096
    v_mfma_f32_32x32x16_bf16 v[16:31], a[4:7], a[8:11], v[16:31]
    ds_read_b64_tr_b16 a[34:35], v212 offset:6144
    ds_read_b64_tr_b16 a[36:37], v213 offset:4096
    v_mfma_f32_32x32x16_bf16 v[32:47], a[0:3], a[12:15], v[32:47]
    s_add_u32 m0, s100, 49152
    s_nop 0
    buffer_load_dwordx4 v193, s[32:35], s46 offen offset:3072 sc1 lds
    s_add_u32 s46, s46, 4096
    ds_read_b64_tr_b16 a[38:39], v213 offset:6144
    v_mfma_f32_32x32x16_bf16 v[48:63], a[4:7], a[12:15], v[48:63]
    ds_read_b128 a[40:43], v197 offset:17408
    ds_read_b128 a[44:47], v197 offset:21504
    s_waitcnt lgkmcnt(6)
    v_mfma_f32_32x32x16_bf16 v[0:15], a[16:19], a[24:27], v[0:15]
    s_add_u32 m0, s40, 32768
    s_nop 0
    buffer_load_dwordx4 v192, s[8:11], s45 offen lds
    s_add_u32 s45, s45, 16384
    ds_read_b64_tr_b16 a[0:1], v212 offset:8192
    v_mfma_f32_32x32x16_bf16 v[16:31], a[20:23], a[24:27], v[16:31]
    ds_read_b64_tr_b16 a[2:3], v212 offset:10240
    ds_read_b64_tr_b16 a[4:5], v213 offset:8192
    v_mfma_f32_32x32x16_bf16 v[32:47], a[16:19], a[28:31], v[32:47]
    s_add_u32 m0, s40, 36864
    s_nop 0
    buffer_load_dwordx4 v192, s[8:11], s45 offen lds
    s_add_u32 s45, s45, 16384
    ds_read_b64_tr_b16 a[6:7], v213 offset:10240
    v_mfma_f32_32x32x16_bf16 v[48:63], a[20:23], a[28:31], v[48:63]
    ds_read_b128 a[8:11], v197 offset:18432
    ds_read_b128 a[12:15], v197 offset:22528
    s_waitcnt lgkmcnt(6)
    v_mfma_f32_32x32x16_bf16 v[0:15], a[32:35], a[40:43], v[0:15]
    s_add_u32 m0, s40, 40960
    s_nop 0
    buffer_load_dwordx4 v192, s[8:11], s45 offen lds
    s_add_u32 s45, s45, 16384
    ds_read_b64_tr_b16 a[16:17], v212 offset:12288
    v_mfma_f32_32x32x16_bf16 v[16:31], a[36:39], a[40:43], v[16:31]
    ds_read_b64_tr_b16 a[18:19], v212 offset:14336
    ds_read_b64_tr_b16 a[20:21], v213 offset:12288
    v_mfma_f32_32x32x16_bf16 v[32:47], a[32:35], a[44:47], v[32:47]
    s_add_u32 m0, s40, 45056
    s_nop 0
    buffer_load_dwordx4 v192, s[8:11], s45 offen lds
    s_add_u32 s45, s45, 16384
    ds_read_b64_tr_b16 a[22:23], v213 offset:14336
    v_mfma_f32_32x32x16_bf16 v[48:63], a[36:39], a[44:47], v[48:63]
    ds_read_b128 a[24:27], v197 offset:19456
    ds_read_b128 a[28:31], v197 offset:23552
    s_waitcnt vmcnt(28) lgkmcnt(0)
    s_barrier
    s_waitcnt lgkmcnt(6)
    v_mfma_f32_32x32x16_bf16 v[0:15], a[0:3], a[8:11], v[0:15]
    s_add_u32 m0, s100, 81920
    s_nop 0
    buffer_load_dwordx4 v193, s[32:35], s46 offen offset:0 sc1 lds
    ds_read_b64_tr_b16 a[32:33], v212 offset:32768
    v_mfma_f32_32x32x16_bf16 v[16:31], a[4:7], a[8:11], v[16:31]
    ds_read_b64_tr_b16 a[34:35], v212 offset:34816
    ds_read_b64_tr_b16 a[36:37], v213 offset:32768
    v_mfma_f32_32x32x16_bf16 v[32:47], a[0:3], a[12:15], v[32:47]
    s_add_u32 m0, s100, 81920
    s_nop 0
    buffer_load_dwordx4 v193, s[32:35], s46 offen offset:1024 sc1 lds
    ds_read_b64_tr_b16 a[38:39], v213 offset:34816
    v_mfma_f32_32x32x16_bf16 v[48:63], a[4:7], a[12:15], v[48:63]
    ds_read_b128 a[40:43], v197 offset:49152
    ds_read_b128 a[44:47], v197 offset:53248
    s_waitcnt lgkmcnt(6)
    v_mfma_f32_32x32x16_bf16 v[0:15], a[16:19], a[24:27], v[0:15]
    s_add_u32 m0, s100, 81920
    s_nop 0
    buffer_load_dwordx4 v193, s[32:35], s46 offen offset:2048 sc1 lds
    ds_read_b64_tr_b16 a[0:1], v212 offset:36864
    v_mfma_f32_32x32x16_bf16 v[16:31], a[20:23], a[24:27], v[16:31]
    ds_read_b64_tr_b16 a[2:3], v212 offset:38912
    ds_read_b64_tr_b16 a[4:5], v213 offset:36864
    v_mfma_f32_32x32x16_bf16 v[32:47], a[16:19], a[28:31], v[32:47]
    s_add_u32 m0, s100, 81920
    s_nop 0
    buffer_load_dwordx4 v193, s[32:35], s46 offen offset:3072 sc1 lds
    s_add_u32 s46, s46, 4096
    ds_read_b64_tr_b16 a[6:7], v213 offset:38912
    v_mfma_f32_32x32x16_bf16 v[48:63], a[20:23], a[28:31], v[48:63]
    ds_read_b128 a[8:11], v197 offset:50176
    ds_read_b128 a[12:15], v197 offset:54272
    s_waitcnt lgkmcnt(6)
    v_mfma_f32_32x32x16_bf16 v[0:15], a[32:35], a[40:43], v[0:15]
    s_add_u32 m0, s40, 65536
    s_nop 0
    buffer_load_dwordx4 v192, s[8:11], s45 offen lds
    s_add_u32 s45, s45, 16384
    ds_read_b64_tr_b16 a[16:17], v212 offset:40960
    v_mfma_f32_32x32x16_bf16 v[16:31], a[36:39], a[40:43], v[16:31]
    ds_read_b64_tr_b16 a[18:19], v212 offset:43008
    ds_read_b64_tr_b16 a[20:21], v213 offset:40960
    v_mfma_f32_32x32x16_bf16 v[32:47], a[32:35], a[44:47], v[32:47]
    s_add_u32 m0, s40, 69632
    s_nop 0
    buffer_load_dwordx4 v192, s[8:11], s45 offen lds
    s_add_u32 s45, s45, 16384
    ds_read_b64_tr_b16 a[22:23], v213 offset:43008
    v_mfma_f32_32x32x16_bf16 v[48:63], a[36:39], a[44:47], v[48:63]
    ds_read_b128 a[24:27], v197 offset:51200
    ds_read_b128 a[28:31], v197 offset:55296
    s_waitcnt lgkmcnt(6)
    v_mfma_f32_32x32x16_bf16 v[0:15], a[0:3], a[8:11], v[0:15]
    s_add_u32 m0, s40, 73728
    s_nop 0
    buffer_load_dwordx4 v192, s[8:11], s45 offen lds
    s_add_u32 s45, s45, 16384
    ds_read_b64_tr_b16 a[32:33], v212 offset:45056
    v_mfma_f32_32x32x16_bf16 v[16:31], a[4:7], a[8:11], v[16:31]
    ds_read_b64_tr_b16 a[34:35], v212 offset:47104
    ds_read_b64_tr_b16 a[36:37], v213 offset:45056
    v_mfma_f32_32x32x16_bf16 v[32:47], a[0:3], a[12:15], v[32:47]
    s_add_u32 m0, s40, 77824
    s_nop 0
    buffer_load_dwordx4 v192, s[8:11], s45 offen lds
    s_add_u32 s45, s45, 16384
    ds_read_b64_tr_b16 a[38:39], v213 offset:47104
    v_mfma_f32_32x32x16_bf16 v[48:63], a[4:7], a[12:15], v[48:63]
    ds_read_b128 a[40:43], v197 offset:52224
    ds_read_b128 a[44:47], v197 offset:56320
    s_waitcnt vmcnt(32) lgkmcnt(0)
    s_barrier
    s_waitcnt lgkmcnt(6)
    v_mfma_f32_32x32x16_bf16 v[0:15], a[16:19], a[24:27], v[0:15]
    s_add_u32 m0, s100, 114688
    s_nop 0
    buffer_load_dwordx4 v193, s[32:35], s46 offen offset:0 sc1 lds
    ds_read_b64_tr_b16 a[0:1], v214 offset:0
    v_mfma_f32_32x32x16_bf16 v[16:31], a[20:23], a[24:27], v[16:31]
    ds_read_b64_tr_b16 a[2:3], v214 offset:2048
    ds_read_b64_tr_b16 a[4:5], v215 offset:0
    v_mfma_f32_32x32x16_bf16 v[32:47], a[16:19], a[28:31], v[32:47]
    s_add_u32 m0, s100, 114688
    s_nop 0
    buffer_load_dwordx4 v193, s[32:35], s46 offen offset:1024 sc1 lds
    ds_read_b64_tr_b16 a[6:7], v215 offset:2048
    v_mfma_f32_32x32x16_bf16 v[48:63], a[20:23], a[28:31], v[48:63]
    ds_read_b128 a[8:11], v198 offset:16384
    ds_read_b128 a[12:15], v198 offset:20480
    s_waitcnt lgkmcnt(6)
    v_mfma_f32_32x32x16_bf16 v[0:15], a[32:35], a[40:43], v[0:15]
    s_add_u32 m0, s100, 114688
    s_nop 0
    buffer_load_dwordx4 v193, s[32:35], s46 offen offset:2048 sc1 lds
    ds_read_b64_tr_b16 a[16:17], v214 offset:4096
    v_mfma_f32_32x32x16_bf16 v[16:31], a[36:39], a[40:43], v[16:31]
    ds_read_b64_tr_b16 a[18:19], v214 offset:6144
    ds_read_b64_tr_b16 a[20:21], v215 offset:4096
    v_mfma_f32_32x32x16_bf16 v[32:47], a[32:35], a[44:47], v[32:47]
    s_add_u32 m0, s100, 114688
    s_nop 0
    buffer_load_dwordx4 v193, s[32:35], s46 offen offset:3072 sc1 lds
    s_add_u32 s46, s46, 4096
    ds_read_b64_tr_b16 a[22:23], v215 offset:6144
    v_mfma_f32_32x32x16_bf16 v[48:63], a[36:39], a[44:47], v[48:63]
    ds_read_b128 a[24:27], v198 offset:17408
    ds_read_b128 a[28:31], v198 offset:21504
    s_waitcnt lgkmcnt(6)
    v_mfma_f32_32x32x16_bf16 v[0:15], a[0:3], a[8:11], v[0:15]
    s_add_u32 m0, s40, 98304
    s_nop 0
    buffer_load_dwordx4 v192, s[8:11], s45 offen lds
    s_add_u32 s45, s45, 16384
    ds_read_b64_tr_b16 a[32:33], v214 offset:8192
    v_mfma_f32_32x32x16_bf16 v[16:31], a[4:7], a[8:11], v[16:31]
    ds_read_b64_tr_b16 a[34:35], v214 offset:10240
    ds_read_b64_tr_b16 a[36:37], v215 offset:8192
    v_mfma_f32_32x32x16_bf16 v[32:47], a[0:3], a[12:15], v[32:47]
    s_add_u32 m0, s40, 102400
    s_nop 0
    buffer_load_dwordx4 v192, s[8:11], s45 offen lds
    s_add_u32 s45, s45, 16384
    ds_read_b64_tr_b16 a[38:39], v215 offset:10240
    v_mfma_f32_32x32x16_bf16 v[48:63], a[4:7], a[12:15], v[48:63]
    ds_read_b128 a[40:43], v198 offset:18432
    ds_read_b128 a[44:47], v198 offset:22528
    s_waitcnt lgkmcnt(6)
    v_mfma_f32_32x32x16_bf16 v[0:15], a[16:19], a[24:27], v[0:15]
    s_add_u32 m0, s40, 106496
    s_nop 0
    buffer_load_dwordx4 v192, s[8:11], s45 offen lds
    s_add_u32 s45, s45, 16384
    ds_read_b64_tr_b16 a[0:1], v214 offset:12288
    v_mfma_f32_32x32x16_bf16 v[16:31], a[20:23], a[24:27], v[16:31]
    ds_read_b64_tr_b16 a[2:3], v214 offset:14336
    ds_read_b64_tr_b16 a[4:5], v215 offset:12288
    v_mfma_f32_32x32x16_bf16 v[32:47], a[16:19], a[28:31], v[32:47]
    s_add_u32 m0, s40, 110592
    s_nop 0
    buffer_load_dwordx4 v192, s[8:11], s45 offen lds
    s_add_u32 s45, s45, 16384
    ds_read_b64_tr_b16 a[6:7], v215 offset:14336
    v_mfma_f32_32x32x16_bf16 v[48:63], a[20:23], a[28:31], v[48:63]
    ds_read_b128 a[8:11], v198 offset:19456
    ds_read_b128 a[12:15], v198 offset:23552
    s_waitcnt vmcnt(24) lgkmcnt(0)
    s_barrier
    s_waitcnt lgkmcnt(6)
    v_mfma_f32_32x32x16_bf16 v[0:15], a[32:35], a[40:43], v[0:15]
    s_cmp_lg_u32 s36, 0
    s_cbranch_scc1 FS_H
    v_mov_b32 v248, s62
    v_mov_b32 v249, 0
    s_mov_b64 exec, 1
    buffer_store_dword v248, v249, s[68:71], s63 offen offset:8 sc1
    s_mov_b64 exec, -1
FS_H:
    ds_read_b64_tr_b16 a[16:17], v210 offset:0
    v_mfma_f32_32x32x16_bf16 v[16:31], a[36:39], a[40:43], v[16:31]
    ds_read_b64_tr_b16 a[18:19], v210 offset:2048
    ds_read_b64_tr_b16 a[20:21], v211 offset:0
    v_mfma_f32_32x32x16_bf16 v[32:47], a[32:35], a[44:47], v[32:47]
    s_add_u32 m0, s100, 147456
    s_nop 0
    buffer_load_dwordx4 v193, s[32:35], s46 offen offset:0 sc1 lds
    ds_read_b64_tr_b16 a[22:23], v211 offset:2048
    v_mfma_f32_32x32x16_bf16 v[48:63], a[36:39], a[44:47], v[48:63]
    ds_read_b128 a[24:27], v196 offset:16384
    ds_read_b128 a[28:31], v196 offset:20480
    s_waitcnt lgkmcnt(6)
    v_mfma_f32_32x32x16_bf16 v[0:15], a[0:3], a[8:11], v[0:15]
    s_add_u32 m0, s100, 147456
    s_nop 0
    buffer_load_dwordx4 v193, s[32:35], s46 offen offset:1024 sc1 lds
    ds_read_b64_tr_b16 a[32:33], v210 offset:4096
    v_mfma_f32_32x32x16_bf16 v[16:31], a[4:7], a[8:11], v[16:31]
    ds_read_b64_tr_b16 a[34:35], v210 offset:6144
    ds_read_b64_tr_b16 a[36:37], v211 offset:4096
    v_mfma_f32_32x32x16_bf16 v[32:47], a[0:3], a[12:15], v[32:47]
    s_add_u32 m0, s100, 147456
    s_nop 0
    buffer_load_dwordx4 v193, s[32:35], s46 offen offset:2048 sc1 lds
    ds_read_b64_tr_b16 a[38:39], v211 offset:6144
    v_mfma_f32_32x32x16_bf16 v[48:63], a[4:7], a[12:15], v[48:63]
    ds_read_b128 a[40:43], v196 offset:17408
    ds_read_b128 a[44:47], v196 offset:21504
    s_waitcnt lgkmcnt(6)
    v_mfma_f32_32x32x16_bf16 v[0:15], a[16:19], a[24:27], v[0:15]
    s_add_u32 m0, s100, 147456
    s_nop 0
    buffer_load_dwordx4 v193, s[32:35], s46 offen offset:3072 sc1 lds
    s_add_u32 s46, s46, 4096
    ds_read_b64_tr_b16 a[0:1], v210 offset:8192
    v_mfma_f32_32x32x16_bf16 v[16:31], a[20:23], a[24:27], v[16:31]
    ds_read_b64_tr_b16 a[2:3], v210 offset:10240
    ds_read_b64_tr_b16 a[4:5], v211 offset:8192
    v_mfma_f32_32x32x16_bf16 v[32:47], a[16:19], a[28:31], v[32:47]
    s_add_u32 m0, s40, 131072
    s_nop 0
    buffer_load_dwordx4 v192, s[8:11], s45 offen lds
    s_add_u32 s45, s45, 16384
    ds_read_b64_tr_b16 a[6:7], v211 offset:10240
    v_mfma_f32_32x32x16_bf16 v[48:63], a[20:23], a[28:31], v[48:63]
    ds_read_b128 a[8:11], v196 offset:18432
    ds_read_b128 a[12:15], v196 offset:22528
    s_waitcnt lgkmcnt(6)
    v_mfma_f32_32x32x16_bf16 v[0:15], a[32:35], a[40:43], v[0:15]
    s_add_u32 m0, s40, 135168
    s_nop 0
    buffer_load_dwordx4 v192, s[8:11], s45 offen lds
    s_add_u32 s45, s45, 16384
    ds_read_b64_tr_b16 a[16:17], v210 offset:12288
    v_mfma_f32_32x32x16_bf16 v[16:31], a[36:39], a[40:43], v[16:31]
    ds_read_b64_tr_b16 a[18:19], v210 offset:14336
    ds_read_b64_tr_b16 a[20:21], v211 offset:12288
    v_mfma_f32_32x32x16_bf16 v[32:47], a[32:35], a[44:47], v[32:47]
    s_add_u32 m0, s40, 139264
    s_nop 0
    buffer_load_dwordx4 v192, s[8:11], s45 offen lds
    s_add_u32 s45, s45, 16384
    ds_read_b64_tr_b16 a[22:23], v211 offset:14336
    v_mfma_f32_32x32x16_bf16 v[48:63], a[36:39], a[44:47], v[48:63]
    ds_read_b128 a[24:27], v196 offset:19456
    ds_read_b128 a[28:31], v196 offset:23552
    s_waitcnt vmcnt(23) lgkmcnt(0)
    s_barrier
    s_waitcnt lgkmcnt(6)
    v_mfma_f32_32x32x16_bf16 v[0:15], a[0:3], a[8:11], v[0:15]
    s_add_u32 m0, s40, 143360
    s_nop 0
    buffer_load_dwordx4 v192, s[8:11], s45 offen lds
    s_add_u32 s45, s45, 16384
    ds_read_b64_tr_b16 a[32:33], v210 offset:32768
    v_mfma_f32_32x32x16_bf16 v[16:31], a[4:7], a[8:11], v[16:31]
    ds_read_b64_tr_b16 a[34:35], v210 offset:34816
    ds_read_b64_tr_b16 a[36:37], v211 offset:32768
    v_mfma_f32_32x32x16_bf16 v[32:47], a[0:3], a[12:15], v[32:47]
    buffer_load_dword v253, v252, s[64:67], s101 offen
    s_xor_b32 s101, s101, 0x100000
    ds_read_b64_tr_b16 a[38:39], v211 offset:34816
    v_mfma_f32_32x32x16_bf16 v[48:63], a[4:7], a[12:15], v[48:63]
    ds_read_b128 a[40:43], v196 offset:49152
    ds_read_b128 a[44:47], v196 offset:53248
    s_waitcnt lgkmcnt(6)
    v_mfma_f32_32x32x16_bf16 v[0:15], a[16:19], a[24:27], v[0:15]
    s_add_u32 m0, s100, 16384
    s_nop 0
    buffer_load_dwordx4 v193, s[32:35], s46 offen offset:0 sc1 lds
    ds_read_b64_tr_b16 a[0:1], v210 offset:36864
    v_mfma_f32_32x32x16_bf16 v[16:31], a[20:23], a[24:27], v[16:31]
    ds_read_b64_tr_b16 a[2:3], v210 offset:38912
    ds_read_b64_tr_b16 a[4:5], v211 offset:36864
    v_mfma_f32_32x32x16_bf16 v[32:47], a[16:19], a[28:31], v[32:47]
    s_add_u32 m0, s100, 16384
    s_nop 0
    buffer_load_dwordx4 v193, s[32:35], s46 offen offset:1024 sc1 lds
    ds_read_b64_tr_b16 a[6:7], v211 offset:38912
    v_mfma_f32_32x32x16_bf16 v[48:63], a[20:23], a[28:31], v[48:63]
    ds_read_b128 a[8:11], v196 offset:50176
    ds_read_b128 a[12:15], v196 offset:54272
    s_waitcnt lgkmcnt(6)
    v_mfma_f32_32x32x16_bf16 v[0:15], a[32:35], a[40:43], v[0:15]
    s_add_u32 m0, s100, 16384
    s_nop 0
    buffer_load_dwordx4 v193, s[32:35], s46 offen offset:2048 sc1 lds
    ds_read_b64_tr_b16 a[16:17], v210 offset:40960
    v_mfma_f32_32x32x16_bf16 v[16:31], a[36:39], a[40:43], v[16:31]
    ds_read_b64_tr_b16 a[18:19], v210 offset:43008
    ds_read_b64_tr_b16 a[20:21], v211 offset:40960
    v_mfma_f32_32x32x16_bf16 v[32:47], a[32:35], a[44:47], v[32:47]
    s_add_u32 m0, s100, 16384
    s_nop 0
    buffer_load_dwordx4 v193, s[32:35], s46 offen offset:3072 sc1 lds
    s_add_u32 s46, s46, 4096
    ds_read_b64_tr_b16 a[22:23], v211 offset:43008
    v_mfma_f32_32x32x16_bf16 v[48:63], a[36:39], a[44:47], v[48:63]
    ds_read_b128 a[24:27], v196 offset:51200
    ds_read_b128 a[28:31], v196 offset:55296
    s_waitcnt lgkmcnt(6)
    v_mfma_f32_32x32x16_bf16 v[0:15], a[0:3], a[8:11], v[0:15]
    s_add_u32 m0, s40, 0
    s_nop 0
    buffer_load_dwordx4 v192, s[8:11], s45 offen lds
    s_add_u32 s45, s45, 16384
    ds_read_b64_tr_b16 a[32:33], v210 offset:45056
    v_mfma_f32_32x32x16_bf16 v[16:31], a[4:7], a[8:11], v[16:31]
    ds_read_b64_tr_b16 a[34:35], v210 offset:47104
    ds_read_b64_tr_b16 a[36:37], v211 offset:45056
    v_mfma_f32_32x32x16_bf16 v[32:47], a[0:3], a[12:15], v[32:47]
    s_add_u32 m0, s40, 4096
    s_nop 0
    buffer_load_dwordx4 v192, s[8:11], s45 offen lds
    s_add_u32 s45, s45, 16384
    ds_read_b64_tr_b16 a[38:39], v211 offset:47104
    v_mfma_f32_32x32x16_bf16 v[48:63], a[4:7], a[12:15], v[48:63]
    ds_read_b128 a[40:43], v196 offset:52224
    ds_read_b128 a[44:47], v196 offset:56320
    s_waitcnt vmcnt(23) lgkmcnt(0)
    s_barrier
    s_waitcnt lgkmcnt(6)
    v_mfma_f32_32x32x16_bf16 v[0:15], a[16:19], a[24:27], v[0:15]
    s_add_u32 m0, s40, 8192
    s_nop 0
    buffer_load_dwordx4 v192, s[8:11], s45 offen lds
    s_add_u32 s45, s45, 16384
    ds_read_b64_tr_b16 a[0:1], v212 offset:0
    v_mfma_f32_32x32x16_bf16 v[16:31], a[20:23], a[24:27], v[16:31]
    ds_read_b64_tr_b16 a[2:3], v212 offset:2048
    ds_read_b64_tr_b16 a[4:5], v213 offset:0
    v_mfma_f32_32x32x16_bf16 v[32:47], a[16:19], a[28:31], v[32:47]
    s_add_u32 m0, s40, 12288
    s_nop 0
    buffer_load_dwordx4 v192, s[8:11], s45 offen lds
    s_add_u32 s45, s45, 16384
    ds_read_b64_tr_b16 a[6:7], v213 offset:2048
    v_mfma_f32_32x32x16_bf16 v[48:63], a[20:23], a[28:31], v[48:63]
    ds_read_b128 a[8:11], v197 offset:16384
    ds_read_b128 a[12:15], v197 offset:20480
    s_waitcnt lgkmcnt(6)
    v_mfma_f32_32x32x16_bf16 v[0:15], a[32:35], a[40:43], v[0:15]
    s_add_u32 m0, s100, 49152
    s_nop 0
    buffer_load_dwordx4 v193, s[32:35], s46 offen offset:0 sc1 lds
    ds_read_b64_tr_b16 a[16:17], v212 offset:4096
    v_mfma_f32_32x32x16_bf16 v[16:31], a[36:39], a[40:43], v[16:31]
    ds_read_b64_tr_b16 a[18:19], v212 offset:6144
    ds_read_b64_tr_b16 a[20:21], v213 offset:4096
    v_mfma_f32_32x32x16_bf16 v[32:47], a[32:35], a[44:47], v[32:47]
    s_add_u32 m0, s100, 49152
    s_nop 0
    buffer_load_dwordx4 v193, s[32:35], s46 offen offset:1024 sc1 lds
    ds_read_b64_tr_b16 a[22:23], v213 offset:6144
    v_mfma_f32_32x32x16_bf16 v[48:63], a[36:39], a[44:47], v[48:63]
    ds_read_b128 a[24:27], v197 offset:17408
    ds_read_b128 a[28:31], v197 offset:21504
    s_waitcnt lgkmcnt(6)
    v_mfma_f32_32x32x16_bf16 v[0:15], a[0:3], a[8:11], v[0:15]
    s_add_u32 m0, s100, 49152
    s_nop 0
    buffer_load_dwordx4 v193, s[32:35], s46 offen offset:2048 sc1 lds
    ds_read_b64_tr_b16 a[32:33], v212 offset:8192
    v_mfma_f32_32x32x16_bf16 v[16:31], a[4:7], a[8:11], v[16:31]
    ds_read_b64_tr_b16 a[34:35], v212 offset:10240
    ds_read_b64_tr_b16 a[36:37], v213 offset:8192
    v_mfma_f32_32x32x16_bf16 v[32:47], a[0:3], a[12:15], v[32:47]
    s_add_u32 m0, s100, 49152
    s_nop 0
    buffer_load_dwordx4 v193, s[32:35], s46 offen offset:3072 sc1 lds
    s_add_u32 s46, s46, 4096
    ds_read_b64_tr_b16 a[38:39], v213 offset:10240
    v_mfma_f32_32x32x16_bf16 v[48:63], a[4:7], a[12:15], v[48:63]
    ds_read_b128 a[40:43], v197 offset:18432
    ds_read_b128 a[44:47], v197 offset:22528
    s_waitcnt lgkmcnt(6)
    v_mfma_f32_32x32x16_bf16 v[0:15], a[16:19], a[24:27], v[0:15]
    s_add_u32 m0, s40, 32768
    s_nop 0
    buffer_load_dwordx4 v192, s[8:11], s45 offen lds
    s_add_u32 s45, s45, 16384
    ds_read_b64_tr_b16 a[0:1], v212 offset:12288
    v_mfma_f32_32x32x16_bf16 v[16:31], a[20:23], a[24:27], v[16:31]
    ds_read_b64_tr_b16 a[2:3], v212 offset:14336
    ds_read_b64_tr_b16 a[4:5], v213 offset:12288
    v_mfma_f32_32x32x16_bf16 v[32:47], a[16:19], a[28:31], v[32:47]
    s_add_u32 m0, s40, 36864
    s_nop 0
    buffer_load_dwordx4 v192, s[8:11], s45 offen lds
    s_add_u32 s45, s45, 16384
    ds_read_b64_tr_b16 a[6:7], v213 offset:14336
    v_mfma_f32_32x32x16_bf16 v[48:63], a[20:23], a[28:31], v[48:63]
    ds_read_b128 a[8:11], v197 offset:19456
    ds_read_b128 a[12:15], v197 offset:23552
    s_waitcnt vmcnt(23) lgkmcnt(0)
    s_barrier
    s_waitcnt lgkmcnt(6)
    v_mfma_f32_32x32x16_bf16 v[0:15], a[32:35], a[40:43], v[0:15]
    s_add_u32 m0, s40, 40960
    s_nop 0
    buffer_load_dwordx4 v192, s[8:11], s45 offen lds
    s_add_u32 s45, s45, 16384
    ds_read_b64_tr_b16 a[16:17], v212 offset:32768
    v_mfma_f32_32x32x16_bf16 v[16:31], a[36:39], a[40:43], v[16:31]
    ds_read_b64_tr_b16 a[18:19], v212 offset:34816
    ds_read_b64_tr_b16 a[20:21], v213 offset:32768
    v_mfma_f32_32x32x16_bf16 v[32:47], a[32:35], a[44:47], v[32:47]
    s_add_u32 m0, s40, 45056
    s_nop 0
    buffer_load_dwordx4 v192, s[8:11], s45 offen lds
    s_add_u32 s45, s45, 16384
    ds_read_b64_tr_b16 a[22:23], v213 offset:34816
    v_mfma_f32_32x32x16_bf16 v[48:63], a[36:39], a[44:47], v[48:63]
    ds_read_b128 a[24:27], v197 offset:49152
    ds_read_b128 a[28:31], v197 offset:53248
    s_waitcnt lgkmcnt(6)
    v_mfma_f32_32x32x16_bf16 v[0:15], a[0:3], a[8:11], v[0:15]
    s_add_u32 m0, s100, 81920
    s_nop 0
    buffer_load_dwordx4 v193, s[32:35], s46 offen offset:0 sc1 lds
    ds_read_b64_tr_b16 a[32:33], v212 offset:36864
    v_mfma_f32_32x32x16_bf16 v[16:31], a[4:7], a[8:11], v[16:31]
    ds_read_b64_tr_b16 a[34:35], v212 offset:38912
    ds_read_b64_tr_b16 a[36:37], v213 offset:36864
    v_mfma_f32_32x32x16_bf16 v[32:47], a[0:3], a[12:15], v[32:47]
    s_add_u32 m0, s100, 81920
    s_nop 0
    buffer_load_dwordx4 v193, s[32:35], s46 offen offset:1024 sc1 lds
    ds_read_b64_tr_b16 a[38:39], v213 offset:38912
    v_mfma_f32_32x32x16_bf16 v[48:63], a[4:7], a[12:15], v[48:63]
    ds_read_b128 a[40:43], v197 offset:50176
    ds_read_b128 a[44:47], v197 offset:54272
    s_waitcnt lgkmcnt(6)
    v_mfma_f32_32x32x16_bf16 v[0:15], a[16:19], a[24:27], v[0:15]
    s_add_u32 m0, s100, 81920
    s_nop 0
    buffer_load_dwordx4 v193, s[32:35], s46 offen offset:2048 sc1 lds
    ds_read_b64_tr_b16 a[0:1], v212 offset:40960
    v_mfma_f32_32x32x16_bf16 v[16:31], a[20:23], a[24:27], v[16:31]
    ds_read_b64_tr_b16 a[2:3], v212 offset:43008
    ds_read_b64_tr_b16 a[4:5], v213 offset:40960
    v_mfma_f32_32x32x16_bf16 v[32:47], a[16:19], a[28:31], v[32:47]
    buffer_load_dword v253, v252, s[64:67], s101 offen
    s_xor_b32 s101, s101, 0x100000
    ds_read_b64_tr_b16 a[6:7], v213 offset:43008
    v_mfma_f32_32x32x16_bf16 v[48:63], a[20:23], a[28:31], v[48:63]
    ds_read_b128 a[8:11], v197 offset:51200
    ds_read_b128 a[12:15], v197 offset:55296
    s_waitcnt lgkmcnt(6)
    v_mfma_f32_32x32x16_bf16 v[0:15], a[32:35], a[40:43], v[0:15]
    s_add_u32 m0, s100, 81920
    s_nop 0
    buffer_load_dwordx4 v193, s[32:35], s46 offen offset:3072 sc1 lds
    s_add_u32 s46, s46, 4096
    ds_read_b64_tr_b16 a[16:17], v212 offset:45056
    v_mfma_f32_32x32x16_bf16 v[16:31], a[36:39], a[40:43], v[16:31]
    ds_read_b64_tr_b16 a[18:19], v212 offset:47104
    ds_read_b64_tr_b16 a[20:21], v213 offset:45056
    v_mfma_f32_32x32x16_bf16 v[32:47], a[32:35], a[44:47], v[32:47]
    s_add_u32 m0, s40, 65536
    s_nop 0
    buffer_load_dwordx4 v192, s[8:11], s45 offen lds
    s_add_u32 s45, s45, 16384
    ds_read_b64_tr_b16 a[22:23], v213 offset:47104
    v_mfma_f32_32x32x16_bf16 v[48:63], a[36:39], a[44:47], v[48:63]
    ds_read_b128 a[24:27], v197 offset:52224
    ds_read_b128 a[28:31], v197 offset:56320
    s_waitcnt vmcnt(23) lgkmcnt(0)
    s_barrier
    s_waitcnt lgkmcnt(6)
    v_mfma_f32_32x32x16_bf16 v[0:15], a[0:3], a[8:11], v[0:15]
    s_add_u32 m0, s40, 69632
    s_nop 0
    buffer_load_dwordx4 v192, s[8:11], s45 offen lds
    s_add_u32 s45, s45, 16384
    ds_read_b64_tr_b16 a[32:33], v214 offset:0
    v_mfma_f32_32x32x16_bf16 v[16:31], a[4:7], a[8:11], v[16:31]
    ds_read_b64_tr_b16 a[34:35], v214 offset:2048
    ds_read_b64_tr_b16 a[36:37], v215 offset:0
    v_mfma_f32_32x32x16_bf16 v[32:47], a[0:3], a[12:15], v[32:47]
    s_add_u32 m0, s40, 73728
    s_nop 0
    buffer_load_dwordx4 v192, s[8:11], s45 offen lds
    s_add_u32 s45, s45, 16384
    ds_read_b64_tr_b16 a[38:39], v215 offset:2048
    v_mfma_f32_32x32x16_bf16 v[48:63], a[4:7], a[12:15], v[48:63]
    ds_read_b128 a[40:43], v198 offset:16384
    ds_read_b128 a[44:47], v198 offset:20480
    s_waitcnt lgkmcnt(6)
    v_mfma_f32_32x32x16_bf16 v[0:15], a[16:19], a[24:27], v[0:15]
    s_add_u32 m0, s40, 77824
    s_nop 0
    buffer_load_dwordx4 v192, s[8:11], s45 offen lds
    s_add_u32 s45, s45, 16384
    ds_read_b64_tr_b16 a[0:1], v214 offset:4096
    v_mfma_f32_32x32x16_bf16 v[16:31], a[20:23], a[24:27], v[16:31]
    ds_read_b64_tr_b16 a[2:3], v214 offset:6144
    ds_read_b64_tr_b16 a[4:5], v215 offset:4096
    v_mfma_f32_32x32x16_bf16 v[32:47], a[16:19], a[28:31], v[32:47]
    s_add_u32 m0, s100, 114688
    s_nop 0
    buffer_load_dwordx4 v193, s[32:35], s46 offen offset:0 sc1 lds
    ds_read_b64_tr_b16 a[6:7], v215 offset:6144
    v_mfma_f32_32x32x16_bf16 v[48:63], a[20:23], a[28:31], v[48:63]
    ds_read_b128 a[8:11], v198 offset:17408
    ds_read_b128 a[12:15], v198 offset:21504
    s_waitcnt lgkmcnt(6)
    v_mfma_f32_32x32x16_bf16 v[0:15], a[32:35], a[40:43], v[0:15]
    s_add_u32 m0, s100, 114688
    s_nop 0
    buffer_load_dwordx4 v193, s[32:35], s46 offen offset:1024 sc1 lds
    ds_read_b64_tr_b16 a[16:17], v214 offset:8192
    v_mfma_f32_32x32x16_bf16 v[16:31], a[36:39], a[40:43], v[16:31]
    ds_read_b64_tr_b16 a[18:19], v214 offset:10240
    ds_read_b64_tr_b16 a[20:21], v215 offset:8192
    v_mfma_f32_32x32x16_bf16 v[32:47], a[32:35], a[44:47], v[32:47]
    s_add_u32 m0, s100, 114688
    s_nop 0
    buffer_load_dwordx4 v193, s[32:35], s46 offen offset:2048 sc1 lds
    ds_read_b64_tr_b16 a[22:23], v215 offset:10240
    v_mfma_f32_32x32x16_bf16 v[48:63], a[36:39], a[44:47], v[48:63]
    ds_read_b128 a[24:27], v198 offset:18432
    ds_read_b128 a[28:31], v198 offset:22528
    s_waitcnt lgkmcnt(6)
    v_mfma_f32_32x32x16_bf16 v[0:15], a[0:3], a[8:11], v[0:15]
    s_add_u32 m0, s100, 114688
    s_nop 0
    buffer_load_dwordx4 v193, s[32:35], s46 offen offset:3072 sc1 lds
    s_add_u32 s46, s46, 4096
    ds_read_b64_tr_b16 a[32:33], v214 offset:12288
    v_mfma_f32_32x32x16_bf16 v[16:31], a[4:7], a[8:11], v[16:31]
    ds_read_b64_tr_b16 a[34:35], v214 offset:14336
    ds_read_b64_tr_b16 a[36:37], v215 offset:12288
    v_mfma_f32_32x32x16_bf16 v[32:47], a[0:3], a[12:15], v[32:47]
    s_add_u32 m0, s40, 98304
    s_nop 0
    buffer_load_dwordx4 v192, s[8:11], s45 offen lds
    s_add_u32 s45, s45, 16384
    ds_read_b64_tr_b16 a[38:39], v215 offset:14336
    v_mfma_f32_32x32x16_bf16 v[48:63], a[4:7], a[12:15], v[48:63]
    ds_read_b128 a[40:43], v198 offset:19456
    ds_read_b128 a[44:47], v198 offset:23552
    s_waitcnt vmcnt(22) lgkmcnt(0)
    s_barrier
    s_waitcnt lgkmcnt(6)
    v_mfma_f32_32x32x16_bf16 v[0:15], a[16:19], a[24:27], v[0:15]
    s_add_u32 m0, s40, 102400
    s_nop 0
    buffer_load_dwordx4 v192, s[8:11], s45 offen lds
    s_add_u32 s45, s45, 16384
    ds_read_b64_tr_b16 a[0:1], v210 offset:0
    v_mfma_f32_32x32x16_bf16 v[16:31], a[20:23], a[24:27], v[16:31]
    ds_read_b64_tr_b16 a[2:3], v210 offset:2048
    ds_read_b64_tr_b16 a[4:5], v211 offset:0
    v_mfma_f32_32x32x16_bf16 v[32:47], a[16:19], a[28:31], v[32:47]
    s_add_u32 m0, s40, 106496
    s_nop 0
    buffer_load_dwordx4 v192, s[8:11], s45 offen lds
    s_add_u32 s45, s45, 16384
    ds_read_b64_tr_b16 a[6:7], v211 offset:2048
    v_mfma_f32_32x32x16_bf16 v[48:63], a[20:23], a[28:31], v[48:63]
    ds_read_b128 a[8:11], v196 offset:16384
    ds_read_b128 a[12:15], v196 offset:20480
    s_waitcnt lgkmcnt(6)
    v_mfma_f32_32x32x16_bf16 v[0:15], a[32:35], a[40:43], v[0:15]
    s_add_u32 m0, s40, 110592
    s_nop 0
    buffer_load_dwordx4 v192, s[8:11], s45 offen lds
    s_add_u32 s45, s45, 16384
    ds_read_b64_tr_b16 a[16:17], v210 offset:4096
    v_mfma_f32_32x32x16_bf16 v[16:31], a[36:39], a[40:43], v[16:31]
    ds_read_b64_tr_b16 a[18:19], v210 offset:6144
    ds_read_b64_tr_b16 a[20:21], v211 offset:4096
    v_mfma_f32_32x32x16_bf16 v[32:47], a[32:35], a[44:47], v[32:47]
    s_add_u32 m0, s100, 147456
    s_nop 0
    buffer_load_dwordx4 v193, s[32:35], s46 offen offset:0 sc1 lds
    ds_read_b64_tr_b16 a[22:23], v211 offset:6144
    v_mfma_f32_32x32x16_bf16 v[48:63], a[36:39], a[44:47], v[48:63]
    ds_read_b128 a[24:27], v196 offset:17408
    ds_read_b128 a[28:31], v196 offset:21504
    s_waitcnt lgkmcnt(6)
    v_mfma_f32_32x32x16_bf16 v[0:15], a[0:3], a[8:11], v[0:15]
    s_add_u32 m0, s100, 147456
    s_nop 0
    buffer_load_dwordx4 v193, s[32:35], s46 offen offset:1024 sc1 lds
    ds_read_b64_tr_b16 a[32:33], v210 offset:8192
    v_mfma_f32_32x32x16_bf16 v[16:31], a[4:7], a[8:11], v[16:31]
    ds_read_b64_tr_b16 a[34:35], v210 offset:10240
    ds_read_b64_tr_b16 a[36:37], v211 offset:8192
    v_mfma_f32_32x32x16_bf16 v[32:47], a[0:3], a[12:15], v[32:47]
    s_add_u32 m0, s100, 147456
    s_nop 0
    buffer_load_dwordx4 v193, s[32:35], s46 offen offset:2048 sc1 lds
    ds_read_b64_tr_b16 a[38:39], v211 offset:10240
    v_mfma_f32_32x32x16_bf16 v[48:63], a[4:7], a[12:15], v[48:63]
    ds_read_b128 a[40:43], v196 offset:18432
    ds_read_b128 a[44:47], v196 offset:22528
    s_waitcnt lgkmcnt(6)
    v_mfma_f32_32x32x16_bf16 v[0:15], a[16:19], a[24:27], v[0:15]
    s_add_u32 m0, s100, 147456
    s_nop 0
    buffer_load_dwordx4 v193, s[32:35], s46 offen offset:3072 sc1 lds
    s_add_u32 s46, s46, 4096
    ds_read_b64_tr_b16 a[0:1], v210 offset:12288
    v_mfma_f32_32x32x16_bf16 v[16:31], a[20:23], a[24:27], v[16:31]
    ds_read_b64_tr_b16 a[2:3], v210 offset:14336
    ds_read_b64_tr_b16 a[4:5], v211 offset:12288
    v_mfma_f32_32x32x16_bf16 v[32:47], a[16:19], a[28:31], v[32:47]
    s_add_u32 m0, s40, 131072
    s_nop 0
    buffer_load_dwordx4 v192, s[8:11], s45 offen lds
    s_add_u32 s45, s45, 16384
    ds_read_b64_tr_b16 a[6:7], v211 offset:14336
    v_mfma_f32_32x32x16_bf16 v[48:63], a[20:23], a[28:31], v[48:63]
    ds_read_b128 a[8:11], v196 offset:19456
    ds_read_b128 a[12:15], v196 offset:23552
    s_waitcnt vmcnt(22) lgkmcnt(0)
    s_barrier
    s_waitcnt lgkmcnt(6)
    v_mfma_f32_32x32x16_bf16 v[0:15], a[32:35], a[40:43], v[0:15]
    s_add_u32 m0, s40, 135168
    s_nop 0
    buffer_load_dwordx4 v192, s[8:11], s45 offen lds
    s_add_u32 s45, s45, 16384
    ds_read_b64_tr_b16 a[16:17], v210 offset:32768
    v_mfma_f32_32x32x16_bf16 v[16:31], a[36:39], a[40:43], v[16:31]
    ds_read_b64_tr_b16 a[18:19], v210 offset:34816
    ds_read_b64_tr_b16 a[20:21], v211 offset:32768
    v_mfma_f32_32x32x16_bf16 v[32:47], a[32:35], a[44:47], v[32:47]
    s_add_u32 m0, s40, 139264
    s_nop 0
    buffer_load_dwordx4 v192, s[8:11], s45 offen lds
    s_add_u32 s45, s45, 16384
    ds_read_b64_tr_b16 a[22:23], v211 offset:34816
    v_mfma_f32_32x32x16_bf16 v[48:63], a[36:39], a[44:47], v[48:63]
    ds_read_b128 a[24:27], v196 offset:49152
    ds_read_b128 a[28:31], v196 offset:53248
    s_waitcnt lgkmcnt(6)
    v_mfma_f32_32x32x16_bf16 v[0:15], a[0:3], a[8:11], v[0:15]
    s_add_u32 m0, s40, 143360
    s_nop 0
    buffer_load_dwordx4 v192, s[8:11], s45 offen lds
    s_add_u32 s45, s45, 16384
    ds_read_b64_tr_b16 a[32:33], v210 offset:36864
    v_mfma_f32_32x32x16_bf16 v[16:31], a[4:7], a[8:11], v[16:31]
    ds_read_b64_tr_b16 a[34:35], v210 offset:38912
    ds_read_b64_tr_b16 a[36:37], v211 offset:36864
    v_mfma_f32_32x32x16_bf16 v[32:47], a[0:3], a[12:15], v[32:47]
    s_add_u32 m0, s100, 16384
    s_nop 0
    buffer_load_dwordx4 v193, s[32:35], s46 offen offset:0 sc1 lds
    ds_read_b64_tr_b16 a[38:39], v211 offset:38912
    v_mfma_f32_32x32x16_bf16 v[48:63], a[4:7], a[12:15], v[48:63]
    ds_read_b128 a[40:43], v196 offset:50176
    ds_read_b128 a[44:47], v196 offset:54272
    s_waitcnt lgkmcnt(6)
    v_mfma_f32_32x32x16_bf16 v[0:15], a[16:19], a[24:27], v[0:15]
    s_add_u32 m0, s100, 16384
    s_nop 0
    buffer_load_dwordx4 v193, s[32:35], s46 offen offset:1024 sc1 lds
    ds_read_b64_tr_b16 a[0:1], v210 offset:40960
    v_mfma_f32_32x32x16_bf16 v[16:31], a[20:23], a[24:27], v[16:31]
    ds_read_b64_tr_b16 a[2:3], v210 offset:43008
    ds_read_b64_tr_b16 a[4:5], v211 offset:40960
    v_mfma_f32_32x32x16_bf16 v[32:47], a[16:19], a[28:31], v[32:47]
    s_add_u32 m0, s100, 16384
    s_nop 0
    buffer_load_dwordx4 v193, s[32:35], s46 offen offset:2048 sc1 lds
    ds_read_b64_tr_b16 a[6:7], v211 offset:43008
    v_mfma_f32_32x32x16_bf16 v[48:63], a[20:23], a[28:31], v[48:63]
    ds_read_b128 a[8:11], v196 offset:51200
    ds_read_b128 a[12:15], v196 offset:55296
    s_waitcnt lgkmcnt(6)
    v_mfma_f32_32x32x16_bf16 v[0:15], a[32:35], a[40:43], v[0:15]
    s_add_u32 m0, s100, 16384
    s_nop 0
    buffer_load_dwordx4 v193, s[32:35], s46 offen offset:3072 sc1 lds
    s_add_u32 s46, s46, 4096
    ds_read_b64_tr_b16 a[16:17], v210 offset:45056
    v_mfma_f32_32x32x16_bf16 v[16:31], a[36:39], a[40:43], v[16:31]
    ds_read_b64_tr_b16 a[18:19], v210 offset:47104
    ds_read_b64_tr_b16 a[20:21], v211 offset:45056
    v_mfma_f32_32x32x16_bf16 v[32:47], a[32:35], a[44:47], v[32:47]
    s_add_u32 m0, s40, 0
    s_nop 0
    buffer_load_dwordx4 v192, s[8:11], s45 offen lds
    s_add_u32 s45, s45, 16384
    ds_read_b64_tr_b16 a[22:23], v211 offset:47104
    v_mfma_f32_32x32x16_bf16 v[48:63], a[36:39], a[44:47], v[48:63]
    ds_read_b128 a[24:27], v196 offset:52224
    ds_read_b128 a[28:31], v196 offset:56320
    s_waitcnt vmcnt(21) lgkmcnt(0)
    s_barrier
    s_waitcnt lgkmcnt(6)
    v_mfma_f32_32x32x16_bf16 v[0:15], a[0:3], a[8:11], v[0:15]
    buffer_load_dword v255, v254, s[68:71], s3 offen offset:8 sc1
    ds_read_b64_tr_b16 a[32:33], v212 offset:0
    v_mfma_f32_32x32x16_bf16 v[16:31], a[4:7], a[8:11], v[16:31]
    ds_read_b64_tr_b16 a[34:35], v212 offset:2048
    ds_read_b64_tr_b16 a[36:37], v213 offset:0
    v_mfma_f32_32x32x16_bf16 v[32:47], a[0:3], a[12:15], v[32:47]
    s_add_u32 m0, s40, 4096
    s_nop 0
    buffer_load_dwordx4 v192, s[8:11], s45 offen lds
    s_add_u32 s45, s45, 16384
    ds_read_b64_tr_b16 a[38:39], v213 offset:2048
    v_mfma_f32_32x32x16_bf16 v[48:63], a[4:7], a[12:15], v[48:63]
    ds_read_b128 a[40:43], v197 offset:16384
    ds_read_b128 a[44:47], v197 offset:20480
    s_waitcnt lgkmcnt(6)
    v_mfma_f32_32x32x16_bf16 v[0:15], a[16:19], a[24:27], v[0:15]
    s_add_u32 m0, s40, 8192
    s_nop 0
    buffer_load_dwordx4 v192, s[8:11], s45 offen lds
    s_add_u32 s45, s45, 16384
    ds_read_b64_tr_b16 a[0:1], v212 offset:4096
    v_mfma_f32_32x32x16_bf16 v[16:31], a[20:23], a[24:27], v[16:31]
    ds_read_b64_tr_b16 a[2:3], v212 offset:6144
    ds_read_b64_tr_b16 a[4:5], v213 offset:4096
    v_mfma_f32_32x32x16_bf16 v[32:47], a[16:19], a[28:31], v[32:47]
    s_add_u32 m0, s40, 12288
    s_nop 0
    buffer_load_dwordx4 v192, s[8:11], s45 offen lds
    s_add_u32 s45, s45, 16384
    ds_read_b64_tr_b16 a[6:7], v213 offset:6144
    v_mfma_f32_32x32x16_bf16 v[48:63], a[20:23], a[28:31], v[48:63]
    ds_read_b128 a[8:11], v197 offset:17408
    ds_read_b128 a[12:15], v197 offset:21504
    s_waitcnt lgkmcnt(6)
    v_mfma_f32_32x32x16_bf16 v[0:15], a[32:35], a[40:43], v[0:15]
    s_add_u32 m0, s100, 49152
    s_nop 0
    buffer_load_dwordx4 v193, s[32:35], s46 offen offset:0 sc1 lds
    ds_read_b64_tr_b16 a[16:17], v212 offset:8192
    v_mfma_f32_32x32x16_bf16 v[16:31], a[36:39], a[40:43], v[16:31]
    ds_read_b64_tr_b16 a[18:19], v212 offset:10240
    ds_read_b64_tr_b16 a[20:21], v213 offset:8192
    v_mfma_f32_32x32x16_bf16 v[32:47], a[32:35], a[44:47], v[32:47]
    s_add_u32 m0, s100, 49152
    s_nop 0
    buffer_load_dwordx4 v193, s[32:35], s46 offen offset:1024 sc1 lds
    ds_read_b64_tr_b16 a[22:23], v213 offset:10240
    v_mfma_f32_32x32x16_bf16 v[48:63], a[36:39], a[44:47], v[48:63]
    ds_read_b128 a[24:27], v197 offset:18432
    ds_read_b128 a[28:31], v197 offset:22528
    s_waitcnt lgkmcnt(6)
    v_mfma_f32_32x32x16_bf16 v[0:15], a[0:3], a[8:11], v[0:15]
    s_add_u32 m0, s100, 49152
    s_nop 0
    buffer_load_dwordx4 v193, s[32:35], s46 offen offset:2048 sc1 lds
    ds_read_b64_tr_b16 a[32:33], v212 offset:12288
    v_mfma_f32_32x32x16_bf16 v[16:31], a[4:7], a[8:11], v[16:31]
    ds_read_b64_tr_b16 a[34:35], v212 offset:14336
    ds_read_b64_tr_b16 a[36:37], v213 offset:12288
    v_mfma_f32_32x32x16_bf16 v[32:47], a[0:3], a[12:15], v[32:47]
    s_add_u32 m0, s100, 49152
    s_nop 0
    buffer_load_dwordx4 v193, s[32:35], s46 offen offset:3072 sc1 lds
    s_add_u32 s46, s46, 4096
    ds_read_b64_tr_b16 a[38:39], v213 offset:14336
    v_mfma_f32_32x32x16_bf16 v[48:63], a[4:7], a[12:15], v[48:63]
    ds_read_b128 a[40:43], v197 offset:19456
    ds_read_b128 a[44:47], v197 offset:23552
    s_waitcnt vmcnt(21) lgkmcnt(0)
    s_barrier
    s_waitcnt lgkmcnt(6)
    v_mfma_f32_32x32x16_bf16 v[0:15], a[16:19], a[24:27], v[0:15]
    s_add_u32 m0, s40, 32768
    s_nop 0
    buffer_load_dwordx4 v192, s[8:11], s45 offen lds
    s_add_u32 s45, s45, 16384
    ds_read_b64_tr_b16 a[0:1], v212 offset:32768
    v_mfma_f32_32x32x16_bf16 v[16:31], a[20:23], a[24:27], v[16:31]
    ds_read_b64_tr_b16 a[2:3], v212 offset:34816
    ds_read_b64_tr_b16 a[4:5], v213 offset:32768
    v_mfma_f32_32x32x16_bf16 v[32:47], a[16:19], a[28:31], v[32:47]
    s_add_u32 m0, s40, 36864
    s_nop 0
    buffer_load_dwordx4 v192, s[8:11], s45 offen lds
    s_add_u32 s45, s45, 16384
    ds_read_b64_tr_b16 a[6:7], v213 offset:34816
    v_mfma_f32_32x32x16_bf16 v[48:63], a[20:23], a[28:31], v[48:63]
    ds_read_b128 a[8:11], v197 offset:49152
    ds_read_b128 a[12:15], v197 offset:53248
    s_waitcnt vmcnt(9)
    v_cmp_ne_u32 vcc, s62, v255
    s_mov_b32 s51, 0
    s_cbranch_vccz SYH_OK
SYH_P:
    s_sleep 2
    buffer_load_dword v255, v254, s[68:71], s3 offen offset:8 sc1
    s_add_u32 s51, s51, 1
    s_waitcnt vmcnt(0)
    v_cmp_ne_u32 vcc, s62, v255
    s_cmp_gt_u32 s51, 0x40000
    s_cbranch_scc1 SYH_OK
    s_cbranch_vccnz SYH_P
SYH_OK:
    s_waitcnt lgkmcnt(6)
    v_mfma_f32_32x32x16_bf16 v[0:15], a[32:35], a[40:43], v[0:15]
    s_add_u32 m0, s40, 40960
    s_nop 0
    buffer_load_dwordx4 v192, s[8:11], s45 offen lds
    s_add_u32 s45, s45, 16384
    ds_read_b64_tr_b16 a[16:17], v212 offset:36864
    v_mfma_f32_32x32x16_bf16 v[16:31], a[36:39], a[40:43], v[16:31]
    ds_read_b64_tr_b16 a[18:19], v212 offset:38912
    ds_read_b64_tr_b16 a[20:21], v213 offset:36864
    v_mfma_f32_32x32x16_bf16 v[32:47], a[32:35], a[44:47], v[32:47]
    s_add_u32 m0, s40, 45056
    s_nop 0
    buffer_load_dwordx4 v192, s[8:11], s45 offen lds
    s_add_u32 s45, s45, 16384
    ds_read_b64_tr_b16 a[22:23], v213 offset:38912
    v_mfma_f32_32x32x16_bf16 v[48:63], a[36:39], a[44:47], v[48:63]
    ds_read_b128 a[24:27], v197 offset:50176
    ds_read_b128 a[28:31], v197 offset:54272
    s_waitcnt lgkmcnt(6)
    v_mfma_f32_32x32x16_bf16 v[0:15], a[0:3], a[8:11], v[0:15]
    buffer_load_dwordx4 a[128:131], v216, s[32:35], s74 offen sc1
    ds_read_b64_tr_b16 a[32:33], v212 offset:40960
    v_mfma_f32_32x32x16_bf16 v[16:31], a[4:7], a[8:11], v[16:31]
    ds_read_b64_tr_b16 a[34:35], v212 offset:43008
    ds_read_b64_tr_b16 a[36:37], v213 offset:40960
    v_mfma_f32_32x32x16_bf16 v[32:47], a[0:3], a[12:15], v[32:47]
    buffer_load_dwordx4 a[132:135], v217, s[32:35], s74 offen sc1
    s_add_u32 s74, s74, 1024
    ds_read_b64_tr_b16 a[38:39], v213 offset:43008
    v_mfma_f32_32x32x16_bf16 v[48:63], a[4:7], a[12:15], v[48:63]
    ds_read_b128 a[40:43], v197 offset:51200
    ds_read_b128 a[44:47], v197 offset:55296
    s_waitcnt lgkmcnt(6)
    v_mfma_f32_32x32x16_bf16 v[0:15], a[16:19], a[24:27], v[0:15]
    buffer_load_dwordx4 a[136:139], v216, s[32:35], s74 offen sc1
    ds_read_b64_tr_b16 a[0:1], v212 offset:45056
    v_mfma_f32_32x32x16_bf16 v[16:31], a[20:23], a[24:27], v[16:31]
    ds_read_b64_tr_b16 a[2:3], v212 offset:47104
    ds_read_b64_tr_b16 a[4:5], v213 offset:45056
    v_mfma_f32_32x32x16_bf16 v[32:47], a[16:19], a[28:31], v[32:47]
    buffer_load_dwordx4 a[140:143], v217, s[32:35], s74 offen sc1
    s_add_u32 s74, s74, 1024
    ds_read_b64_tr_b16 a[6:7], v213 offset:47104
    v_mfma_f32_32x32x16_bf16 v[48:63], a[20:23], a[28:31], v[48:63]
    ds_read_b128 a[8:11], v197 offset:52224
    ds_read_b128 a[12:15], v197 offset:56320
    s_waitcnt vmcnt(21) lgkmcnt(0)
    s_barrier
    s_waitcnt lgkmcnt(6)
    v_mfma_f32_32x32x16_bf16 v[0:15], a[32:35], a[40:43], v[0:15]
    buffer_load_dwordx4 a[144:147], v216, s[32:35], s74 offen sc1
    ds_read_b64_tr_b16 a[16:17], v214 offset:0
    v_mfma_f32_32x32x16_bf16 v[16:31], a[36:39], a[40:43], v[16:31]
    ds_read_b64_tr_b16 a[18:19], v214 offset:2048
    ds_read_b64_tr_b16 a[20:21], v215 offset:0
    v_mfma_f32_32x32x16_bf16 v[32:47], a[32:35], a[44:47], v[32:47]
    buffer_load_dwordx4 a[148:151], v217, s[32:35], s74 offen sc1
    s_add_u32 s74, s74, 1024
    ds_read_b64_tr_b16 a[22:23], v215 offset:2048
    v_mfma_f32_32x32x16_bf16 v[48:63], a[36:39], a[44:47], v[48:63]
    ds_read_b128 a[24:27], v198 offset:16384
    ds_read_b128 a[28:31], v198 offset:20480
    s_waitcnt lgkmcnt(6)
    v_mfma_f32_32x32x16_bf16 v[0:15], a[0:3], a[8:11], v[0:15]
    buffer_load_dwordx4 a[152:155], v216, s[32:35], s74 offen sc1
    ds_read_b64_tr_b16 a[32:33], v214 offset:4096
    v_mfma_f32_32x32x16_bf16 v[16:31], a[4:7], a[8:11], v[16:31]
    ds_read_b64_tr_b16 a[34:35], v214 offset:6144
    ds_read_b64_tr_b16 a[36:37], v215 offset:4096
    v_mfma_f32_32x32x16_bf16 v[32:47], a[0:3], a[12:15], v[32:47]
    buffer_load_dwordx4 a[156:159], v217, s[32:35], s74 offen sc1
    s_add_u32 s74, s74, 1024
    ds_read_b64_tr_b16 a[38:39], v215 offset:6144
    v_mfma_f32_32x32x16_bf16 v[48:63], a[4:7], a[12:15], v[48:63]
    ds_read_b128 a[40:43], v198 offset:17408
    ds_read_b128 a[44:47], v198 offset:21504
    s_waitcnt lgkmcnt(6)
    v_mfma_f32_32x32x16_bf16 v[0:15], a[16:19], a[24:27], v[0:15]
    buffer_load_dwordx4 a[160:163], v216, s[32:35], s74 offen sc1
    ds_read_b64_tr_b16 a[0:1], v214 offset:8192
    v_mfma_f32_32x32x16_bf16 v[16:31], a[20:23], a[24:27], v[16:31]
    ds_read_b64_tr_b16 a[2:3], v214 offset:10240
    ds_read_b64_tr_b16 a[4:5], v215 offset:8192
    v_mfma_f32_32x32x16_bf16 v[32:47], a[16:19], a[28:31], v[32:47]
    buffer_load_dwordx4 a[164:167], v217, s[32:35], s74 offen sc1
    s_add_u32 s74, s74, 1024
    ds_read_b64_tr_b16 a[6:7], v215 offset:10240
    v_mfma_f32_32x32x16_bf16 v[48:63], a[20:23], a[28:31], v[48:63]
    ds_read_b128 a[8:11], v198 offset:18432
    ds_read_b128 a[12:15], v198 offset:22528
    s_waitcnt lgkmcnt(6)
    v_mfma_f32_32x32x16_bf16 v[0:15], a[32:35], a[40:43], v[0:15]
    buffer_load_dwordx4 a[168:171], v216, s[32:35], s74 offen sc1
    ds_read_b64_tr_b16 a[16:17], v214 offset:12288
    v_mfma_f32_32x32x16_bf16 v[16:31], a[36:39], a[40:43], v[16:31]
    ds_read_b64_tr_b16 a[18:19], v214 offset:14336
    ds_read_b64_tr_b16 a[20:21], v215 offset:12288
    v_mfma_f32_32x32x16_bf16 v[32:47], a[32:35], a[44:47], v[32:47]
    buffer_load_dwordx4 a[172:175], v217, s[32:35], s74 offen sc1
    s_add_u32 s74, s74, 1024
    ds_read_b64_tr_b16 a[22:23], v215 offset:14336
    v_mfma_f32_32x32x16_bf16 v[48:63], a[36:39], a[44:47], v[48:63]
    ds_read_b128 a[24:27], v198 offset:19456
    ds_read_b128 a[28:31], v198 offset:23552
    s_waitcnt vmcnt(20) lgkmcnt(0)
    s_barrier
    s_waitcnt lgkmcnt(6)
    v_mfma_f32_32x32x16_bf16 v[0:15], a[0:3], a[8:11], v[0:15]
    buffer_load_dwordx4 a[176:179], v216, s[32:35], s74 offen sc1
    ds_read_b64_tr_b16 a[32:33], v210 offset:0
    v_mfma_f32_32x32x16_bf16 v[16:31], a[4:7], a[8:11], v[16:31]
    ds_read_b64_tr_b16 a[34:35], v210 offset:2048
    ds_read_b64_tr_b16 a[36:37], v211 offset:0
    v_mfma_f32_32x32x16_bf16 v[32:47], a[0:3], a[12:15], v[32:47]
    buffer_load_dwordx4 a[180:183], v217, s[32:35], s74 offen sc1
    s_add_u32 s74, s74, 1024
    ds_read_b64_tr_b16 a[38:39], v211 offset:2048
    v_mfma_f32_32x32x16_bf16 v[48:63], a[4:7], a[12:15], v[48:63]
    ds_read_b128 a[40:43], v196 offset:16384
    ds_read_b128 a[44:47], v196 offset:20480
    s_waitcnt lgkmcnt(6)
    v_mfma_f32_32x32x16_bf16 v[0:15], a[16:19], a[24:27], v[0:15]
    s_add_u32 m0, s75, 0
    s_nop 0
    buffer_load_dwordx4 v218, s[64:67], s73 offen lds
    ds_read_b64_tr_b16 a[0:1], v210 offset:4096
    v_mfma_f32_32x32x16_bf16 v[16:31], a[20:23], a[24:27], v[16:31]
    ds_read_b64_tr_b16 a[2:3], v210 offset:6144
    ds_read_b64_tr_b16 a[4:5], v211 offset:4096
    v_mfma_f32_32x32x16_bf16 v[32:47], a[16:19], a[28:31], v[32:47]
    s_add_u32 m0, s75, 0
    s_nop 0
    buffer_load_dwordx4 v219, s[64:67], s73 offen offset:1024 lds
    s_add_u32 s73, s73, 16384
    ds_read_b64_tr_b16 a[6:7], v211 offset:6144
    v_mfma_f32_32x32x16_bf16 v[48:63], a[20:23], a[28:31], v[48:63]
    ds_read_b128 a[8:11], v196 offset:17408
    ds_read_b128 a[12:15], v196 offset:21504
    s_waitcnt lgkmcnt(6)
    v_mfma_f32_32x32x16_bf16 v[0:15], a[32:35], a[40:43], v[0:15]
    buffer_load_dwordx4 a[184:187], v216, s[32:35], s74 offen sc1
    ds_read_b64_tr_b16 a[16:17], v210 offset:8192
    v_mfma_f32_32x32x16_bf16 v[16:31], a[36:39], a[40:43], v[16:31]
    ds_read_b64_tr_b16 a[18:19], v210 offset:10240
    ds_read_b64_tr_b16 a[20:21], v211 offset:8192
    v_mfma_f32_32x32x16_bf16 v[32:47], a[32:35], a[44:47], v[32:47]
    buffer_load_dwordx4 a[188:191], v217, s[32:35], s74 offen sc1
    s_add_u32 s74, s74, 1024
    ds_read_b64_tr_b16 a[22:23], v211 offset:10240
    v_mfma_f32_32x32x16_bf16 v[48:63], a[36:39], a[44:47], v[48:63]
    ds_read_b128 a[24:27], v196 offset:18432
    ds_read_b128 a[28:31], v196 offset:22528
    s_waitcnt lgkmcnt(6)
    v_mfma_f32_32x32x16_bf16 v[0:15], a[0:3], a[8:11], v[0:15]
    s_add_u32 m0, s75, 2048
    s_nop 0
    buffer_load_dwordx4 v218, s[64:67], s73 offen lds
    ds_read_b64_tr_b16 a[32:33], v210 offset:12288
    v_mfma_f32_32x32x16_bf16 v[16:31], a[4:7], a[8:11], v[16:31]
    ds_read_b64_tr_b16 a[34:35], v210 offset:14336
    ds_read_b64_tr_b16 a[36:37], v211 offset:12288
    v_mfma_f32_32x32x16_bf16 v[32:47], a[0:3], a[12:15], v[32:47]
    s_add_u32 m0, s75, 2048
    s_nop 0
    buffer_load_dwordx4 v219, s[64:67], s73 offen offset:1024 lds
    s_add_u32 s73, s73, 16384
    ds_read_b64_tr_b16 a[38:39], v211 offset:14336
    v_mfma_f32_32x32x16_bf16 v[48:63], a[4:7], a[12:15], v[48:63]
    ds_read_b128 a[40:43], v196 offset:19456
    ds_read_b128 a[44:47], v196 offset:23552
    s_waitcnt vmcnt(20) lgkmcnt(0)
    s_barrier
    s_waitcnt lgkmcnt(6)
    v_mfma_f32_32x32x16_bf16 v[0:15], a[16:19], a[24:27], v[0:15]
    buffer_load_dwordx4 a[192:195], v216, s[32:35], s74 offen sc1
    ds_read_b64_tr_b16 a[0:1], v210 offset:32768
    v_mfma_f32_32x32x16_bf16 v[16:31], a[20:23], a[24:27], v[16:31]
    ds_read_b64_tr_b16 a[2:3], v210 offset:34816
    ds_read_b64_tr_b16 a[4:5], v211 offset:32768
    v_mfma_f32_32x32x16_bf16 v[32:47], a[16:19], a[28:31], v[32:47]
    buffer_load_dwordx4 a[196:199], v217, s[32:35], s74 offen sc1
    s_add_u32 s74, s74, 1024
    ds_read_b64_tr_b16 a[6:7], v211 offset:34816
    v_mfma_f32_32x32x16_bf16 v[48:63], a[20:23], a[28:31], v[48:63]
    ds_read_b128 a[8:11], v196 offset:49152
    ds_read_b128 a[12:15], v196 offset:53248
    s_waitcnt lgkmcnt(6)
    v_mfma_f32_32x32x16_bf16 v[0:15], a[32:35], a[40:43], v[0:15]
    s_add_u32 m0, s75, 4096
    s_nop 0
    buffer_load_dwordx4 v218, s[64:67], s73 offen lds
    ds_read_b64_tr_b16 a[16:17], v210 offset:36864
    v_mfma_f32_32x32x16_bf16 v[16:31], a[36:39], a[40:43], v[16:31]
    ds_read_b64_tr_b16 a[18:19], v210 offset:38912
    ds_read_b64_tr_b16 a[20:21], v211 offset:36864
    v_mfma_f32_32x32x16_bf16 v[32:47], a[32:35], a[44:47], v[32:47]
    s_add_u32 m0, s75, 4096
    s_nop 0
    buffer_load_dwordx4 v219, s[64:67], s73 offen offset:1024 lds
    s_add_u32 s73, s73, 16384
    ds_read_b64_tr_b16 a[22:23], v211 offset:38912
    v_mfma_f32_32x32x16_bf16 v[48:63], a[36:39], a[44:47], v[48:63]
    ds_read_b128 a[24:27], v196 offset:50176
    ds_read_b128 a[28:31], v196 offset:54272
    s_waitcnt lgkmcnt(6)
    v_mfma_f32_32x32x16_bf16 v[0:15], a[0:3], a[8:11], v[0:15]
    buffer_load_dwordx4 a[200:203], v216, s[32:35], s74 offen sc1
    ds_read_b64_tr_b16 a[32:33], v210 offset:40960
    v_mfma_f32_32x32x16_bf16 v[16:31], a[4:7], a[8:11], v[16:31]
    ds_read_b64_tr_b16 a[34:35], v210 offset:43008
    ds_read_b64_tr_b16 a[36:37], v211 offset:40960
    v_mfma_f32_32x32x16_bf16 v[32:47], a[0:3], a[12:15], v[32:47]
    buffer_load_dwordx4 a[204:207], v217, s[32:35], s74 offen sc1
    s_add_u32 s74, s74, 1024
    ds_read_b64_tr_b16 a[38:39], v211 offset:43008
    v_mfma_f32_32x32x16_bf16 v[48:63], a[4:7], a[12:15], v[48:63]
    ds_read_b128 a[40:43], v196 offset:51200
    ds_read_b128 a[44:47], v196 offset:55296
    s_waitcnt lgkmcnt(6)
    v_mfma_f32_32x32x16_bf16 v[0:15], a[16:19], a[24:27], v[0:15]
    s_add_u32 m0, s75, 6144
    s_nop 0
    buffer_load_dwordx4 v218, s[64:67], s73 offen lds
    ds_read_b64_tr_b16 a[0:1], v210 offset:45056
    v_mfma_f32_32x32x16_bf16 v[16:31], a[20:23], a[24:27], v[16:31]
    ds_read_b64_tr_b16 a[2:3], v210 offset:47104
    ds_read_b64_tr_b16 a[4:5], v211 offset:45056
    v_mfma_f32_32x32x16_bf16 v[32:47], a[16:19], a[28:31], v[32:47]
    s_add_u32 m0, s75, 6144
    s_nop 0
    buffer_load_dwordx4 v219, s[64:67], s73 offen offset:1024 lds
    s_add_u32 s73, s73, 16384
    ds_read_b64_tr_b16 a[6:7], v211 offset:47104
    v_mfma_f32_32x32x16_bf16 v[48:63], a[20:23], a[28:31], v[48:63]
    ds_read_b128 a[8:11], v196 offset:52224
    ds_read_b128 a[12:15], v196 offset:56320
    s_waitcnt lgkmcnt(6)
    v_mfma_f32_32x32x16_bf16 v[0:15], a[32:35], a[40:43], v[0:15]
    buffer_load_dwordx4 a[208:211], v216, s[32:35], s74 offen sc1
    s_lshl_b32 s54, s36, 13
    v_mfma_f32_32x32x16_bf16 v[16:31], a[36:39], a[40:43], v[16:31]
    buffer_load_dwordx4 a[212:215], v217, s[32:35], s74 offen sc1
    s_add_u32 s74, s74, 1024
    s_add_u32 s54, s54, 131072
    v_mfma_f32_32x32x16_bf16 v[32:47], a[32:35], a[44:47], v[32:47]
    s_add_u32 m0, s75, 8192
    s_nop 0
    buffer_load_dwordx4 v218, s[64:67], s73 offen lds
    v_add_u32 v230, s54, v194
    v_mfma_f32_32x32x16_bf16 v[48:63], a[36:39], a[44:47], v[48:63]
    s_add_u32 m0, s75, 8192
    s_nop 0
    buffer_load_dwordx4 v219, s[64:67], s73 offen offset:1024 lds
    s_add_u32 s73, s73, 16384
    s_lshl_b32 s54, s38, 13
    s_waitcnt lgkmcnt(0)
    v_mfma_f32_32x32x16_bf16 v[0:15], a[0:3], a[8:11], v[0:15]
    buffer_load_dwordx4 a[216:219], v216, s[32:35], s74 offen sc1
    s_add_u32 s54, s54, s39
    v_mfma_f32_32x32x16_bf16 v[16:31], a[4:7], a[8:11], v[16:31]
    buffer_load_dwordx4 a[220:223], v217, s[32:35], s74 offen sc1
    s_add_u32 s74, s74, 1024
    s_add_u32 s54, s54, 131072
    v_mfma_f32_32x32x16_bf16 v[32:47], a[0:3], a[12:15], v[32:47]
    s_add_u32 m0, s75, 10240
    s_nop 0
    buffer_load_dwordx4 v218, s[64:67], s73 offen lds
    v_add_u32 v231, s54, v194
    v_mfma_f32_32x32x16_bf16 v[48:63], a[4:7], a[12:15], v[48:63]
    s_add_u32 m0, s75, 10240
    s_nop 0
    buffer_load_dwordx4 v219, s[64:67], s73 offen offset:1024 lds
    s_add_u32 s73, s73, 16384
    s_waitcnt vmcnt(34)
    s_barrier
    v_mfma_f32_32x32x16_bf16 v[64:79], a[48:51], a[128:131], 0
    buffer_load_dwordx4 a[224:227], v216, s[32:35], s74 offen sc1
    v_mfma_f32_32x32x16_bf16 v[80:95], a[52:55], a[128:131], 0
    buffer_load_dwordx4 a[228:231], v217, s[32:35], s74 offen sc1
    s_add_u32 s74, s74, 1024
    v_mfma_f32_32x32x16_bf16 v[96:111], a[48:51], a[132:135], 0
    s_add_u32 m0, s75, 12288
    s_nop 0
    buffer_load_dwordx4 v218, s[64:67], s73 offen lds
    v_mfma_f32_32x32x16_bf16 v[112:127], a[52:55], a[132:135], 0
    s_add_u32 m0, s75, 12288
    s_nop 0
    buffer_load_dwordx4 v219, s[64:67], s73 offen offset:1024 lds
    s_add_u32 s73, s73, 16384
    s_waitcnt vmcnt(36)
    v_mfma_f32_32x32x16_bf16 v[64:79], a[56:59], a[136:139], v[64:79]
    buffer_load_dwordx4 a[232:235], v216, s[32:35], s74 offen sc1
    v_cvt_pk_bf16_f32 v128, v0, v1
    v_cvt_pk_bf16_f32 v129, v2, v3
    v_mfma_f32_32x32x16_bf16 v[80:95], a[60:63], a[136:139], v[80:95]
    buffer_load_dwordx4 a[236:239], v217, s[32:35], s74 offen sc1
    s_add_u32 s74, s74, 1024
    v_cvt_pk_bf16_f32 v130, v4, v5
    v_cvt_pk_bf16_f32 v131, v6, v7
    v_mfma_f32_32x32x16_bf16 v[96:111], a[56:59], a[140:143], v[96:111]
    buffer_store_dwordx4 v[128:131], v194, s[24:27], s59 offen offset:0 sc1
    ds_write_b128 v230, v[128:131] offset:0
    v_cvt_pk_bf16_f32 v132, v8, v9
    v_cvt_pk_bf16_f32 v133, v10, v11
    v_mfma_f32_32x32x16_bf16 v[112:127], a[60:63], a[140:143], v[112:127]
    s_add_u32 m0, s75, 14336
    s_nop 0
    buffer_load_dwordx4 v218, s[64:67], s73 offen lds
    v_cvt_pk_bf16_f32 v134, v12, v13
    v_cvt_pk_bf16_f32 v135, v14, v15
    s_waitcnt vmcnt(38)
    v_mfma_f32_32x32x16_bf16 v[64:79], a[64:67], a[144:147], v[64:79]
    buffer_store_dwordx4 v[132:135], v194, s[24:27], s59 offen offset:1024 sc1
    ds_write_b128 v230, v[132:135] offset:1024
    v_cvt_pk_bf16_f32 v136, v16, v17
    v_cvt_pk_bf16_f32 v137, v18, v19
    v_mfma_f32_32x32x16_bf16 v[80:95], a[68:71], a[144:147], v[80:95]
    s_add_u32 m0, s75, 14336
    s_nop 0
    buffer_load_dwordx4 v219, s[64:67], s73 offen offset:1024 lds
    s_add_u32 s73, s73, 16384
    v_cvt_pk_bf16_f32 v138, v20, v21
    v_cvt_pk_bf16_f32 v139, v22, v23
    v_mfma_f32_32x32x16_bf16 v[96:111], a[64:67], a[148:151], v[96:111]
    buffer_store_dwordx4 v[136:139], v194, s[24:27], s59 offen offset:2048 sc1
    ds_write_b128 v230, v[136:139] offset:2048
    v_cvt_pk_bf16_f32 v140, v24, v25
    v_cvt_pk_bf16_f32 v141, v26, v27
    v_mfma_f32_32x32x16_bf16 v[112:127], a[68:71], a[148:151], v[112:127]
    buffer_load_dwordx4 a[128:131], v216, s[32:35], s74 offen sc1
    v_cvt_pk_bf16_f32 v142, v28, v29
    v_cvt_pk_bf16_f32 v143, v30, v31
    s_waitcnt vmcnt(40)
    v_mfma_f32_32x32x16_bf16 v[64:79], a[72:75], a[152:155], v[64:79]
    buffer_store_dwordx4 v[140:143], v194, s[24:27], s59 offen offset:3072 sc1
    ds_write_b128 v230, v[140:143] offset:3072
    v_cvt_pk_bf16_f32 v144, v32, v33
    v_cvt_pk_bf16_f32 v145, v34, v35
    v_mfma_f32_32x32x16_bf16 v[80:95], a[76:79], a[152:155], v[80:95]
    buffer_load_dwordx4 a[132:135], v217, s[32:35], s74 offen sc1
    s_add_u32 s74, s74, 1024
    v_cvt_pk_bf16_f32 v146, v36, v37
    v_cvt_pk_bf16_f32 v147, v38, v39
    s_add_u32 s59, s59, 4096
    v_mfma_f32_32x32x16_bf16 v[96:111], a[72:75], a[156:159], v[96:111]
    buffer_store_dwordx4 v[144:147], v194, s[24:27], s59 offen offset:0 sc1
    ds_write_b128 v230, v[144:147] offset:4096
    v_cvt_pk_bf16_f32 v148, v40, v41
    v_cvt_pk_bf16_f32 v149, v42, v43
    v_mfma_f32_32x32x16_bf16 v[112:127], a[76:79], a[156:159], v[112:127]
    s_add_u32 m0, s75, 4294901760
    s_nop 0
    buffer_load_dwordx4 v218, s[64:67], s73 offen lds
    v_cvt_pk_bf16_f32 v150, v44, v45
    v_cvt_pk_bf16_f32 v151, v46, v47
    s_waitcnt vmcnt(42)
    v_mfma_f32_32x32x16_bf16 v[64:79], a[80:83], a[160:163], v[64:79]
    buffer_store_dwordx4 v[148:151], v194, s[24:27], s59 offen offset:1024 sc1
    ds_write_b128 v230, v[148:151] offset:5120
    v_cvt_pk_bf16_f32 v152, v48, v49
    v_cvt_pk_bf16_f32 v153, v50, v51
    v_mfma_f32_32x32x16_bf16 v[80:95], a[84:87], a[160:163], v[80:95]
    s_add_u32 m0, s75, 4294901760
    s_nop 0
    buffer_load_dwordx4 v219, s[64:67], s73 offen offset:1024 lds
    s_add_u32 s73, s73, 16384
    v_cvt_pk_bf16_f32 v154, v52, v53
    v_cvt_pk_bf16_f32 v155, v54, v55
    v_mfma_f32_32x32x16_bf16 v[96:111], a[80:83], a[164:167], v[96:111]
    buffer_store_dwordx4 v[152:155], v194, s[24:27], s59 offen offset:2048 sc1
    ds_write_b128 v230, v[152:155] offset:6144
    v_cvt_pk_bf16_f32 v156, v56, v57
    v_cvt_pk_bf16_f32 v157, v58, v59
    v_mfma_f32_32x32x16_bf16 v[112:127], a[84:87], a[164:167], v[112:127]
    buffer_load_dwordx4 a[136:139], v216, s[32:35], s74 offen sc1
    v_cvt_pk_bf16_f32 v158, v60, v61
    v_cvt_pk_bf16_f32 v159, v62, v63
    s_waitcnt vmcnt(44)
    v_mfma_f32_32x32x16_bf16 v[64:79], a[88:91], a[168:171], v[64:79]
    buffer_store_dwordx4 v[156:159], v194, s[24:27], s59 offen offset:3072 sc1
    ds_write_b128 v230, v[156:159] offset:7168
    v_mfma_f32_32x32x16_bf16 v[80:95], a[92:95], a[168:171], v[80:95]
    buffer_load_dwordx4 a[140:143], v217, s[32:35], s74 offen sc1
    s_add_u32 s74, s74, 1024
    v_mfma_f32_32x32x16_bf16 v[96:111], a[88:91], a[172:175], v[96:111]
    s_add_u32 m0, s75, 4294903808
    s_nop 0
    buffer_load_dwordx4 v218, s[64:67], s73 offen lds
    v_mfma_f32_32x32x16_bf16 v[112:127], a[92:95], a[172:175], v[112:127]
    s_add_u32 m0, s75, 4294903808
    s_nop 0
    buffer_load_dwordx4 v219, s[64:67], s73 offen offset:1024 lds
    s_add_u32 s73, s73, 16384
    s_waitcnt vmcnt(46)
    v_mfma_f32_32x32x16_bf16 v[64:79], a[96:99], a[176:179], v[64:79]
    buffer_load_dwordx4 a[144:147], v216, s[32:35], s74 offen sc1
    v_mfma_f32_32x32x16_bf16 v[80:95], a[100:103], a[176:179], v[80:95]
    buffer_load_dwordx4 a[148:151], v217, s[32:35], s74 offen sc1
    s_add_u32 s74, s74, 1024
    v_mfma_f32_32x32x16_bf16 v[96:111], a[96:99], a[180:183], v[96:111]
    s_add_u32 m0, s75, 4294905856
    s_nop 0
    buffer_load_dwordx4 v218, s[64:67], s73 offen lds
    v_mfma_f32_32x32x16_bf16 v[112:127], a[100:103], a[180:183], v[112:127]
    s_add_u32 m0, s75, 4294905856
    s_nop 0
    buffer_load_dwordx4 v219, s[64:67], s73 offen offset:1024 lds
    s_add_u32 s73, s73, 16384
    s_waitcnt vmcnt(46)
    ds_read_b64_tr_b16 a[240:241], v220 offset:0
    ds_read_b64_tr_b16 a[242:243], v220 offset:1024
    ds_read_b64_tr_b16 a[244:245], v221 offset:0
    ds_read_b64_tr_b16 a[246:247], v221 offset:1024
    v_mfma_f32_32x32x16_bf16 v[64:79], a[104:107], a[184:187], v[64:79]
    buffer_load_dwordx4 a[152:155], v216, s[32:35], s74 offen sc1
    v_mfma_f32_32x32x16_bf16 v[80:95], a[108:111], a[184:187], v[80:95]
    buffer_load_dwordx4 a[156:159], v217, s[32:35], s74 offen sc1
    s_add_u32 s74, s74, 1024
    v_mfma_f32_32x32x16_bf16 v[96:111], a[104:107], a[188:191], v[96:111]
    s_add_u32 m0, s75, 4294907904
    s_nop 0
    buffer_load_dwordx4 v218, s[64:67], s73 offen lds
    v_mfma_f32_32x32x16_bf16 v[112:127], a[108:111], a[188:191], v[112:127]
    s_add_u32 m0, s75, 4294907904
    s_nop 0
    buffer_load_dwordx4 v219, s[64:67], s73 offen offset:1024 lds
    s_add_u32 s73, s73, 16384
    s_waitcnt vmcnt(46)
    ds_read_b64_tr_b16 a[248:249], v220 offset:2048
    ds_read_b64_tr_b16 a[250:251], v220 offset:3072
    ds_read_b64_tr_b16 a[252:253], v221 offset:2048
    ds_read_b64_tr_b16 a[254:255], v221 offset:3072
    s_waitcnt lgkmcnt(4)
    v_mfma_f32_32x32x16_bf16 v[64:79], a[240:243], a[192:195], v[64:79]
    buffer_load_dwordx4 a[160:163], v216, s[32:35], s74 offen sc1
    v_mfma_f32_32x32x16_bf16 v[80:95], a[244:247], a[192:195], v[80:95]
    buffer_load_dwordx4 a[164:167], v217, s[32:35], s74 offen sc1
    s_add_u32 s74, s74, 1024
    v_mfma_f32_32x32x16_bf16 v[96:111], a[240:243], a[196:199], v[96:111]
    s_add_u32 m0, s75, 4294909952
    s_nop 0
    buffer_load_dwordx4 v218, s[64:67], s73 offen lds
    v_mfma_f32_32x32x16_bf16 v[112:127], a[244:247], a[196:199], v[112:127]
    s_add_u32 m0, s75, 4294909952
    s_nop 0
    buffer_load_dwordx4 v219, s[64:67], s73 offen offset:1024 lds
    s_add_u32 s73, s73, 16384
    s_waitcnt vmcnt(46)
    ds_read_b64_tr_b16 a[240:241], v220 offset:4096
    ds_read_b64_tr_b16 a[242:243], v220 offset:5120
    ds_read_b64_tr_b16 a[244:245], v221 offset:4096
    ds_read_b64_tr_b16 a[246:247], v221 offset:5120
    s_waitcnt lgkmcnt(4)
    v_mfma_f32_32x32x16_bf16 v[64:79], a[248:251], a[200:203], v[64:79]
    buffer_load_dwordx4 a[168:171], v216, s[32:35], s74 offen sc1
    v_mfma_f32_32x32x16_bf16 v[80:95], a[252:255], a[200:203], v[80:95]
    buffer_load_dwordx4 a[172:175], v217, s[32:35], s74 offen sc1
    s_add_u32 s74, s74, 1024
    v_mfma_f32_32x32x16_bf16 v[96:111], a[248:251], a[204:207], v[96:111]
    s_add_u32 m0, s75, 4294912000
    s_nop 0
    buffer_load_dwordx4 v218, s[64:67], s73 offen lds
    v_mfma_f32_32x32x16_bf16 v[112:127], a[252:255], a[204:207], v[112:127]
    s_add_u32 m0, s75, 4294912000
    s_nop 0
    buffer_load_dwordx4 v219, s[64:67], s73 offen offset:1024 lds
    s_add_u32 s73, s73, 16384
    s_waitcnt vmcnt(46)
    ds_read_b64_tr_b16 a[248:249], v220 offset:6144
    ds_read_b64_tr_b16 a[250:251], v220 offset:7168
    ds_read_b64_tr_b16 a[252:253], v221 offset:6144
    ds_read_b64_tr_b16 a[254:255], v221 offset:7168
    s_lshl_b32 s63, s36, 9
    s_add_u32 s63, s63, s50
    s_lshl_b32 s54, s49, 7
    s_add_u32 s63, s63, s54
    s_lshl_b32 s54, s38, 9
    s_add_u32 s50, s50, s54
    v_and_b32 v254, 384, v254
    s_waitcnt vmcnt(19)
    s_waitcnt lgkmcnt(4)
    v_mfma_f32_32x32x16_bf16 v[64:79], a[240:243], a[208:211], v[64:79]
    v_mov_b32 v248, s62
    v_mov_b32 v249, 0
    s_mov_b64 exec, 1
    buffer_store_dword v248, v249, s[68:71], s63 offen offset:0 sc1
    s_mov_b64 exec, -1
    v_mfma_f32_32x32x16_bf16 v[80:95], a[244:247], a[208:211], v[80:95]
    buffer_load_dwordx4 a[176:179], v216, s[32:35], s74 offen sc1
    v_mfma_f32_32x32x16_bf16 v[96:111], a[240:243], a[212:215], v[96:111]
    buffer_load_dwordx4 a[180:183], v217, s[32:35], s74 offen sc1
    s_add_u32 s74, s74, 1024
    v_mfma_f32_32x32x16_bf16 v[112:127], a[244:247], a[212:215], v[112:127]
    s_add_u32 m0, s75, 4294914048
    s_nop 0
    buffer_load_dwordx4 v218, s[64:67], s73 offen lds
    s_waitcnt vmcnt(46)
    ds_read_b64_tr_b16 a[240:241], v220 offset:8192
    ds_read_b64_tr_b16 a[242:243], v220 offset:9216
    ds_read_b64_tr_b16 a[244:245], v221 offset:8192
    ds_read_b64_tr_b16 a[246:247], v221 offset:9216
    s_waitcnt lgkmcnt(4)
    v_mfma_f32_32x32x16_bf16 v[64:79], a[248:251], a[216:219], v[64:79]
    s_add_u32 m0, s75, 4294914048
    s_nop 0
    buffer_load_dwordx4 v219, s[64:67], s73 offen offset:1024 lds
    s_add_u32 s73, s73, 16384
    v_mfma_f32_32x32x16_bf16 v[80:95], a[252:255], a[216:219], v[80:95]
    buffer_load_dwordx4 a[184:187], v216, s[32:35], s74 offen sc1
    v_mfma_f32_32x32x16_bf16 v[96:111], a[248:251], a[220:223], v[96:111]
    buffer_load_dwordx4 a[188:191], v217, s[32:35], s74 offen sc1
    s_add_u32 s74, s74, 1024
    v_mfma_f32_32x32x16_bf16 v[112:127], a[252:255], a[220:223], v[112:127]
    s_add_u32 m0, s75, 4294916096
    s_nop 0
    buffer_load_dwordx4 v218, s[64:67], s73 offen lds
    s_waitcnt vmcnt(46)
    ds_read_b64_tr_b16 a[248:249], v220 offset:10240
    ds_read_b64_tr_b16 a[250:251], v220 offset:11264
    ds_read_b64_tr_b16 a[252:253], v221 offset:10240
    ds_read_b64_tr_b16 a[254:255], v221 offset:11264
    s_waitcnt lgkmcnt(4)
    s_waitcnt lgkmcnt(14)
    s_barrier
    ds_read_b128 v[184:187], v231
    ds_read_b128 v[188:191], v231 offset:1024
    v_mfma_f32_32x32x16_bf16 v[64:79], a[240:243], a[224:227], v[64:79]
    s_add_u32 m0, s75, 4294916096
    s_nop 0
    buffer_load_dwordx4 v219, s[64:67], s73 offen offset:1024 lds
    s_add_u32 s73, s73, 16384
    v_mfma_f32_32x32x16_bf16 v[80:95], a[244:247], a[224:227], v[80:95]
    buffer_load_dwordx4 a[192:195], v216, s[32:35], s74 offen sc1
    v_mfma_f32_32x32x16_bf16 v[96:111], a[240:243], a[228:231], v[96:111]
    buffer_load_dwordx4 a[196:199], v217, s[32:35], s74 offen sc1
    s_add_u32 s74, s74, 1024
    v_mfma_f32_32x32x16_bf16 v[112:127], a[244:247], a[228:231], v[112:127]
    s_add_u32 m0, s75, 0
    s_nop 0
    buffer_load_dwordx4 v218, s[64:67], s73 offen lds
    s_waitcnt vmcnt(46)
    ds_read_b64_tr_b16 a[240:241], v220 offset:12288
    ds_read_b64_tr_b16 a[242:243], v220 offset:13312
    ds_read_b64_tr_b16 a[244:245], v221 offset:12288
    ds_read_b64_tr_b16 a[246:247], v221 offset:13312
    s_waitcnt lgkmcnt(6)
    v_mfma_f32_32x32x16_bf16 v[64:79], a[248:251], a[232:235], v[64:79]
    s_add_u32 m0, s75, 0
    s_nop 0
    buffer_load_dwordx4 v219, s[64:67], s73 offen offset:1024 lds
    s_add_u32 s73, s73, 16384
    v_mfma_f32_32x32x16_bf16 v[80:95], a[252:255], a[232:235], v[80:95]
    buffer_load_dwordx4 a[200:203], v216, s[32:35], s74 offen sc1
    v_mfma_f32_32x32x16_bf16 v[96:111], a[248:251], a[236:239], v[96:111]
    buffer_load_dwordx4 a[204:207], v217, s[32:35], s74 offen sc1
    s_add_u32 s74, s74, 1024
    v_mfma_f32_32x32x16_bf16 v[112:127], a[252:255], a[236:239], v[112:127]
    s_add_u32 m0, s75, 2048
    s_nop 0
    buffer_load_dwordx4 v218, s[64:67], s73 offen lds
    s_waitcnt vmcnt(42)
    ds_read_b64_tr_b16 a[248:249], v220 offset:14336
    ds_read_b64_tr_b16 a[250:251], v220 offset:15360
    ds_read_b64_tr_b16 a[252:253], v221 offset:14336
    ds_read_b64_tr_b16 a[254:255], v221 offset:15360
    s_waitcnt lgkmcnt(4)
    v_mfma_f32_32x32x16_bf16 v[64:79], a[240:243], a[128:131], v[64:79]
    s_add_u32 m0, s75, 2048
    s_nop 0
    buffer_load_dwordx4 v219, s[64:67], s73 offen offset:1024 lds
    s_add_u32 s73, s73, 16384
    v_lshlrev_b32 v0, 16, v184
    v_and_b32 v1, 0xffff0000, v184
    v_mfma_f32_32x32x16_bf16 v[80:95], a[244:247], a[128:131], v[80:95]
    buffer_load_dwordx4 a[208:211], v216, s[32:35], s74 offen sc1
    v_lshlrev_b32 v2, 16, v185
    v_and_b32 v3, 0xffff0000, v185
    v_mfma_f32_32x32x16_bf16 v[96:111], a[240:243], a[132:135], v[96:111]
    buffer_load_dwordx4 a[212:215], v217, s[32:35], s74 offen sc1
    s_add_u32 s74, s74, 1024
    v_lshlrev_b32 v4, 16, v186
    v_and_b32 v5, 0xffff0000, v186
    v_mfma_f32_32x32x16_bf16 v[112:127], a[244:247], a[132:135], v[112:127]
    s_add_u32 m0, s75, 4096
    s_nop 0
    buffer_load_dwordx4 v218, s[64:67], s73 offen lds
    v_lshlrev_b32 v6, 16, v187
    v_and_b32 v7, 0xffff0000, v187
    s_waitcnt vmcnt(38)
    ds_read_b64_tr_b16 a[240:241], v222 offset:0
    ds_read_b64_tr_b16 a[242:243], v222 offset:1024
    ds_read_b64_tr_b16 a[244:245], v223 offset:0
    ds_read_b64_tr_b16 a[246:247], v223 offset:1024
    s_waitcnt lgkmcnt(4)
    v_mfma_f32_32x32x16_bf16 v[64:79], a[248:251], a[136:139], v[64:79]
    s_add_u32 m0, s75, 4096
    s_nop 0
    buffer_load_dwordx4 v219, s[64:67], s73 offen offset:1024 lds
    s_add_u32 s73, s73, 16384
    v_lshlrev_b32 v8, 16, v188
    v_and_b32 v9, 0xffff0000, v188
    v_mfma_f32_32x32x16_bf16 v[80:95], a[252:255], a[136:139], v[80:95]
    buffer_load_dwordx4 a[216:219], v216, s[32:35], s74 offen sc1
    v_lshlrev_b32 v10, 16, v189
    v_and_b32 v11, 0xffff0000, v189
    v_mfma_f32_32x32x16_bf16 v[96:111], a[248:251], a[140:143], v[96:111]
    buffer_load_dwordx4 a[220:223], v217, s[32:35], s74 offen sc1
    s_add_u32 s74, s74, 1024
    v_lshlrev_b32 v12, 16, v190
    v_and_b32 v13, 0xffff0000, v190
    v_mfma_f32_32x32x16_bf16 v[112:127], a[252:255], a[140:143], v[112:127]
    s_add_u32 m0, s75, 6144
    s_nop 0
    buffer_load_dwordx4 v218, s[64:67], s73 offen lds
    v_lshlrev_b32 v14, 16, v191
    v_and_b32 v15, 0xffff0000, v191
    s_waitcnt vmcnt(38)
    ds_read_b64_tr_b16 a[248:249], v222 offset:2048
    ds_read_b64_tr_b16 a[250:251], v222 offset:3072
    ds_read_b64_tr_b16 a[252:253], v223 offset:2048
    ds_read_b64_tr_b16 a[254:255], v223 offset:3072
    s_waitcnt lgkmcnt(4)
    v_mfma_f32_32x32x16_bf16 v[64:79], a[240:243], a[144:147], v[64:79]
    s_add_u32 m0, s75, 6144
    s_nop 0
    buffer_load_dwordx4 v219, s[64:67], s73 offen offset:1024 lds
    s_add_u32 s73, s73, 16384
    v_mfma_f32_32x32x16_bf16 v[80:95], a[244:247], a[144:147], v[80:95]
    buffer_load_dwordx4 a[224:227], v216, s[32:35], s74 offen sc1
    v_mfma_f32_32x32x16_bf16 v[96:111], a[240:243], a[148:151], v[96:111]
    buffer_load_dwordx4 a[228:231], v217, s[32:35], s74 offen sc1
    s_add_u32 s74, s74, 1024
    v_mfma_f32_32x32x16_bf16 v[112:127], a[244:247], a[148:151], v[112:127]
    buffer_load_dwordx4 a[232:235], v216, s[32:35], s74 offen sc1
    s_waitcnt vmcnt(38)
    ds_read_b64_tr_b16 a[240:241], v222 offset:4096
    ds_read_b64_tr_b16 a[242:243], v222 offset:5120
    ds_read_b64_tr_b16 a[244:245], v223 offset:4096
    ds_read_b64_tr_b16 a[246:247], v223 offset:5120
    s_waitcnt lgkmcnt(4)
    v_mfma_f32_32x32x16_bf16 v[64:79], a[248:251], a[152:155], v[64:79]
    buffer_load_dwordx4 a[236:239], v217, s[32:35], s74 offen sc1
    s_add_u32 s74, s74, 1024
    v_mfma_f32_32x32x16_bf16 v[80:95], a[252:255], a[152:155], v[80:95]
    buffer_load_dwordx4 v[176:179], v199, s[4:7], 0 offen
    v_mfma_f32_32x32x16_bf16 v[96:111], a[248:251], a[156:159], v[96:111]
    buffer_load_dwordx4 v[180:183], v199, s[4:7], 0 offen offset:32
    v_mfma_f32_32x32x16_bf16 v[112:127], a[252:255], a[156:159], v[112:127]
    s_waitcnt vmcnt(37)
    ds_read_b64_tr_b16 a[248:249], v222 offset:6144
    ds_read_b64_tr_b16 a[250:251], v222 offset:7168
    ds_read_b64_tr_b16 a[252:253], v223 offset:6144
    ds_read_b64_tr_b16 a[254:255], v223 offset:7168
    s_waitcnt lgkmcnt(4)
    v_mfma_f32_32x32x16_bf16 v[64:79], a[240:243], a[160:163], v[64:79]
    v_mfma_f32_32x32x16_bf16 v[80:95], a[244:247], a[160:163], v[80:95]
    v_mfma_f32_32x32x16_bf16 v[96:111], a[240:243], a[164:167], v[96:111]
    v_mfma_f32_32x32x16_bf16 v[112:127], a[244:247], a[164:167], v[112:127]
    s_waitcnt vmcnt(33)
    ds_read_b64_tr_b16 a[240:241], v222 offset:8192
    ds_read_b64_tr_b16 a[242:243], v222 offset:9216
    ds_read_b64_tr_b16 a[244:245], v223 offset:8192
    ds_read_b64_tr_b16 a[246:247], v223 offset:9216
    s_waitcnt lgkmcnt(4)
    v_mfma_f32_32x32x16_bf16 v[64:79], a[248:251], a[168:171], v[64:79]
    buffer_load_dword v255, v254, s[68:71], s50 offen offset:0 sc1
    v_mfma_f32_32x32x16_bf16 v[80:95], a[252:255], a[168:171], v[80:95]
    v_mfma_f32_32x32x16_bf16 v[96:111], a[248:251], a[172:175], v[96:111]
    v_mfma_f32_32x32x16_bf16 v[112:127], a[252:255], a[172:175], v[112:127]
    s_waitcnt vmcnt(29)
    ds_read_b64_tr_b16 a[248:249], v222 offset:10240
    ds_read_b64_tr_b16 a[250:251], v222 offset:11264
    ds_read_b64_tr_b16 a[252:253], v223 offset:10240
    ds_read_b64_tr_b16 a[254:255], v223 offset:11264
    s_waitcnt lgkmcnt(4)
    v_mfma_f32_32x32x16_bf16 v[64:79], a[240:243], a[176:179], v[64:79]
    v_mfma_f32_32x32x16_bf16 v[80:95], a[244:247], a[176:179], v[80:95]
    v_mfma_f32_32x32x16_bf16 v[96:111], a[240:243], a[180:183], v[96:111]
    v_mfma_f32_32x32x16_bf16 v[112:127], a[244:247], a[180:183], v[112:127]
    s_waitcnt vmcnt(25)
    ds_read_b64_tr_b16 a[240:241], v222 offset:12288
    ds_read_b64_tr_b16 a[242:243], v222 offset:13312
    ds_read_b64_tr_b16 a[244:245], v223 offset:12288
    ds_read_b64_tr_b16 a[246:247], v223 offset:13312
    s_waitcnt lgkmcnt(4)
    v_mfma_f32_32x32x16_bf16 v[64:79], a[248:251], a[184:187], v[64:79]
    v_mfma_f32_32x32x16_bf16 v[80:95], a[252:255], a[184:187], v[80:95]
    v_mfma_f32_32x32x16_bf16 v[96:111], a[248:251], a[188:191], v[96:111]
    v_mfma_f32_32x32x16_bf16 v[112:127], a[252:255], a[188:191], v[112:127]
    s_waitcnt vmcnt(21)
    ds_read_b64_tr_b16 a[248:249], v222 offset:14336
    ds_read_b64_tr_b16 a[250:251], v222 offset:15360
    ds_read_b64_tr_b16 a[252:253], v223 offset:14336
    ds_read_b64_tr_b16 a[254:255], v223 offset:15360
    s_waitcnt lgkmcnt(4)
    v_mfma_f32_32x32x16_bf16 v[64:79], a[240:243], a[192:195], v[64:79]
    v_mfma_f32_32x32x16_bf16 v[80:95], a[244:247], a[192:195], v[80:95]
    v_mfma_f32_32x32x16_bf16 v[96:111], a[240:243], a[196:199], v[96:111]
    v_mfma_f32_32x32x16_bf16 v[112:127], a[244:247], a[196:199], v[112:127]
    s_waitcnt vmcnt(17)
    ds_read_b64_tr_b16 a[240:241], v220 offset:0
    ds_read_b64_tr_b16 a[242:243], v220 offset:1024
    ds_read_b64_tr_b16 a[244:245], v221 offset:0
    ds_read_b64_tr_b16 a[246:247], v221 offset:1024
    s_waitcnt vmcnt(0)
    v_cmp_ne_u32 vcc, s62, v255
    s_mov_b32 s51, 0
    s_cbranch_vccz SYP_OK
SYP_P:
    s_sleep 2
    buffer_load_dword v255, v254, s[68:71], s50 offen offset:0 sc1
    s_add_u32 s51, s51, 1
    s_waitcnt vmcnt(0)
    v_cmp_ne_u32 vcc, s62, v255
    s_cmp_gt_u32 s51, 0x40000
    s_cbranch_scc1 SYP_OK
    s_cbranch_vccnz SYP_P
SYP_OK:
    s_waitcnt lgkmcnt(4)
    v_mfma_f32_32x32x16_bf16 v[64:79], a[248:251], a[200:203], v[64:79]
    s_add_u32 s42, s72, 0
    s_cmp_eq_u32 s49, 0
    s_cselect_b32 s42, 0x40000000, s42
    buffer_load_dwordx4 v[144:147], v194, s[24:27], s42 offen sc1
    v_mfma_f32_32x32x16_bf16 v[80:95], a[252:255], a[200:203], v[80:95]
    buffer_load_dwordx4 v[148:151], v194, s[24:27], s42 offen offset:1024 sc1
    v_mfma_f32_32x32x16_bf16 v[96:111], a[248:251], a[204:207], v[96:111]
    s_add_u32 s42, s72, 8192
    s_cmp_eq_u32 s49, 1
    s_cselect_b32 s42, 0x40000000, s42
    buffer_load_dwordx4 v[152:155], v194, s[24:27], s42 offen sc1
    v_mfma_f32_32x32x16_bf16 v[112:127], a[252:255], a[204:207], v[112:127]
    buffer_load_dwordx4 v[156:159], v194, s[24:27], s42 offen offset:1024 sc1
    s_waitcnt vmcnt(17)
    ds_read_b64_tr_b16 a[248:249], v220 offset:2048
    ds_read_b64_tr_b16 a[250:251], v220 offset:3072
    ds_read_b64_tr_b16 a[252:253], v221 offset:2048
    ds_read_b64_tr_b16 a[254:255], v221 offset:3072
    s_waitcnt lgkmcnt(4)
    v_mfma_f32_32x32x16_bf16 v[64:79], a[240:243], a[208:211], v[64:79]
    s_add_u32 s42, s72, 16384
    s_cmp_eq_u32 s49, 2
    s_cselect_b32 s42, 0x40000000, s42
    buffer_load_dwordx4 v[160:163], v194, s[24:27], s42 offen sc1
    v_mfma_f32_32x32x16_bf16 v[80:95], a[244:247], a[208:211], v[80:95]
    buffer_load_dwordx4 v[164:167], v194, s[24:27], s42 offen offset:1024 sc1
    v_mfma_f32_32x32x16_bf16 v[96:111], a[240:243], a[212:215], v[96:111]
    s_add_u32 s42, s72, 24576
    s_cmp_eq_u32 s49, 3
    s_cselect_b32 s42, 0x40000000, s42
    buffer_load_dwordx4 v[168:171], v194, s[24:27], s42 offen sc1
    v_mfma_f32_32x32x16_bf16 v[112:127], a[244:247], a[212:215], v[112:127]
    buffer_load_dwordx4 v[172:175], v194, s[24:27], s42 offen offset:1024 sc1
    s_waitcnt vmcnt(17)
    ds_read_b64_tr_b16 a[240:241], v220 offset:4096
    ds_read_b64_tr_b16 a[242:243], v220 offset:5120
    ds_read_b64_tr_b16 a[244:245], v221 offset:4096
    ds_read_b64_tr_b16 a[246:247], v221 offset:5120
    s_waitcnt lgkmcnt(4)
    v_mfma_f32_32x32x16_bf16 v[64:79], a[248:251], a[216:219], v[64:79]
    v_mfma_f32_32x32x16_bf16 v[80:95], a[252:255], a[216:219], v[80:95]
    v_mfma_f32_32x32x16_bf16 v[96:111], a[248:251], a[220:223], v[96:111]
    v_mfma_f32_32x32x16_bf16 v[112:127], a[252:255], a[220:223], v[112:127]
    s_waitcnt vmcnt(13)
    ds_read_b64_tr_b16 a[248:249], v220 offset:6144
    ds_read_b64_tr_b16 a[250:251], v220 offset:7168
    ds_read_b64_tr_b16 a[252:253], v221 offset:6144
    ds_read_b64_tr_b16 a[254:255], v221 offset:7168
    s_waitcnt lgkmcnt(4)
    v_mfma_f32_32x32x16_bf16 v[64:79], a[240:243], a[224:227], v[64:79]
    v_mfma_f32_32x32x16_bf16 v[80:95], a[244:247], a[224:227], v[80:95]
    v_mfma_f32_32x32x16_bf16 v[96:111], a[240:243], a[228:231], v[96:111]
    v_mfma_f32_32x32x16_bf16 v[112:127], a[244:247], a[228:231], v[112:127]
    s_waitcnt vmcnt(11)
    s_waitcnt lgkmcnt(0)
    v_mfma_f32_32x32x16_bf16 v[64:79], a[248:251], a[232:235], v[64:79]
    v_mfma_f32_32x32x16_bf16 v[80:95], a[252:255], a[232:235], v[80:95]
    v_mfma_f32_32x32x16_bf16 v[96:111], a[248:251], a[236:239], v[96:111]
    v_mfma_f32_32x32x16_bf16 v[112:127], a[252:255], a[236:239], v[112:127]
    s_waitcnt vmcnt(9)
    v_lshlrev_b32 v48, 16, v176
    v_and_b32 v49, 0xffff0000, v176
    v_lshlrev_b32 v50, 16, v177
    v_and_b32 v51, 0xffff0000, v177
    v_lshlrev_b32 v52, 16, v178
    v_and_b32 v53, 0xffff0000, v178
    v_lshlrev_b32 v54, 16, v179
    v_and_b32 v55, 0xffff0000, v179
    v_lshlrev_b32 v56, 16, v180
    v_and_b32 v57, 0xffff0000, v180
    v_lshlrev_b32 v58, 16, v181
    v_and_b32 v59, 0xffff0000, v181
    v_lshlrev_b32 v60, 16, v182
    v_and_b32 v61, 0xffff0000, v182
    v_lshlrev_b32 v62, 16, v183
    v_and_b32 v63, 0xffff0000, v183
    v_add_u32 v230, s75, v194
    s_add_u32 s54, s100, 65536
    v_add_u32 v231, s54, v194
    ds_write_b128 v230, v[64:67] offset:0
    ds_write_b128 v230, v[68:71] offset:1024
    ds_write_b128 v230, v[72:75] offset:2048
    ds_write_b128 v230, v[76:79] offset:3072
    ds_write_b128 v230, v[80:83] offset:4096
    ds_write_b128 v230, v[84:87] offset:5120
    ds_write_b128 v230, v[88:91] offset:6144
    ds_write_b128 v230, v[92:95] offset:7168
    ds_write_b128 v230, v[96:99] offset:8192
    ds_write_b128 v230, v[100:103] offset:9216
    ds_write_b128 v230, v[104:107] offset:10240
    ds_write_b128 v230, v[108:111] offset:11264
    ds_write_b128 v230, v[112:115] offset:12288
    ds_write_b128 v230, v[116:119] offset:13312
    ds_write_b128 v230, v[120:123] offset:14336
    ds_write_b128 v230, v[124:127] offset:15360
    s_waitcnt vmcnt(6)
    v_lshlrev_b32 v16, 16, v144
    v_and_b32 v17, 0xffff0000, v144
    v_lshlrev_b32 v18, 16, v145
    v_and_b32 v19, 0xffff0000, v145
    v_lshlrev_b32 v20, 16, v146
    v_and_b32 v21, 0xffff0000, v146
    v_lshlrev_b32 v22, 16, v147
    v_and_b32 v23, 0xffff0000, v147
    v_lshlrev_b32 v24, 16, v148
    v_and_b32 v25, 0xffff0000, v148
    v_lshlrev_b32 v26, 16, v149
    v_and_b32 v27, 0xffff0000, v149
    v_lshlrev_b32 v28, 16, v150
    v_and_b32 v29, 0xffff0000, v150
    v_lshlrev_b32 v30, 16, v151
    v_and_b32 v31, 0xffff0000, v151
    v_pk_add_f32 v[0:1], v[0:1], v[16:17]
    v_pk_add_f32 v[2:3], v[2:3], v[18:19]
    v_pk_add_f32 v[4:5], v[4:5], v[20:21]
    v_pk_add_f32 v[6:7], v[6:7], v[22:23]
    v_pk_add_f32 v[8:9], v[8:9], v[24:25]
    v_pk_add_f32 v[10:11], v[10:11], v[26:27]
    v_pk_add_f32 v[12:13], v[12:13], v[28:29]
    v_pk_add_f32 v[14:15], v[14:15], v[30:31]
    s_waitcnt vmcnt(4)
    v_lshlrev_b32 v16, 16, v152
    v_and_b32 v17, 0xffff0000, v152
    v_lshlrev_b32 v18, 16, v153
    v_and_b32 v19, 0xffff0000, v153
    v_lshlrev_b32 v20, 16, v154
    v_and_b32 v21, 0xffff0000, v154
    v_lshlrev_b32 v22, 16, v155
    v_and_b32 v23, 0xffff0000, v155
    v_lshlrev_b32 v24, 16, v156
    v_and_b32 v25, 0xffff0000, v156
    v_lshlrev_b32 v26, 16, v157
    v_and_b32 v27, 0xffff0000, v157
    v_lshlrev_b32 v28, 16, v158
    v_and_b32 v29, 0xffff0000, v158
    v_lshlrev_b32 v30, 16, v159
    v_and_b32 v31, 0xffff0000, v159
    v_pk_add_f32 v[0:1], v[0:1], v[16:17]
    v_pk_add_f32 v[2:3], v[2:3], v[18:19]
    v_pk_add_f32 v[4:5], v[4:5], v[20:21]
    v_pk_add_f32 v[6:7], v[6:7], v[22:23]
    v_pk_add_f32 v[8:9], v[8:9], v[24:25]
    v_pk_add_f32 v[10:11], v[10:11], v[26:27]
    v_pk_add_f32 v[12:13], v[12:13], v[28:29]
    v_pk_add_f32 v[14:15], v[14:15], v[30:31]
    s_waitcnt vmcnt(2)
    v_lshlrev_b32 v16, 16, v160
    v_and_b32 v17, 0xffff0000, v160
    v_lshlrev_b32 v18, 16, v161
    v_and_b32 v19, 0xffff0000, v161
    v_lshlrev_b32 v20, 16, v162
    v_and_b32 v21, 0xffff0000, v162
    v_lshlrev_b32 v22, 16, v163
    v_and_b32 v23, 0xffff0000, v163
    v_lshlrev_b32 v24, 16, v164
    v_and_b32 v25, 0xffff0000, v164
    v_lshlrev_b32 v26, 16, v165
    v_and_b32 v27, 0xffff0000, v165
    v_lshlrev_b32 v28, 16, v166
    v_and_b32 v29, 0xffff0000, v166
    v_lshlrev_b32 v30, 16, v167
    v_and_b32 v31, 0xffff0000, v167
    v_pk_add_f32 v[0:1], v[0:1], v[16:17]
    v_pk_add_f32 v[2:3], v[2:3], v[18:19]
    v_pk_add_f32 v[4:5], v[4:5], v[20:21]
    v_pk_add_f32 v[6:7], v[6:7], v[22:23]
    v_pk_add_f32 v[8:9], v[8:9], v[24:25]
    v_pk_add_f32 v[10:11], v[10:11], v[26:27]
    v_pk_add_f32 v[12:13], v[12:13], v[28:29]
    v_pk_add_f32 v[14:15], v[14:15], v[30:31]
    s_waitcnt vmcnt(0)
    v_lshlrev_b32 v16, 16, v168
    v_and_b32 v17, 0xffff0000, v168
    v_lshlrev_b32 v18, 16, v169
    v_and_b32 v19, 0xffff0000, v169
    v_lshlrev_b32 v20, 16, v170
    v_and_b32 v21, 0xffff0000, v170
    v_lshlrev_b32 v22, 16, v171
    v_and_b32 v23, 0xffff0000, v171
    v_lshlrev_b32 v24, 16, v172
    v_and_b32 v25, 0xffff0000, v172
    v_lshlrev_b32 v26, 16, v173
    v_and_b32 v27, 0xffff0000, v173
    v_lshlrev_b32 v28, 16, v174
    v_and_b32 v29, 0xffff0000, v174
    v_lshlrev_b32 v30, 16, v175
    v_and_b32 v31, 0xffff0000, v175
    v_pk_add_f32 v[0:1], v[0:1], v[16:17]
    v_pk_add_f32 v[2:3], v[2:3], v[18:19]
    v_pk_add_f32 v[4:5], v[4:5], v[20:21]
    v_pk_add_f32 v[6:7], v[6:7], v[22:23]
    v_pk_add_f32 v[8:9], v[8:9], v[24:25]
    v_pk_add_f32 v[10:11], v[10:11], v[26:27]
    v_pk_add_f32 v[12:13], v[12:13], v[28:29]
    v_pk_add_f32 v[14:15], v[14:15], v[30:31]
    s_waitcnt lgkmcnt(0)
    s_barrier
    ds_read_b128 v[64:67], v231 offset:0
    ds_read_b128 v[68:71], v231 offset:1024
    ds_read_b128 v[72:75], v231 offset:2048
    ds_read_b128 v[76:79], v231 offset:3072
    ds_read_b128 v[80:83], v231 offset:16384
    ds_read_b128 v[84:87], v231 offset:17408
    ds_read_b128 v[88:91], v231 offset:18432
    ds_read_b128 v[92:95], v231 offset:19456
    ds_read_b128 v[96:99], v231 offset:32768
    ds_read_b128 v[100:103], v231 offset:33792
    ds_read_b128 v[104:107], v231 offset:34816
    ds_read_b128 v[108:111], v231 offset:35840
    ds_read_b128 v[112:115], v231 offset:49152
    ds_read_b128 v[116:119], v231 offset:50176
    ds_read_b128 v[120:123], v231 offset:51200
    ds_read_b128 v[124:127], v231 offset:52224
    s_waitcnt lgkmcnt(8)
    v_pk_add_f32 v[64:65], v[64:65], v[80:81]
    v_pk_add_f32 v[66:67], v[66:67], v[82:83]
    v_pk_add_f32 v[68:69], v[68:69], v[84:85]
    v_pk_add_f32 v[70:71], v[70:71], v[86:87]
    v_pk_add_f32 v[72:73], v[72:73], v[88:89]
    v_pk_add_f32 v[74:75], v[74:75], v[90:91]
    v_pk_add_f32 v[76:77], v[76:77], v[92:93]
    v_pk_add_f32 v[78:79], v[78:79], v[94:95]
    s_waitcnt lgkmcnt(0)
    v_pk_add_f32 v[96:97], v[96:97], v[112:113]
    v_pk_add_f32 v[98:99], v[98:99], v[114:115]
    v_pk_add_f32 v[100:101], v[100:101], v[116:117]
    v_pk_add_f32 v[102:103], v[102:103], v[118:119]
    v_pk_add_f32 v[104:105], v[104:105], v[120:121]
    v_pk_add_f32 v[106:107], v[106:107], v[122:123]
    v_pk_add_f32 v[108:109], v[108:109], v[124:125]
    v_pk_add_f32 v[110:111], v[110:111], v[126:127]
    v_pk_add_f32 v[64:65], v[64:65], v[96:97]
    v_pk_add_f32 v[66:67], v[66:67], v[98:99]
    v_pk_add_f32 v[68:69], v[68:69], v[100:101]
    v_pk_add_f32 v[70:71], v[70:71], v[102:103]
    v_pk_add_f32 v[72:73], v[72:73], v[104:105]
    v_pk_add_f32 v[74:75], v[74:75], v[106:107]
    v_pk_add_f32 v[76:77], v[76:77], v[108:109]
    v_pk_add_f32 v[78:79], v[78:79], v[110:111]
    v_pk_mul_f32 v[128:129], v[64:65], s[52:53]
    v_pk_mul_f32 v[130:131], v[66:67], s[52:53]
    v_pk_mul_f32 v[132:133], v[68:69], s[52:53]
    v_pk_mul_f32 v[134:135], v[70:71], s[52:53]
    v_pk_mul_f32 v[136:137], v[72:73], s[52:53]
    v_pk_mul_f32 v[138:139], v[74:75], s[52:53]
    v_pk_mul_f32 v[140:141], v[76:77], s[52:53]
    v_pk_mul_f32 v[142:143], v[78:79], s[52:53]
    v_pk_mul_f32 v[0:1], v[0:1], v[64:65]
    v_pk_mul_f32 v[2:3], v[2:3], v[66:67]
    v_pk_mul_f32 v[4:5], v[4:5], v[68:69]
    v_pk_mul_f32 v[6:7], v[6:7], v[70:71]
    v_pk_mul_f32 v[8:9], v[8:9], v[72:73]
    v_pk_mul_f32 v[10:11], v[10:11], v[74:75]
    v_pk_mul_f32 v[12:13], v[12:13], v[76:77]
    v_pk_mul_f32 v[14:15], v[14:15], v[78:79]
    v_exp_f32 v128, v128
    v_exp_f32 v129, v129
    v_exp_f32 v130, v130
    v_exp_f32 v131, v131
    v_exp_f32 v132, v132
    v_exp_f32 v133, v133
    v_exp_f32 v134, v134
    v_exp_f32 v135, v135
    v_exp_f32 v136, v136
    v_exp_f32 v137, v137
    v_exp_f32 v138, v138
    v_exp_f32 v139, v139
    v_exp_f32 v140, v140
    v_exp_f32 v141, v141
    v_exp_f32 v142, v142
    v_exp_f32 v143, v143
    v_add_f32 v128, 1.0, v128
    v_add_f32 v129, 1.0, v129
    v_add_f32 v130, 1.0, v130
    v_add_f32 v131, 1.0, v131
    v_add_f32 v132, 1.0, v132
    v_add_f32 v133, 1.0, v133
    v_add_f32 v134, 1.0, v134
    v_add_f32 v135, 1.0, v135
    v_add_f32 v136, 1.0, v136
    v_add_f32 v137, 1.0, v137
    v_add_f32 v138, 1.0, v138
    v_add_f32 v139, 1.0, v139
    v_add_f32 v140, 1.0, v140
    v_add_f32 v141, 1.0, v141
    v_add_f32 v142, 1.0, v142
    v_add_f32 v143, 1.0, v143
    v_rcp_f32 v128, v128
    v_rcp_f32 v129, v129
    v_rcp_f32 v130, v130
    v_rcp_f32 v131, v131
    v_rcp_f32 v132, v132
    v_rcp_f32 v133, v133
    v_rcp_f32 v134, v134
    v_rcp_f32 v135, v135
    v_rcp_f32 v136, v136
    v_rcp_f32 v137, v137
    v_rcp_f32 v138, v138
    v_rcp_f32 v139, v139
    v_rcp_f32 v140, v140
    v_rcp_f32 v141, v141
    v_rcp_f32 v142, v142
    v_rcp_f32 v143, v143
    s_nop 0
    v_pk_fma_f32 v[0:1], v[0:1], v[128:129], v[48:49]
    v_pk_fma_f32 v[2:3], v[2:3], v[130:131], v[50:51]
    v_pk_fma_f32 v[4:5], v[4:5], v[132:133], v[52:53]
    v_pk_fma_f32 v[6:7], v[6:7], v[134:135], v[54:55]
    v_pk_fma_f32 v[8:9], v[8:9], v[136:137], v[56:57]
    v_pk_fma_f32 v[10:11], v[10:11], v[138:139], v[58:59]
    v_pk_fma_f32 v[12:13], v[12:13], v[140:141], v[60:61]
    v_pk_fma_f32 v[14:15], v[14:15], v[142:143], v[62:63]
    v_cvt_pk_bf16_f32 v32, v0, v1
    v_cvt_pk_bf16_f32 v33, v2, v3
    v_cvt_pk_bf16_f32 v34, v4, v5
    v_cvt_pk_bf16_f32 v35, v6, v7
    v_cvt_pk_bf16_f32 v36, v8, v9
    v_cvt_pk_bf16_f32 v37, v10, v11
    v_cvt_pk_bf16_f32 v38, v12, v13
    v_cvt_pk_bf16_f32 v39, v14, v15
    buffer_store_dwordx4 v[32:35], v199, s[28:31], 0 offen
    buffer_store_dwordx4 v[36:39], v199, s[28:31], 0 offen offset:32
K_END:
    s_endpgm
K2_SLOW:
    s_mov_b32 s48, 1
    s_mov_b32 s45, 0
    s_mov_b32 s47, 0
    s_sub_u32 s44, s44, 8192
    s_and_b32 s44, s44, 0x7fff
    v_mov_b32 v230, 0xff800000
    v_mov_b32 v231, 0xff800000
    s_waitcnt vmcnt(0) lgkmcnt(0)
K2_SLOWL:
    s_barrier
    s_add_u32 m0, s39, 8192
    s_nop 0
    buffer_load_dwordx4 v222, s[24:27], s45 offen lds
    s_add_u32 m0, s39, 8192
    s_nop 0
    buffer_load_dwordx4 v223, s[24:27], s45 offen offset:1024 lds
    s_add_u32 s45, s45, 8192
    s_and_b32 s45, s45, 0x1ffff
    s_waitcnt vmcnt(0)
    s_barrier
    ds_read_b128 a[192:195], v210 offset:8192
    ds_read_b128 a[196:199], v211 offset:8192
    ds_read_b128 a[200:203], v212 offset:8192
    ds_read_b128 a[204:207], v213 offset:8192
    ds_read_b128 a[208:211], v214 offset:8192
    ds_read_b128 a[212:215], v215 offset:8192
    ds_read_b128 a[216:219], v216 offset:8192
    ds_read_b128 a[220:223], v217 offset:8192
    s_waitcnt lgkmcnt(0)
    v_mfma_f32_32x32x16_bf16 v[64:79], a[192:195], v[0:3], 0
    v_mfma_f32_32x32x16_bf16 v[80:95], a[192:195], v[8:11], 0
    v_mfma_f32_32x32x16_bf16 v[64:79], a[196:199], v[4:7], v[64:79]
    v_mfma_f32_32x32x16_bf16 v[80:95], a[196:199], v[12:15], v[80:95]
    v_mfma_f32_32x32x16_bf16 v[64:79], a[200:203], v[16:19], v[64:79]
    v_mfma_f32_32x32x16_bf16 v[80:95], a[200:203], v[24:27], v[80:95]
    v_mfma_f32_32x32x16_bf16 v[64:79], a[204:207], v[20:23], v[64:79]
    v_mfma_f32_32x32x16_bf16 v[80:95], a[204:207], v[28:31], v[80:95]
    v_mfma_f32_32x32x16_bf16 v[64:79], a[208:211], v[32:35], v[64:79]
    v_mfma_f32_32x32x16_bf16 v[80:95], a[208:211], v[40:43], v[80:95]
    v_mfma_f32_32x32x16_bf16 v[64:79], a[212:215], v[36:39], v[64:79]
    v_mfma_f32_32x32x16_bf16 v[80:95], a[212:215], v[44:47], v[80:95]
    v_mfma_f32_32x32x16_bf16 v[64:79], a[216:219], v[48:51], v[64:79]
    v_mfma_f32_32x32x16_bf16 v[80:95], a[216:219], v[56:59], v[80:95]
    v_mfma_f32_32x32x16_bf16 v[64:79], a[220:223], v[52:55], v[64:79]
    v_mfma_f32_32x32x16_bf16 v[80:95], a[220:223], v[60:63], v[80:95]
    s_nop 11
    v_max3_f32 v230, v230, v64, v65
    v_max3_f32 v230, v230, v66, v67
    v_max3_f32 v230, v230, v68, v69
    v_max3_f32 v230, v230, v70, v71
    v_max3_f32 v230, v230, v72, v73
    v_max3_f32 v230, v230, v74, v75
    v_max3_f32 v230, v230, v76, v77
    v_max3_f32 v230, v230, v78, v79
    v_max3_f32 v231, v231, v80, v81
    v_max3_f32 v231, v231, v82, v83
    v_max3_f32 v231, v231, v84, v85
    v_max3_f32 v231, v231, v86, v87
    v_max3_f32 v231, v231, v88, v89
    v_max3_f32 v231, v231, v90, v91
    v_max3_f32 v231, v231, v92, v93
    v_max3_f32 v231, v231, v94, v95
    s_add_u32 s47, s47, 1
    s_cmp_lt_u32 s47, 16
    s_cbranch_scc1 K2_SLOWL
    v_mov_b32 v232, v230
    v_mov_b32 v233, v231
    s_nop 1
    v_permlane32_swap_b32 v230, v232
    v_permlane32_swap_b32 v231, v233
    v_max_f32 v230, v230, v232
    v_max_f32 v231, v231, v233
    v_sub_f32 v160, 0, v230
    v_sub_f32 v161, 0, v230
    v_sub_f32 v162, 0, v230
    v_sub_f32 v163, 0, v230
    v_sub_f32 v164, 0, v230
    v_sub_f32 v165, 0, v230
    v_sub_f32 v166, 0, v230
    v_sub_f32 v167, 0, v230
    v_sub_f32 v168, 0, v230
    v_sub_f32 v169, 0, v230
    v_sub_f32 v170, 0, v230
    v_sub_f32 v171, 0, v230
    v_sub_f32 v172, 0, v230
    v_sub_f32 v173, 0, v230
    v_sub_f32 v174, 0, v230
    v_sub_f32 v175, 0, v230
    v_sub_f32 v176, 0, v231
    v_sub_f32 v177, 0, v231
    v_sub_f32 v178, 0, v231
    v_sub_f32 v179, 0, v231
    v_sub_f32 v180, 0, v231
    v_sub_f32 v181, 0, v231
    v_sub_f32 v182, 0, v231
    v_sub_f32 v183, 0, v231
    v_sub_f32 v184, 0, v231
    v_sub_f32 v185, 0, v231
    v_sub_f32 v186, 0, v231
    v_sub_f32 v187, 0, v231
    v_sub_f32 v188, 0, v231
    v_sub_f32 v189, 0, v231
    v_sub_f32 v190, 0, v231
    v_sub_f32 v191, 0, v231
    s_barrier
    s_mov_b32 s45, s49
    s_mov_b32 s46, s49
    s_add_u32 m0, s39, 98304
    s_nop 0
    buffer_load_dwordx4 v222, s[24:27], s45 offen lds
    s_add_u32 m0, s39, 98304
    s_nop 0
    buffer_load_dwordx4 v223, s[24:27], s45 offen offset:1024 lds
    s_add_u32 s45, s45, 8192
    s_and_b32 s45, s45, 0x1ffff
    s_add_u32 m0, s39, 106496
    s_nop 0
    buffer_load_dwordx4 v222, s[24:27], s45 offen lds
    s_add_u32 m0, s39, 106496
    s_nop 0
    buffer_load_dwordx4 v223, s[24:27], s45 offen offset:1024 lds
    s_add_u32 s45, s45, 8192
    s_and_b32 s45, s45, 0x1ffff
    s_add_u32 m0, s39, 0
    s_nop 0
    buffer_load_dwordx4 v224, s[28:31], s46 offen lds
    s_add_u32 m0, s39, 0
    s_nop 0
    buffer_load_dwordx4 v224, s[28:31], s46 offen offset:1024 lds
    s_add_u32 s46, s46, 8192
    s_and_b32 s46, s46, 0x1ffff
    s_add_u32 m0, s39, 8192
    s_nop 0
    buffer_load_dwordx4 v222, s[24:27], s45 offen lds
    s_add_u32 m0, s39, 8192
    s_nop 0
    buffer_load_dwordx4 v223, s[24:27], s45 offen offset:1024 lds
    s_add_u32 s45, s45, 8192
    s_and_b32 s45, s45, 0x1ffff
    s_add_u32 m0, s39, 16384
    s_nop 0
    buffer_load_dwordx4 v224, s[28:31], s46 offen lds
    s_add_u32 m0, s39, 16384
    s_nop 0
    buffer_load_dwordx4 v224, s[28:31], s46 offen offset:1024 lds
    s_add_u32 s46, s46, 8192
    s_and_b32 s46, s46, 0x1ffff
    s_add_u32 m0, s39, 24576
    s_nop 0
    buffer_load_dwordx4 v222, s[24:27], s45 offen lds
    s_add_u32 m0, s39, 24576
    s_nop 0
    buffer_load_dwordx4 v223, s[24:27], s45 offen offset:1024 lds
    s_add_u32 s45, s45, 8192
    s_and_b32 s45, s45, 0x1ffff
    s_waitcnt vmcnt(0)
    s_barrier
    v_add_u32 v238, 0x10000, v210
    ds_read_b128 a[192:195], v238 offset:32768
    v_add_u32 v239, 0x10000, v211
    ds_read_b128 a[196:199], v239 offset:32768
    v_add_u32 v240, 0x10000, v212
    ds_read_b128 a[200:203], v240 offset:32768
    v_add_u32 v241, 0x10000, v213
    ds_read_b128 a[204:207], v241 offset:32768
    v_add_u32 v238, 0x10000, v214
    ds_read_b128 a[208:211], v238 offset:32768
    v_add_u32 v239, 0x10000, v215
    ds_read_b128 a[212:215], v239 offset:32768
    v_add_u32 v240, 0x10000, v216
    ds_read_b128 a[216:219], v240 offset:32768
    v_add_u32 v241, 0x10000, v217
    ds_read_b128 a[220:223], v241 offset:32768
    s_branch K2_ATT
CODE_END:
.section .rodata,"a"
.p2align 6
.amdhsa_kernel recurrent_scan__sliding_block_cached__glu_gated_glu__prompt_kernel
  .amdhsa_next_free_vgpr 512
  .amdhsa_next_free_sgpr 102
  .amdhsa_accum_offset 256
  .amdhsa_group_segment_fixed_size 0
  .amdhsa_kernarg_size 96
  .amdhsa_user_sgpr_count 2
  .amdhsa_user_sgpr_kernarg_segment_ptr 1
  .amdhsa_system_sgpr_workgroup_id_x 1
.end_amdhsa_kernel
```
